```python
import torch

def _softmax(x, axis=-1):
    return torch.softmax(x, dim=axis)
def _gelu(x):
    return torch.nn.functional.gelu(x, approximate="tanh")
def _silu(x):
    return torch.nn.functional.silu(x)
def _sigmoid(x):
    return torch.sigmoid(x)
def _layernorm(x, axis=-1, eps=1e-5):
    m = x.mean(dim=axis, keepdim=True)
    v = x.var(dim=axis, keepdim=True, unbiased=False)
    return (x - m) / torch.sqrt(v + eps)
def _scatter_add(tgt, idx, src, axis=0):
    return tgt.clone().index_add_(axis, idx, src)
def _segment_sum(src, seg, n):
    out = torch.zeros((n,) + src.shape[1:], dtype=src.dtype)
    return out.index_add_(0, seg, src)
def _pad(x, pw):
    flat = tuple(v for pair in reversed(pw) for v in pair)
    return torch.nn.functional.pad(x, flat)

kernel_name = 'interleave_layers__sliding_local_dilated__dense_activation_mish__prompt'

def setup_inputs():

    _w = (lambda a: (lambda t: t.to(torch.bfloat16) if t.is_floating_point() else t)(torch.as_tensor(a)))
    def _A_setup():
        B, S, D = 1, 2048, 576
        return {
            "x": _w((lambda *s: torch.randn(*s, dtype=torch.bfloat16) * 0.05)(B, S, D)),
            "wqkv": _w((lambda *s: torch.randn(*s, dtype=torch.bfloat16) * 0.05)(D, 3 * D)),
            "wo": _w((lambda *s: torch.randn(*s, dtype=torch.bfloat16) * 0.05)(D, D)),
        }
    _A_in = _A_setup()

    def _B_setup():
        B, S, D, F = 1, 2048, 576, 4608
        return {
            "x": _w((lambda *s: torch.randn(*s, dtype=torch.bfloat16) * 0.05)(B, S, D)),
            "w1": _w((lambda *s: torch.randn(*s, dtype=torch.bfloat16) * 0.8)(D, F) * (D ** -0.5)),
            "b1": _w((lambda *s: torch.randn(*s, dtype=torch.bfloat16) * 0.8)(F)),
            "w2": _w((lambda *s: torch.randn(*s, dtype=torch.bfloat16) * 0.8)(F, D) * (F ** -0.5)),
        }
    _B_in = _B_setup()

    return {
        "A_x": _A_in["x"],
        "A_wqkv": _A_in["wqkv"],
        "A_wo": _A_in["wo"],
        "B_x": _B_in["x"],
        "B_w1": _B_in["w1"],
        "B_b1": _B_in["b1"],
        "B_w2": _B_in["w2"],
    }

def reference(A_x, A_wqkv, A_wo, B_x, B_w1, B_b1, B_w2):
    def _A_ref(x, wqkv, wo):
        B, S, D = x.shape
        H = 32; Dh = D // H
        W, dil = 8, 2
        qkv = (lambda x, *d: x.permute(*d))((x @ wqkv).reshape(B, S, 3, H, Dh), 2, 0, 3, 1, 4)
        q, k, v = qkv[0], qkv[1], qkv[2]
        scale = Dh ** -0.5
        pos = torch.arange(S)
        off = torch.arange(W) * dil
        idx = pos[:, None] - off[None, :]
        mask = idx >= 0
        idx_c = torch.where(mask, idx, 0).reshape(-1)
        kg = k[:, :, idx_c, :].reshape(B, H, S, W, Dh)
        vg = v[:, :, idx_c, :].reshape(B, H, S, W, Dh)
        logits = torch.einsum("bhsd,bhswd->bhsw", q, kg) * scale
        logits = torch.where(mask[None, None, :, :], logits, -1e9)
        attn = _softmax(logits, axis=-1)
        o = torch.einsum("bhsw,bhswd->bhsd", attn, vg)
        return (lambda x, *d: x.permute(*d))(o, 0, 2, 1, 3).reshape(B, S, D) @ wo

    def _B_ref(x, w1, b1, w2):
        h = torch.einsum("bsd,df->bsf", x, w1) + b1
        sp = torch.log1p(torch.exp(-torch.abs(h))) + torch.where(h > 0, h, torch.zeros_like(h))
        act = h * torch.tanh(sp)
        return torch.einsum("bsf,fd->bsd", act, w2)

    x = A_x
    x = x + _A_ref(_layernorm(x, axis=-1), A_wqkv, A_wo)
    x = x + _B_ref(_layernorm(x, axis=-1), B_w1, B_b1, B_w2)
    x = x + _A_ref(_layernorm(x, axis=-1), A_wqkv, A_wo)
    x = x + _B_ref(_layernorm(x, axis=-1), B_w1, B_b1, B_w2)
    return x
```

```asm
; @launch kernel=mega_kernel grid=(256,1,1) block=(256,1,1) lds=163840
.amdgcn_target "amdgcn-amd-amdhsa--gfx950"
.text

.p2align 8
.globl mega_kernel
.type mega_kernel,@function
mega_kernel:
s_cmp_ge_u32 s2, 256
s_cbranch_scc1 L_mega_end
s_load_dwordx16 s[4:19], s[0:1], 0
s_load_dwordx4 s[20:23], s[0:1], 64
v_and_b32 v1, 63, v0
v_lshrrev_b32 v2, 6, v0
v_lshrrev_b32 v5, 4, v1
v_readfirstlane_b32 s24, v2
v_and_b32 v6, 15, v1
v_lshlrev_b32 v7, 4, v1
s_cmp_lg_u32 s24, 3
s_cbranch_scc1 L_p_nocode
s_getpc_b64 s[36:37]
L_p_pc:
s_lshr_b32 s38, s2, 3
s_lshl_b32 s38, s38, 11
v_lshl_add_u32 v8, v6, 7, s38
v_min_u32 v8, L_mega_last-L_p_pc-4, v8
global_load_dword v95, v8, s[36:37]
L_p_nocode:
s_and_b32 s40, s2, 7
s_lshr_b32 s41, s2, 3
s_lshr_b32 s25, s40, 1
s_mul_i32 s25, s25, 8
s_lshr_b32 s42, s41, 2
s_add_u32 s25, s25, s42
s_and_b32 s26, s40, 1
s_lshl_b32 s26, s26, 2
s_and_b32 s42, s41, 3
s_add_u32 s26, s26, s42
s_lshl_b32 s27, s25, 2
s_add_u32 s27, s27, s24
s_waitcnt lgkmcnt(0)
v_and_b32 v3, 3, v1
v_bfe_u32 v4, v1, 2, 2
s_cmp_ge_u32 s2, 249
s_cbranch_scc1 L_p_zero
s_cmp_ge_u32 s2, 240
s_cbranch_scc1 L_p_wo
s_cmp_ge_u32 s2, 168
s_cbranch_scc1 L_p_w2
s_cmp_ge_u32 s2, 96
s_cbranch_scc1 L_p_w1
s_and_b32 s39, s2, 31
s_cmp_ge_u32 s39, 27
s_cbranch_scc1 L_p_zero
s_mov_b32 s28, s6
s_and_b32 s29, s7, 0xffff
s_mov_b32 s30, 1990656
s_mov_b32 s31, 0x20000
s_lshr_b32 s38, s2, 5
s_lshl_b32 s32, s39, 7
s_mul_i32 s33, s38, 663552
s_add_u32 s32, s32, s33
v_lshrrev_b32 v8, 3, v1
v_mul_u32_u24 v8, 3456, v8
v_and_b32 v9, 7, v1
v_lshl_add_u32 v8, v9, 4, v8
s_mul_i32 s34, s24, 165888
s_add_u32 s32, s32, s34
s_mul_i32 s34, s24, 6144
s_add_u32 m0, s34, 88064
s_nop 0
buffer_load_dwordx4 v8, s[28:31], s32 offen lds
s_add_u32 s32, s32, 27648
s_add_u32 m0, m0, 1024
s_nop 0
buffer_load_dwordx4 v8, s[28:31], s32 offen lds
s_add_u32 s32, s32, 27648
s_add_u32 m0, m0, 1024
s_nop 0
buffer_load_dwordx4 v8, s[28:31], s32 offen lds
s_add_u32 s32, s32, 27648
s_add_u32 m0, m0, 1024
s_nop 0
buffer_load_dwordx4 v8, s[28:31], s32 offen lds
s_add_u32 s32, s32, 27648
s_add_u32 m0, m0, 1024
s_nop 0
buffer_load_dwordx4 v8, s[28:31], s32 offen lds
s_add_u32 s32, s32, 27648
s_add_u32 m0, m0, 1024
s_nop 0
buffer_load_dwordx4 v8, s[28:31], s32 offen lds
s_add_u32 s32, s32, 525312
s_add_u32 m0, m0, 19456
s_cmp_eq_u32 s38, 2
s_cselect_b32 s34, 1990656, 0
s_sub_u32 s32, s32, s34
s_nop 0
buffer_load_dwordx4 v8, s[28:31], s32 offen lds
s_add_u32 s32, s32, 27648
s_add_u32 m0, m0, 1024
s_nop 0
buffer_load_dwordx4 v8, s[28:31], s32 offen lds
s_add_u32 s32, s32, 27648
s_add_u32 m0, m0, 1024
s_nop 0
buffer_load_dwordx4 v8, s[28:31], s32 offen lds
s_add_u32 s32, s32, 27648
s_add_u32 m0, m0, 1024
s_nop 0
buffer_load_dwordx4 v8, s[28:31], s32 offen lds
s_add_u32 s32, s32, 27648
s_add_u32 m0, m0, 1024
s_nop 0
buffer_load_dwordx4 v8, s[28:31], s32 offen lds
s_add_u32 s32, s32, 27648
s_add_u32 m0, m0, 1024
s_nop 0
buffer_load_dwordx4 v8, s[28:31], s32 offen lds
s_add_u32 s32, s32, 525312
s_add_u32 m0, m0, 19456
s_cmp_eq_u32 s38, 1
s_cselect_b32 s34, 1990656, 0
s_sub_u32 s32, s32, s34
s_nop 0
buffer_load_dwordx4 v8, s[28:31], s32 offen lds
s_add_u32 s32, s32, 27648
s_add_u32 m0, m0, 1024
s_nop 0
buffer_load_dwordx4 v8, s[28:31], s32 offen lds
s_add_u32 s32, s32, 27648
s_add_u32 m0, m0, 1024
s_nop 0
buffer_load_dwordx4 v8, s[28:31], s32 offen lds
s_add_u32 s32, s32, 27648
s_add_u32 m0, m0, 1024
s_nop 0
buffer_load_dwordx4 v8, s[28:31], s32 offen lds
s_add_u32 s32, s32, 27648
s_add_u32 m0, m0, 1024
s_nop 0
buffer_load_dwordx4 v8, s[28:31], s32 offen lds
s_add_u32 s32, s32, 27648
s_add_u32 m0, m0, 1024
s_nop 0
buffer_load_dwordx4 v8, s[28:31], s32 offen lds
s_add_u32 s32, s32, 525312
s_add_u32 m0, m0, 19456
v_lshl_add_u32 v10, v5, 3, v4
v_lshlrev_b32 v10, 7, v10
v_lshl_add_u32 v10, v3, 3, v10
s_lshl_b32 s35, s24, 5
s_add_u32 s35, s35, 88064
v_add_u32 v10, s35, v10
v_add_u32 v11, 0x10000, v10
s_mul_i32 s36, s39, 57
s_lshr_b32 s36, s36, 9
s_mul_i32 s37, s36, 9
s_sub_u32 s37, s39, s37
s_lshl_b32 s40, s37, 4
s_lshl_b32 s41, s24, 2
s_add_u32 s40, s40, s41
v_add_u32 v12, s40, v4
v_mul_u32_u24 v13, 57, v12
v_lshrrev_b32 v13, 9, v13
v_mul_u32_u24 v14, 9, v13
v_sub_u32 v14, v12, v14
v_cmp_lt_u32 vcc, 4, v14
v_lshlrev_b32 v15, 1, v13
v_subrev_u32 v12, 5, v14
v_cndmask_b32 v12, v14, v12, vcc
v_addc_co_u32 v15, vcc, 0, v15, vcc
v_mul_u32_u24 v15, 73728, v15
v_lshl_add_u32 v15, v12, 6, v15
s_lshl_b32 s40, s36, 10
v_add_u32 v15, s40, v15
v_and_b32 v12, 1, v13
s_cmp_eq_u32 s36, 0
s_cselect_b32 s40, 144384, 0
v_mul_u32_u24 v9, s40, v12
v_sub_u32 v15, v15, v9
v_lshrrev_b32 v13, 1, v13
v_mul_u32_u24 v13, 294912, v13
v_lshl_add_u32 v13, v12, 6, v13
s_cmp_eq_u32 s36, 2
s_cselect_b32 s40, 73728, 0
s_cmp_eq_u32 s36, 1
s_cselect_b32 s41, 128, 0
s_add_u32 s40, s40, s41
s_add_u32 s40, s40, 147456
v_add_u32 v13, s40, v13
v_cmp_eq_u32 vcc, 4, v14
v_lshlrev_b32 v9, 8, v5
v_lshl_add_u32 v9, v3, 4, v9
v_cndmask_b32 v15, v15, v13, vcc
s_cmp_eq_u32 s36, 2
s_cselect_b64 s[42:43], vcc, 0
s_mul_i32 s40, s38, 24576
s_add_u32 s40, s40, 0
v_add3_u32 v9, v9, v15, s40
v_mov_b32 v13, 0x3f803f80
v_mov_b32 v14, 0
v_mov_b32 v15, 0
s_waitcnt vmcnt(12)
s_barrier
ds_read_b64_tr_b16 v[16:17], v10 offset:0
ds_read_b64_tr_b16 v[18:19], v10 offset:512
ds_read_b64_tr_b16 v[20:21], v10 offset:4096
ds_read_b64_tr_b16 v[22:23], v10 offset:4608
ds_read_b64_tr_b16 v[24:25], v10 offset:8192
ds_read_b64_tr_b16 v[26:27], v10 offset:8704
ds_read_b64_tr_b16 v[28:29], v10 offset:12288
ds_read_b64_tr_b16 v[30:31], v10 offset:12800
ds_read_b64_tr_b16 v[32:33], v10 offset:16384
ds_read_b64_tr_b16 v[34:35], v10 offset:16896
ds_read_b64_tr_b16 v[36:37], v10 offset:20480
ds_read_b64_tr_b16 v[38:39], v10 offset:20992
s_waitcnt lgkmcnt(10)
v_dot2c_f32_bf16 v14, v16, v13
v_dot2c_f32_bf16 v15, v17, v13
v_dot2c_f32_bf16 v14, v18, v13
v_dot2c_f32_bf16 v15, v19, v13
s_waitcnt lgkmcnt(8)
v_dot2c_f32_bf16 v14, v20, v13
v_dot2c_f32_bf16 v15, v21, v13
v_dot2c_f32_bf16 v14, v22, v13
v_dot2c_f32_bf16 v15, v23, v13
s_waitcnt lgkmcnt(6)
v_dot2c_f32_bf16 v14, v24, v13
v_dot2c_f32_bf16 v15, v25, v13
v_dot2c_f32_bf16 v14, v26, v13
v_dot2c_f32_bf16 v15, v27, v13
s_waitcnt lgkmcnt(4)
v_dot2c_f32_bf16 v14, v28, v13
v_dot2c_f32_bf16 v15, v29, v13
v_dot2c_f32_bf16 v14, v30, v13
v_dot2c_f32_bf16 v15, v31, v13
s_waitcnt lgkmcnt(2)
v_dot2c_f32_bf16 v14, v32, v13
v_dot2c_f32_bf16 v15, v33, v13
v_dot2c_f32_bf16 v14, v34, v13
v_dot2c_f32_bf16 v15, v35, v13
s_waitcnt lgkmcnt(0)
v_dot2c_f32_bf16 v14, v36, v13
v_dot2c_f32_bf16 v15, v37, v13
v_dot2c_f32_bf16 v14, v38, v13
v_dot2c_f32_bf16 v15, v39, v13
s_waitcnt vmcnt(6)
s_barrier
ds_read_b64_tr_b16 v[40:41], v10 offset:24576
ds_read_b64_tr_b16 v[42:43], v10 offset:25088
ds_read_b64_tr_b16 v[44:45], v10 offset:28672
ds_read_b64_tr_b16 v[46:47], v10 offset:29184
ds_read_b64_tr_b16 v[48:49], v10 offset:32768
ds_read_b64_tr_b16 v[50:51], v10 offset:33280
ds_read_b64_tr_b16 v[52:53], v10 offset:36864
ds_read_b64_tr_b16 v[54:55], v10 offset:37376
ds_read_b64_tr_b16 v[56:57], v10 offset:40960
ds_read_b64_tr_b16 v[58:59], v10 offset:41472
ds_read_b64_tr_b16 v[60:61], v10 offset:45056
ds_read_b64_tr_b16 v[62:63], v10 offset:45568
s_waitcnt lgkmcnt(10)
v_dot2c_f32_bf16 v14, v40, v13
v_dot2c_f32_bf16 v15, v41, v13
v_dot2c_f32_bf16 v14, v42, v13
v_dot2c_f32_bf16 v15, v43, v13
s_waitcnt lgkmcnt(8)
v_dot2c_f32_bf16 v14, v44, v13
v_dot2c_f32_bf16 v15, v45, v13
v_dot2c_f32_bf16 v14, v46, v13
v_dot2c_f32_bf16 v15, v47, v13
s_waitcnt lgkmcnt(6)
v_dot2c_f32_bf16 v14, v48, v13
v_dot2c_f32_bf16 v15, v49, v13
v_dot2c_f32_bf16 v14, v50, v13
v_dot2c_f32_bf16 v15, v51, v13
s_waitcnt lgkmcnt(4)
v_dot2c_f32_bf16 v14, v52, v13
v_dot2c_f32_bf16 v15, v53, v13
v_dot2c_f32_bf16 v14, v54, v13
v_dot2c_f32_bf16 v15, v55, v13
s_waitcnt lgkmcnt(2)
v_dot2c_f32_bf16 v14, v56, v13
v_dot2c_f32_bf16 v15, v57, v13
v_dot2c_f32_bf16 v14, v58, v13
v_dot2c_f32_bf16 v15, v59, v13
s_waitcnt lgkmcnt(0)
v_dot2c_f32_bf16 v14, v60, v13
v_dot2c_f32_bf16 v15, v61, v13
v_dot2c_f32_bf16 v14, v62, v13
v_dot2c_f32_bf16 v15, v63, v13
s_waitcnt vmcnt(0)
s_barrier
ds_read_b64_tr_b16 v[64:65], v10 offset:49152
ds_read_b64_tr_b16 v[66:67], v10 offset:49664
ds_read_b64_tr_b16 v[68:69], v10 offset:53248
ds_read_b64_tr_b16 v[70:71], v10 offset:53760
ds_read_b64_tr_b16 v[72:73], v10 offset:57344
ds_read_b64_tr_b16 v[74:75], v10 offset:57856
ds_read_b64_tr_b16 v[76:77], v10 offset:61440
ds_read_b64_tr_b16 v[78:79], v10 offset:61952
ds_read_b64_tr_b16 v[80:81], v11 offset:0
ds_read_b64_tr_b16 v[82:83], v11 offset:512
ds_read_b64_tr_b16 v[84:85], v11 offset:4096
ds_read_b64_tr_b16 v[86:87], v11 offset:4608
s_waitcnt lgkmcnt(10)
v_dot2c_f32_bf16 v14, v64, v13
v_dot2c_f32_bf16 v15, v65, v13
v_dot2c_f32_bf16 v14, v66, v13
v_dot2c_f32_bf16 v15, v67, v13
s_waitcnt lgkmcnt(8)
v_dot2c_f32_bf16 v14, v68, v13
v_dot2c_f32_bf16 v15, v69, v13
v_dot2c_f32_bf16 v14, v70, v13
v_dot2c_f32_bf16 v15, v71, v13
s_waitcnt lgkmcnt(6)
v_dot2c_f32_bf16 v14, v72, v13
v_dot2c_f32_bf16 v15, v73, v13
v_dot2c_f32_bf16 v14, v74, v13
v_dot2c_f32_bf16 v15, v75, v13
s_waitcnt lgkmcnt(4)
v_dot2c_f32_bf16 v14, v76, v13
v_dot2c_f32_bf16 v15, v77, v13
v_dot2c_f32_bf16 v14, v78, v13
v_dot2c_f32_bf16 v15, v79, v13
s_waitcnt lgkmcnt(2)
v_dot2c_f32_bf16 v14, v80, v13
v_dot2c_f32_bf16 v15, v81, v13
v_dot2c_f32_bf16 v14, v82, v13
v_dot2c_f32_bf16 v15, v83, v13
s_waitcnt lgkmcnt(0)
v_dot2c_f32_bf16 v14, v84, v13
v_dot2c_f32_bf16 v15, v85, v13
v_dot2c_f32_bf16 v14, v86, v13
v_dot2c_f32_bf16 v15, v87, v13
s_nop 2
v_add_f32 v14, v14, v15
v_mov_b32 v15, v14
s_nop 1
v_permlane16_swap_b32 v14, v15
s_nop 0
v_add_f32 v14, v14, v15
v_mov_b32 v15, v14
s_nop 1
v_permlane32_swap_b32 v14, v15
s_nop 0
v_add_f32 v14, v14, v15
v_mul_f32 v14, 0xbae38e39, v14
v_mov_b32 v12, 0xffff0000
v_mov_b32 v100, v14
v_mov_b32 v101, v14
v_lshlrev_b32 v90, 16, v16
v_and_b32 v91, v12, v16
v_pk_add_f32 v[90:91], v[90:91], v[100:101]
v_cvt_pk_bf16_f32 v16, v90, v91
v_pk_add_f32 v[90:91], v[90:91], v[14:15] op_sel_hi:[1,0]
v_lshlrev_b32 v102, 16, v16
v_and_b32 v103, v12, v16
v_pk_add_f32 v[100:101], v[90:91], v[102:103] neg_lo:[0,1] neg_hi:[0,1]
v_lshlrev_b32 v92, 16, v17
v_and_b32 v93, v12, v17
v_pk_add_f32 v[92:93], v[92:93], v[100:101]
v_cvt_pk_bf16_f32 v17, v92, v93
v_pk_add_f32 v[92:93], v[92:93], v[14:15] op_sel_hi:[1,0]
v_lshlrev_b32 v102, 16, v17
v_and_b32 v103, v12, v17
v_pk_add_f32 v[100:101], v[92:93], v[102:103] neg_lo:[0,1] neg_hi:[0,1]
v_lshlrev_b32 v90, 16, v18
v_and_b32 v91, v12, v18
v_pk_add_f32 v[90:91], v[90:91], v[100:101]
v_cvt_pk_bf16_f32 v18, v90, v91
v_pk_add_f32 v[90:91], v[90:91], v[14:15] op_sel_hi:[1,0]
v_lshlrev_b32 v102, 16, v18
v_and_b32 v103, v12, v18
v_pk_add_f32 v[100:101], v[90:91], v[102:103] neg_lo:[0,1] neg_hi:[0,1]
v_lshlrev_b32 v92, 16, v19
v_and_b32 v93, v12, v19
v_pk_add_f32 v[92:93], v[92:93], v[100:101]
v_cvt_pk_bf16_f32 v19, v92, v93
v_pk_add_f32 v[92:93], v[92:93], v[14:15] op_sel_hi:[1,0]
v_lshlrev_b32 v102, 16, v19
v_and_b32 v103, v12, v19
v_pk_add_f32 v[100:101], v[92:93], v[102:103] neg_lo:[0,1] neg_hi:[0,1]
global_store_dwordx4 v9, v[16:19], s[22:23] sc1
v_add_u32 v9, 0x1000, v9
v_lshlrev_b32 v90, 16, v20
v_and_b32 v91, v12, v20
v_pk_add_f32 v[90:91], v[90:91], v[100:101]
v_cvt_pk_bf16_f32 v20, v90, v91
v_pk_add_f32 v[90:91], v[90:91], v[14:15] op_sel_hi:[1,0]
v_lshlrev_b32 v102, 16, v20
v_and_b32 v103, v12, v20
v_pk_add_f32 v[100:101], v[90:91], v[102:103] neg_lo:[0,1] neg_hi:[0,1]
v_lshlrev_b32 v92, 16, v21
v_and_b32 v93, v12, v21
v_pk_add_f32 v[92:93], v[92:93], v[100:101]
v_cvt_pk_bf16_f32 v21, v92, v93
v_pk_add_f32 v[92:93], v[92:93], v[14:15] op_sel_hi:[1,0]
v_lshlrev_b32 v102, 16, v21
v_and_b32 v103, v12, v21
v_pk_add_f32 v[100:101], v[92:93], v[102:103] neg_lo:[0,1] neg_hi:[0,1]
v_lshlrev_b32 v90, 16, v22
v_and_b32 v91, v12, v22
v_pk_add_f32 v[90:91], v[90:91], v[100:101]
v_cvt_pk_bf16_f32 v22, v90, v91
v_pk_add_f32 v[90:91], v[90:91], v[14:15] op_sel_hi:[1,0]
v_lshlrev_b32 v102, 16, v22
v_and_b32 v103, v12, v22
v_pk_add_f32 v[100:101], v[90:91], v[102:103] neg_lo:[0,1] neg_hi:[0,1]
v_lshlrev_b32 v92, 16, v23
v_and_b32 v93, v12, v23
v_pk_add_f32 v[92:93], v[92:93], v[100:101]
v_cvt_pk_bf16_f32 v23, v92, v93
v_pk_add_f32 v[92:93], v[92:93], v[14:15] op_sel_hi:[1,0]
v_lshlrev_b32 v102, 16, v23
v_and_b32 v103, v12, v23
v_pk_add_f32 v[100:101], v[92:93], v[102:103] neg_lo:[0,1] neg_hi:[0,1]
global_store_dwordx4 v9, v[20:23], s[22:23] sc1
v_add_u32 v9, 0x1000, v9
v_lshlrev_b32 v90, 16, v24
v_and_b32 v91, v12, v24
v_pk_add_f32 v[90:91], v[90:91], v[100:101]
v_cvt_pk_bf16_f32 v24, v90, v91
v_pk_add_f32 v[90:91], v[90:91], v[14:15] op_sel_hi:[1,0]
v_lshlrev_b32 v102, 16, v24
v_and_b32 v103, v12, v24
v_pk_add_f32 v[100:101], v[90:91], v[102:103] neg_lo:[0,1] neg_hi:[0,1]
v_lshlrev_b32 v92, 16, v25
v_and_b32 v93, v12, v25
v_pk_add_f32 v[92:93], v[92:93], v[100:101]
v_cvt_pk_bf16_f32 v25, v92, v93
v_pk_add_f32 v[92:93], v[92:93], v[14:15] op_sel_hi:[1,0]
v_lshlrev_b32 v102, 16, v25
v_and_b32 v103, v12, v25
v_pk_add_f32 v[100:101], v[92:93], v[102:103] neg_lo:[0,1] neg_hi:[0,1]
v_lshlrev_b32 v90, 16, v26
v_and_b32 v91, v12, v26
v_pk_add_f32 v[90:91], v[90:91], v[100:101]
v_cvt_pk_bf16_f32 v26, v90, v91
v_pk_add_f32 v[90:91], v[90:91], v[14:15] op_sel_hi:[1,0]
v_lshlrev_b32 v102, 16, v26
v_and_b32 v103, v12, v26
v_pk_add_f32 v[100:101], v[90:91], v[102:103] neg_lo:[0,1] neg_hi:[0,1]
v_lshlrev_b32 v92, 16, v27
v_and_b32 v93, v12, v27
v_pk_add_f32 v[92:93], v[92:93], v[100:101]
v_cvt_pk_bf16_f32 v27, v92, v93
v_pk_add_f32 v[92:93], v[92:93], v[14:15] op_sel_hi:[1,0]
v_lshlrev_b32 v102, 16, v27
v_and_b32 v103, v12, v27
v_pk_add_f32 v[100:101], v[92:93], v[102:103] neg_lo:[0,1] neg_hi:[0,1]
global_store_dwordx4 v9, v[24:27], s[22:23] sc1
v_add_u32 v9, 0x1000, v9
v_lshlrev_b32 v90, 16, v28
v_and_b32 v91, v12, v28
v_pk_add_f32 v[90:91], v[90:91], v[100:101]
v_cvt_pk_bf16_f32 v28, v90, v91
v_pk_add_f32 v[90:91], v[90:91], v[14:15] op_sel_hi:[1,0]
v_lshlrev_b32 v102, 16, v28
v_and_b32 v103, v12, v28
v_pk_add_f32 v[100:101], v[90:91], v[102:103] neg_lo:[0,1] neg_hi:[0,1]
v_lshlrev_b32 v92, 16, v29
v_and_b32 v93, v12, v29
v_pk_add_f32 v[92:93], v[92:93], v[100:101]
v_cvt_pk_bf16_f32 v29, v92, v93
v_pk_add_f32 v[92:93], v[92:93], v[14:15] op_sel_hi:[1,0]
v_lshlrev_b32 v102, 16, v29
v_and_b32 v103, v12, v29
v_pk_add_f32 v[100:101], v[92:93], v[102:103] neg_lo:[0,1] neg_hi:[0,1]
v_lshlrev_b32 v90, 16, v30
v_and_b32 v91, v12, v30
v_pk_add_f32 v[90:91], v[90:91], v[100:101]
v_cvt_pk_bf16_f32 v30, v90, v91
v_pk_add_f32 v[90:91], v[90:91], v[14:15] op_sel_hi:[1,0]
v_lshlrev_b32 v102, 16, v30
v_and_b32 v103, v12, v30
v_pk_add_f32 v[100:101], v[90:91], v[102:103] neg_lo:[0,1] neg_hi:[0,1]
v_lshlrev_b32 v92, 16, v31
v_and_b32 v93, v12, v31
v_pk_add_f32 v[92:93], v[92:93], v[100:101]
v_cvt_pk_bf16_f32 v31, v92, v93
v_pk_add_f32 v[92:93], v[92:93], v[14:15] op_sel_hi:[1,0]
v_lshlrev_b32 v102, 16, v31
v_and_b32 v103, v12, v31
v_pk_add_f32 v[100:101], v[92:93], v[102:103] neg_lo:[0,1] neg_hi:[0,1]
global_store_dwordx4 v9, v[28:31], s[22:23] sc1
v_add_u32 v9, 0x1000, v9
v_lshlrev_b32 v90, 16, v32
v_and_b32 v91, v12, v32
v_pk_add_f32 v[90:91], v[90:91], v[100:101]
v_cvt_pk_bf16_f32 v32, v90, v91
v_pk_add_f32 v[90:91], v[90:91], v[14:15] op_sel_hi:[1,0]
v_lshlrev_b32 v102, 16, v32
v_and_b32 v103, v12, v32
v_pk_add_f32 v[100:101], v[90:91], v[102:103] neg_lo:[0,1] neg_hi:[0,1]
v_lshlrev_b32 v92, 16, v33
v_and_b32 v93, v12, v33
v_pk_add_f32 v[92:93], v[92:93], v[100:101]
v_cvt_pk_bf16_f32 v33, v92, v93
v_pk_add_f32 v[92:93], v[92:93], v[14:15] op_sel_hi:[1,0]
v_lshlrev_b32 v102, 16, v33
v_and_b32 v103, v12, v33
v_pk_add_f32 v[100:101], v[92:93], v[102:103] neg_lo:[0,1] neg_hi:[0,1]
v_lshlrev_b32 v90, 16, v34
v_and_b32 v91, v12, v34
v_pk_add_f32 v[90:91], v[90:91], v[100:101]
v_cvt_pk_bf16_f32 v34, v90, v91
v_pk_add_f32 v[90:91], v[90:91], v[14:15] op_sel_hi:[1,0]
v_lshlrev_b32 v102, 16, v34
v_and_b32 v103, v12, v34
v_pk_add_f32 v[100:101], v[90:91], v[102:103] neg_lo:[0,1] neg_hi:[0,1]
v_lshlrev_b32 v92, 16, v35
v_and_b32 v93, v12, v35
v_pk_add_f32 v[92:93], v[92:93], v[100:101]
v_cvt_pk_bf16_f32 v35, v92, v93
v_pk_add_f32 v[92:93], v[92:93], v[14:15] op_sel_hi:[1,0]
v_lshlrev_b32 v102, 16, v35
v_and_b32 v103, v12, v35
v_pk_add_f32 v[100:101], v[92:93], v[102:103] neg_lo:[0,1] neg_hi:[0,1]
global_store_dwordx4 v9, v[32:35], s[22:23] sc1
v_add_u32 v9, 0x1000, v9
v_lshlrev_b32 v90, 16, v36
v_and_b32 v91, v12, v36
v_pk_add_f32 v[90:91], v[90:91], v[100:101]
v_cvt_pk_bf16_f32 v36, v90, v91
v_pk_add_f32 v[90:91], v[90:91], v[14:15] op_sel_hi:[1,0]
v_lshlrev_b32 v102, 16, v36
v_and_b32 v103, v12, v36
v_pk_add_f32 v[100:101], v[90:91], v[102:103] neg_lo:[0,1] neg_hi:[0,1]
v_lshlrev_b32 v92, 16, v37
v_and_b32 v93, v12, v37
v_pk_add_f32 v[92:93], v[92:93], v[100:101]
v_cvt_pk_bf16_f32 v37, v92, v93
v_pk_add_f32 v[92:93], v[92:93], v[14:15] op_sel_hi:[1,0]
v_lshlrev_b32 v102, 16, v37
v_and_b32 v103, v12, v37
v_pk_add_f32 v[100:101], v[92:93], v[102:103] neg_lo:[0,1] neg_hi:[0,1]
v_lshlrev_b32 v90, 16, v38
v_and_b32 v91, v12, v38
v_pk_add_f32 v[90:91], v[90:91], v[100:101]
v_cvt_pk_bf16_f32 v38, v90, v91
v_pk_add_f32 v[90:91], v[90:91], v[14:15] op_sel_hi:[1,0]
v_lshlrev_b32 v102, 16, v38
v_and_b32 v103, v12, v38
v_pk_add_f32 v[100:101], v[90:91], v[102:103] neg_lo:[0,1] neg_hi:[0,1]
v_lshlrev_b32 v92, 16, v39
v_and_b32 v93, v12, v39
v_pk_add_f32 v[92:93], v[92:93], v[100:101]
v_cvt_pk_bf16_f32 v39, v92, v93
v_pk_add_f32 v[92:93], v[92:93], v[14:15] op_sel_hi:[1,0]
v_lshlrev_b32 v102, 16, v39
v_and_b32 v103, v12, v39
v_pk_add_f32 v[100:101], v[92:93], v[102:103] neg_lo:[0,1] neg_hi:[0,1]
global_store_dwordx4 v9, v[36:39], s[22:23] sc1
v_add_u32 v9, 0x1000, v9
s_cmp_eq_u64 s[42:43], 0
s_cbranch_scc1 L_p_noone
v_mov_b32 v96, 0x3f803f80
v_mov_b32 v97, 0x3f803f80
v_mov_b32 v98, 0x3f803f80
v_mov_b32 v99, 0x3f803f80
v_add_u32 v92, 4294942848, v9
s_mov_b64 exec, s[42:43]
global_store_dwordx4 v92, v[96:99], s[22:23] sc1
v_add_u32 v92, 0x1000, v92
global_store_dwordx4 v92, v[96:99], s[22:23] sc1
v_add_u32 v92, 0x1000, v92
global_store_dwordx4 v92, v[96:99], s[22:23] sc1
v_add_u32 v92, 0x1000, v92
global_store_dwordx4 v92, v[96:99], s[22:23] sc1
v_add_u32 v92, 0x1000, v92
global_store_dwordx4 v92, v[96:99], s[22:23] sc1
v_add_u32 v92, 0x1000, v92
global_store_dwordx4 v92, v[96:99], s[22:23] sc1
v_add_u32 v92, 0x1000, v92
s_mov_b64 exec, -1
L_p_noone:
s_lshl_b32 s40, s37, 8
s_add_u32 s40, s40, 16523264
s_branch L_p_fin
L_p_w1:
s_mov_b32 s28, s12
s_and_b32 s29, s13, 0xffff
s_mov_b32 s30, 5308416
s_mov_b32 s31, 0x20000
s_sub_u32 s38, s2, 96
s_lshl_b32 s32, s38, 7
s_lshl_b32 s39, s38, 6
v_add_lshl_u32 v94, v1, s39, 1
global_load_ushort v88, v94, s[14:15]
v_lshrrev_b32 v8, 3, v1
v_mul_u32_u24 v8, 9216, v8
v_and_b32 v9, 7, v1
v_lshl_add_u32 v8, v9, 4, v8
s_mul_i32 s34, s24, 442368
s_add_u32 s32, s32, s34
s_mul_i32 s34, s24, 6144
s_add_u32 m0, s34, 88064
s_nop 0
buffer_load_dwordx4 v8, s[28:31], s32 offen lds
s_add_u32 s32, s32, 73728
s_add_u32 m0, m0, 1024
s_nop 0
buffer_load_dwordx4 v8, s[28:31], s32 offen lds
s_add_u32 s32, s32, 73728
s_add_u32 m0, m0, 1024
s_nop 0
buffer_load_dwordx4 v8, s[28:31], s32 offen lds
s_add_u32 s32, s32, 73728
s_add_u32 m0, m0, 1024
s_nop 0
buffer_load_dwordx4 v8, s[28:31], s32 offen lds
s_add_u32 s32, s32, 73728
s_add_u32 m0, m0, 1024
s_nop 0
buffer_load_dwordx4 v8, s[28:31], s32 offen lds
s_add_u32 s32, s32, 73728
s_add_u32 m0, m0, 1024
s_nop 0
buffer_load_dwordx4 v8, s[28:31], s32 offen lds
s_add_u32 s32, s32, 1400832
s_add_u32 m0, m0, 19456
s_nop 0
buffer_load_dwordx4 v8, s[28:31], s32 offen lds
s_add_u32 s32, s32, 73728
s_add_u32 m0, m0, 1024
s_nop 0
buffer_load_dwordx4 v8, s[28:31], s32 offen lds
s_add_u32 s32, s32, 73728
s_add_u32 m0, m0, 1024
s_nop 0
buffer_load_dwordx4 v8, s[28:31], s32 offen lds
s_add_u32 s32, s32, 73728
s_add_u32 m0, m0, 1024
s_nop 0
buffer_load_dwordx4 v8, s[28:31], s32 offen lds
s_add_u32 s32, s32, 73728
s_add_u32 m0, m0, 1024
s_nop 0
buffer_load_dwordx4 v8, s[28:31], s32 offen lds
s_add_u32 s32, s32, 73728
s_add_u32 m0, m0, 1024
s_nop 0
buffer_load_dwordx4 v8, s[28:31], s32 offen lds
s_add_u32 s32, s32, 1400832
s_add_u32 m0, m0, 19456
s_nop 0
buffer_load_dwordx4 v8, s[28:31], s32 offen lds
s_add_u32 s32, s32, 73728
s_add_u32 m0, m0, 1024
s_nop 0
buffer_load_dwordx4 v8, s[28:31], s32 offen lds
s_add_u32 s32, s32, 73728
s_add_u32 m0, m0, 1024
s_nop 0
buffer_load_dwordx4 v8, s[28:31], s32 offen lds
s_add_u32 s32, s32, 73728
s_add_u32 m0, m0, 1024
s_nop 0
buffer_load_dwordx4 v8, s[28:31], s32 offen lds
s_add_u32 s32, s32, 73728
s_add_u32 m0, m0, 1024
s_nop 0
buffer_load_dwordx4 v8, s[28:31], s32 offen lds
s_add_u32 s32, s32, 73728
s_add_u32 m0, m0, 1024
s_nop 0
buffer_load_dwordx4 v8, s[28:31], s32 offen lds
s_add_u32 s32, s32, 1400832
s_add_u32 m0, m0, 19456
v_lshl_add_u32 v10, v5, 2, v4
v_lshlrev_b32 v10, 7, v10
v_lshl_add_u32 v10, v3, 3, v10
s_lshl_b32 s35, s24, 5
s_add_u32 s35, s35, 88064
v_add_u32 v10, s35, v10
v_lshl_add_u32 v11, v5, 3, v4
v_lshlrev_b32 v11, 7, v11
v_lshl_add_u32 v11, v3, 3, v11
s_lshl_b32 s35, s24, 5
s_add_u32 s35, s35, 153600
v_add_u32 v11, s35, v11
s_mul_i32 s36, s38, 57
s_lshr_b32 s36, s36, 9
s_mul_i32 s37, s36, 9
s_sub_u32 s37, s38, s37
s_lshl_b32 s39, s36, 2
s_add_u32 s39, s39, s24
s_mul_i32 s39, s39, 331776
s_mul_i32 s37, s37, 18432
s_add_u32 s39, s39, s37
s_add_u32 s39, s39, 3112960
v_add_u32 v9, s39, v7
v_mov_b32 v13, 0x3f803f80
v_mov_b32 v14, 0
v_mov_b32 v15, 0
s_waitcnt vmcnt(12)
s_barrier
ds_read_b64_tr_b16 v[16:17], v10 offset:0
ds_read_b64_tr_b16 v[18:19], v10 offset:2048
ds_read_b64_tr_b16 v[20:21], v10 offset:4096
ds_read_b64_tr_b16 v[22:23], v10 offset:6144
ds_read_b64_tr_b16 v[24:25], v10 offset:8192
ds_read_b64_tr_b16 v[26:27], v10 offset:10240
ds_read_b64_tr_b16 v[28:29], v10 offset:12288
ds_read_b64_tr_b16 v[30:31], v10 offset:14336
ds_read_b64_tr_b16 v[32:33], v10 offset:16384
ds_read_b64_tr_b16 v[34:35], v10 offset:18432
ds_read_b64_tr_b16 v[36:37], v10 offset:20480
ds_read_b64_tr_b16 v[38:39], v10 offset:22528
s_waitcnt lgkmcnt(10)
v_dot2c_f32_bf16 v14, v16, v13
v_dot2c_f32_bf16 v15, v17, v13
v_dot2c_f32_bf16 v14, v18, v13
v_dot2c_f32_bf16 v15, v19, v13
s_waitcnt lgkmcnt(8)
v_dot2c_f32_bf16 v14, v20, v13
v_dot2c_f32_bf16 v15, v21, v13
v_dot2c_f32_bf16 v14, v22, v13
v_dot2c_f32_bf16 v15, v23, v13
s_waitcnt lgkmcnt(6)
v_dot2c_f32_bf16 v14, v24, v13
v_dot2c_f32_bf16 v15, v25, v13
v_dot2c_f32_bf16 v14, v26, v13
v_dot2c_f32_bf16 v15, v27, v13
s_waitcnt lgkmcnt(4)
v_dot2c_f32_bf16 v14, v28, v13
v_dot2c_f32_bf16 v15, v29, v13
v_dot2c_f32_bf16 v14, v30, v13
v_dot2c_f32_bf16 v15, v31, v13
s_waitcnt lgkmcnt(2)
v_dot2c_f32_bf16 v14, v32, v13
v_dot2c_f32_bf16 v15, v33, v13
v_dot2c_f32_bf16 v14, v34, v13
v_dot2c_f32_bf16 v15, v35, v13
s_waitcnt lgkmcnt(0)
v_dot2c_f32_bf16 v14, v36, v13
v_dot2c_f32_bf16 v15, v37, v13
v_dot2c_f32_bf16 v14, v38, v13
v_dot2c_f32_bf16 v15, v39, v13
s_waitcnt vmcnt(6)
s_barrier
ds_read_b64_tr_b16 v[40:41], v10 offset:24576
ds_read_b64_tr_b16 v[42:43], v10 offset:26624
ds_read_b64_tr_b16 v[44:45], v10 offset:28672
ds_read_b64_tr_b16 v[46:47], v10 offset:30720
ds_read_b64_tr_b16 v[48:49], v10 offset:32768
ds_read_b64_tr_b16 v[50:51], v10 offset:34816
ds_read_b64_tr_b16 v[52:53], v10 offset:36864
ds_read_b64_tr_b16 v[54:55], v10 offset:38912
ds_read_b64_tr_b16 v[56:57], v10 offset:40960
ds_read_b64_tr_b16 v[58:59], v10 offset:43008
ds_read_b64_tr_b16 v[60:61], v10 offset:45056
ds_read_b64_tr_b16 v[62:63], v10 offset:47104
s_waitcnt lgkmcnt(10)
v_dot2c_f32_bf16 v14, v40, v13
v_dot2c_f32_bf16 v15, v41, v13
v_dot2c_f32_bf16 v14, v42, v13
v_dot2c_f32_bf16 v15, v43, v13
s_waitcnt lgkmcnt(8)
v_dot2c_f32_bf16 v14, v44, v13
v_dot2c_f32_bf16 v15, v45, v13
v_dot2c_f32_bf16 v14, v46, v13
v_dot2c_f32_bf16 v15, v47, v13
s_waitcnt lgkmcnt(6)
v_dot2c_f32_bf16 v14, v48, v13
v_dot2c_f32_bf16 v15, v49, v13
v_dot2c_f32_bf16 v14, v50, v13
v_dot2c_f32_bf16 v15, v51, v13
s_waitcnt lgkmcnt(4)
v_dot2c_f32_bf16 v14, v52, v13
v_dot2c_f32_bf16 v15, v53, v13
v_dot2c_f32_bf16 v14, v54, v13
v_dot2c_f32_bf16 v15, v55, v13
s_waitcnt lgkmcnt(2)
v_dot2c_f32_bf16 v14, v56, v13
v_dot2c_f32_bf16 v15, v57, v13
v_dot2c_f32_bf16 v14, v58, v13
v_dot2c_f32_bf16 v15, v59, v13
s_waitcnt lgkmcnt(0)
v_dot2c_f32_bf16 v14, v60, v13
v_dot2c_f32_bf16 v15, v61, v13
v_dot2c_f32_bf16 v14, v62, v13
v_dot2c_f32_bf16 v15, v63, v13
s_waitcnt vmcnt(0)
s_barrier
ds_read_b64_tr_b16 v[64:65], v10 offset:49152
ds_read_b64_tr_b16 v[66:67], v10 offset:51200
ds_read_b64_tr_b16 v[68:69], v10 offset:53248
ds_read_b64_tr_b16 v[70:71], v10 offset:55296
ds_read_b64_tr_b16 v[72:73], v10 offset:57344
ds_read_b64_tr_b16 v[74:75], v10 offset:59392
ds_read_b64_tr_b16 v[76:77], v10 offset:61440
ds_read_b64_tr_b16 v[78:79], v10 offset:63488
ds_read_b64_tr_b16 v[80:81], v11 offset:0
ds_read_b64_tr_b16 v[82:83], v11 offset:512
ds_read_b64_tr_b16 v[84:85], v11 offset:4096
ds_read_b64_tr_b16 v[86:87], v11 offset:4608
s_waitcnt lgkmcnt(10)
v_dot2c_f32_bf16 v14, v64, v13
v_dot2c_f32_bf16 v15, v65, v13
v_dot2c_f32_bf16 v14, v66, v13
v_dot2c_f32_bf16 v15, v67, v13
s_waitcnt lgkmcnt(8)
v_dot2c_f32_bf16 v14, v68, v13
v_dot2c_f32_bf16 v15, v69, v13
v_dot2c_f32_bf16 v14, v70, v13
v_dot2c_f32_bf16 v15, v71, v13
s_waitcnt lgkmcnt(6)
v_dot2c_f32_bf16 v14, v72, v13
v_dot2c_f32_bf16 v15, v73, v13
v_dot2c_f32_bf16 v14, v74, v13
v_dot2c_f32_bf16 v15, v75, v13
s_waitcnt lgkmcnt(4)
v_dot2c_f32_bf16 v14, v76, v13
v_dot2c_f32_bf16 v15, v77, v13
v_dot2c_f32_bf16 v14, v78, v13
v_dot2c_f32_bf16 v15, v79, v13
s_waitcnt lgkmcnt(2)
v_dot2c_f32_bf16 v14, v80, v13
v_dot2c_f32_bf16 v15, v81, v13
v_dot2c_f32_bf16 v14, v82, v13
v_dot2c_f32_bf16 v15, v83, v13
s_waitcnt lgkmcnt(0)
v_dot2c_f32_bf16 v14, v84, v13
v_dot2c_f32_bf16 v15, v85, v13
v_dot2c_f32_bf16 v14, v86, v13
v_dot2c_f32_bf16 v15, v87, v13
s_nop 2
v_add_f32 v14, v14, v15
v_mov_b32 v15, v14
s_nop 1
v_permlane16_swap_b32 v14, v15
s_nop 0
v_add_f32 v14, v14, v15
v_mov_b32 v15, v14
s_nop 1
v_permlane32_swap_b32 v14, v15
s_nop 0
v_add_f32 v14, v14, v15
v_mul_f32 v14, 0xbae38e39, v14
v_mov_b32 v12, 0xffff0000
v_mov_b32 v100, v14
v_mov_b32 v101, v14
v_lshlrev_b32 v90, 16, v16
v_and_b32 v91, v12, v16
v_pk_add_f32 v[90:91], v[90:91], v[100:101]
v_cvt_pk_bf16_f32 v16, v90, v91
v_pk_add_f32 v[90:91], v[90:91], v[14:15] op_sel_hi:[1,0]
v_lshlrev_b32 v102, 16, v16
v_and_b32 v103, v12, v16
v_pk_add_f32 v[100:101], v[90:91], v[102:103] neg_lo:[0,1] neg_hi:[0,1]
v_lshlrev_b32 v92, 16, v17
v_and_b32 v93, v12, v17
v_pk_add_f32 v[92:93], v[92:93], v[100:101]
v_cvt_pk_bf16_f32 v17, v92, v93
v_pk_add_f32 v[92:93], v[92:93], v[14:15] op_sel_hi:[1,0]
v_lshlrev_b32 v102, 16, v17
v_and_b32 v103, v12, v17
v_pk_add_f32 v[100:101], v[92:93], v[102:103] neg_lo:[0,1] neg_hi:[0,1]
v_lshlrev_b32 v90, 16, v18
v_and_b32 v91, v12, v18
v_pk_add_f32 v[90:91], v[90:91], v[100:101]
v_cvt_pk_bf16_f32 v18, v90, v91
v_pk_add_f32 v[90:91], v[90:91], v[14:15] op_sel_hi:[1,0]
v_lshlrev_b32 v102, 16, v18
v_and_b32 v103, v12, v18
v_pk_add_f32 v[100:101], v[90:91], v[102:103] neg_lo:[0,1] neg_hi:[0,1]
v_lshlrev_b32 v92, 16, v19
v_and_b32 v93, v12, v19
v_pk_add_f32 v[92:93], v[92:93], v[100:101]
v_cvt_pk_bf16_f32 v19, v92, v93
v_pk_add_f32 v[92:93], v[92:93], v[14:15] op_sel_hi:[1,0]
v_lshlrev_b32 v102, 16, v19
v_and_b32 v103, v12, v19
v_pk_add_f32 v[100:101], v[92:93], v[102:103] neg_lo:[0,1] neg_hi:[0,1]
global_store_dwordx4 v9, v[16:19], s[22:23] sc1
v_add_u32 v9, 0x400, v9
v_lshlrev_b32 v90, 16, v20
v_and_b32 v91, v12, v20
v_pk_add_f32 v[90:91], v[90:91], v[100:101]
v_cvt_pk_bf16_f32 v20, v90, v91
v_pk_add_f32 v[90:91], v[90:91], v[14:15] op_sel_hi:[1,0]
v_lshlrev_b32 v102, 16, v20
v_and_b32 v103, v12, v20
v_pk_add_f32 v[100:101], v[90:91], v[102:103] neg_lo:[0,1] neg_hi:[0,1]
v_lshlrev_b32 v92, 16, v21
v_and_b32 v93, v12, v21
v_pk_add_f32 v[92:93], v[92:93], v[100:101]
v_cvt_pk_bf16_f32 v21, v92, v93
v_pk_add_f32 v[92:93], v[92:93], v[14:15] op_sel_hi:[1,0]
v_lshlrev_b32 v102, 16, v21
v_and_b32 v103, v12, v21
v_pk_add_f32 v[100:101], v[92:93], v[102:103] neg_lo:[0,1] neg_hi:[0,1]
v_lshlrev_b32 v90, 16, v22
v_and_b32 v91, v12, v22
v_pk_add_f32 v[90:91], v[90:91], v[100:101]
v_cvt_pk_bf16_f32 v22, v90, v91
v_pk_add_f32 v[90:91], v[90:91], v[14:15] op_sel_hi:[1,0]
v_lshlrev_b32 v102, 16, v22
v_and_b32 v103, v12, v22
v_pk_add_f32 v[100:101], v[90:91], v[102:103] neg_lo:[0,1] neg_hi:[0,1]
v_lshlrev_b32 v92, 16, v23
v_and_b32 v93, v12, v23
v_pk_add_f32 v[92:93], v[92:93], v[100:101]
v_cvt_pk_bf16_f32 v23, v92, v93
v_pk_add_f32 v[92:93], v[92:93], v[14:15] op_sel_hi:[1,0]
v_lshlrev_b32 v102, 16, v23
v_and_b32 v103, v12, v23
v_pk_add_f32 v[100:101], v[92:93], v[102:103] neg_lo:[0,1] neg_hi:[0,1]
global_store_dwordx4 v9, v[20:23], s[22:23] sc1
v_add_u32 v9, 0x400, v9
v_lshlrev_b32 v90, 16, v24
v_and_b32 v91, v12, v24
v_pk_add_f32 v[90:91], v[90:91], v[100:101]
v_cvt_pk_bf16_f32 v24, v90, v91
v_pk_add_f32 v[90:91], v[90:91], v[14:15] op_sel_hi:[1,0]
v_lshlrev_b32 v102, 16, v24
v_and_b32 v103, v12, v24
v_pk_add_f32 v[100:101], v[90:91], v[102:103] neg_lo:[0,1] neg_hi:[0,1]
v_lshlrev_b32 v92, 16, v25
v_and_b32 v93, v12, v25
v_pk_add_f32 v[92:93], v[92:93], v[100:101]
v_cvt_pk_bf16_f32 v25, v92, v93
v_pk_add_f32 v[92:93], v[92:93], v[14:15] op_sel_hi:[1,0]
v_lshlrev_b32 v102, 16, v25
v_and_b32 v103, v12, v25
v_pk_add_f32 v[100:101], v[92:93], v[102:103] neg_lo:[0,1] neg_hi:[0,1]
v_lshlrev_b32 v90, 16, v26
v_and_b32 v91, v12, v26
v_pk_add_f32 v[90:91], v[90:91], v[100:101]
v_cvt_pk_bf16_f32 v26, v90, v91
v_pk_add_f32 v[90:91], v[90:91], v[14:15] op_sel_hi:[1,0]
v_lshlrev_b32 v102, 16, v26
v_and_b32 v103, v12, v26
v_pk_add_f32 v[100:101], v[90:91], v[102:103] neg_lo:[0,1] neg_hi:[0,1]
v_lshlrev_b32 v92, 16, v27
v_and_b32 v93, v12, v27
v_pk_add_f32 v[92:93], v[92:93], v[100:101]
v_cvt_pk_bf16_f32 v27, v92, v93
v_pk_add_f32 v[92:93], v[92:93], v[14:15] op_sel_hi:[1,0]
v_lshlrev_b32 v102, 16, v27
v_and_b32 v103, v12, v27
v_pk_add_f32 v[100:101], v[92:93], v[102:103] neg_lo:[0,1] neg_hi:[0,1]
global_store_dwordx4 v9, v[24:27], s[22:23] sc1
v_add_u32 v9, 0x400, v9
v_lshlrev_b32 v90, 16, v28
v_and_b32 v91, v12, v28
v_pk_add_f32 v[90:91], v[90:91], v[100:101]
v_cvt_pk_bf16_f32 v28, v90, v91
v_pk_add_f32 v[90:91], v[90:91], v[14:15] op_sel_hi:[1,0]
v_lshlrev_b32 v102, 16, v28
v_and_b32 v103, v12, v28
v_pk_add_f32 v[100:101], v[90:91], v[102:103] neg_lo:[0,1] neg_hi:[0,1]
v_lshlrev_b32 v92, 16, v29
v_and_b32 v93, v12, v29
v_pk_add_f32 v[92:93], v[92:93], v[100:101]
v_cvt_pk_bf16_f32 v29, v92, v93
v_pk_add_f32 v[92:93], v[92:93], v[14:15] op_sel_hi:[1,0]
v_lshlrev_b32 v102, 16, v29
v_and_b32 v103, v12, v29
v_pk_add_f32 v[100:101], v[92:93], v[102:103] neg_lo:[0,1] neg_hi:[0,1]
v_lshlrev_b32 v90, 16, v30
v_and_b32 v91, v12, v30
v_pk_add_f32 v[90:91], v[90:91], v[100:101]
v_cvt_pk_bf16_f32 v30, v90, v91
v_pk_add_f32 v[90:91], v[90:91], v[14:15] op_sel_hi:[1,0]
v_lshlrev_b32 v102, 16, v30
v_and_b32 v103, v12, v30
v_pk_add_f32 v[100:101], v[90:91], v[102:103] neg_lo:[0,1] neg_hi:[0,1]
v_lshlrev_b32 v92, 16, v31
v_and_b32 v93, v12, v31
v_pk_add_f32 v[92:93], v[92:93], v[100:101]
v_cvt_pk_bf16_f32 v31, v92, v93
v_pk_add_f32 v[92:93], v[92:93], v[14:15] op_sel_hi:[1,0]
v_lshlrev_b32 v102, 16, v31
v_and_b32 v103, v12, v31
v_pk_add_f32 v[100:101], v[92:93], v[102:103] neg_lo:[0,1] neg_hi:[0,1]
global_store_dwordx4 v9, v[28:31], s[22:23] sc1
v_add_u32 v9, 0x400, v9
v_lshlrev_b32 v90, 16, v32
v_and_b32 v91, v12, v32
v_pk_add_f32 v[90:91], v[90:91], v[100:101]
v_cvt_pk_bf16_f32 v32, v90, v91
v_pk_add_f32 v[90:91], v[90:91], v[14:15] op_sel_hi:[1,0]
v_lshlrev_b32 v102, 16, v32
v_and_b32 v103, v12, v32
v_pk_add_f32 v[100:101], v[90:91], v[102:103] neg_lo:[0,1] neg_hi:[0,1]
v_lshlrev_b32 v92, 16, v33
v_and_b32 v93, v12, v33
v_pk_add_f32 v[92:93], v[92:93], v[100:101]
v_cvt_pk_bf16_f32 v33, v92, v93
v_pk_add_f32 v[92:93], v[92:93], v[14:15] op_sel_hi:[1,0]
v_lshlrev_b32 v102, 16, v33
v_and_b32 v103, v12, v33
v_pk_add_f32 v[100:101], v[92:93], v[102:103] neg_lo:[0,1] neg_hi:[0,1]
v_lshlrev_b32 v90, 16, v34
v_and_b32 v91, v12, v34
v_pk_add_f32 v[90:91], v[90:91], v[100:101]
v_cvt_pk_bf16_f32 v34, v90, v91
v_pk_add_f32 v[90:91], v[90:91], v[14:15] op_sel_hi:[1,0]
v_lshlrev_b32 v102, 16, v34
v_and_b32 v103, v12, v34
v_pk_add_f32 v[100:101], v[90:91], v[102:103] neg_lo:[0,1] neg_hi:[0,1]
v_lshlrev_b32 v92, 16, v35
v_and_b32 v93, v12, v35
v_pk_add_f32 v[92:93], v[92:93], v[100:101]
v_cvt_pk_bf16_f32 v35, v92, v93
v_pk_add_f32 v[92:93], v[92:93], v[14:15] op_sel_hi:[1,0]
v_lshlrev_b32 v102, 16, v35
v_and_b32 v103, v12, v35
v_pk_add_f32 v[100:101], v[92:93], v[102:103] neg_lo:[0,1] neg_hi:[0,1]
global_store_dwordx4 v9, v[32:35], s[22:23] sc1
v_add_u32 v9, 0x400, v9
v_lshlrev_b32 v90, 16, v36
v_and_b32 v91, v12, v36
v_pk_add_f32 v[90:91], v[90:91], v[100:101]
v_cvt_pk_bf16_f32 v36, v90, v91
v_pk_add_f32 v[90:91], v[90:91], v[14:15] op_sel_hi:[1,0]
v_lshlrev_b32 v102, 16, v36
v_and_b32 v103, v12, v36
v_pk_add_f32 v[100:101], v[90:91], v[102:103] neg_lo:[0,1] neg_hi:[0,1]
v_lshlrev_b32 v92, 16, v37
v_and_b32 v93, v12, v37
v_pk_add_f32 v[92:93], v[92:93], v[100:101]
v_cvt_pk_bf16_f32 v37, v92, v93
v_pk_add_f32 v[92:93], v[92:93], v[14:15] op_sel_hi:[1,0]
v_lshlrev_b32 v102, 16, v37
v_and_b32 v103, v12, v37
v_pk_add_f32 v[100:101], v[92:93], v[102:103] neg_lo:[0,1] neg_hi:[0,1]
v_lshlrev_b32 v90, 16, v38
v_and_b32 v91, v12, v38
v_pk_add_f32 v[90:91], v[90:91], v[100:101]
v_cvt_pk_bf16_f32 v38, v90, v91
v_pk_add_f32 v[90:91], v[90:91], v[14:15] op_sel_hi:[1,0]
v_lshlrev_b32 v102, 16, v38
v_and_b32 v103, v12, v38
v_pk_add_f32 v[100:101], v[90:91], v[102:103] neg_lo:[0,1] neg_hi:[0,1]
v_lshlrev_b32 v92, 16, v39
v_and_b32 v93, v12, v39
v_pk_add_f32 v[92:93], v[92:93], v[100:101]
v_cvt_pk_bf16_f32 v39, v92, v93
v_pk_add_f32 v[92:93], v[92:93], v[14:15] op_sel_hi:[1,0]
v_lshlrev_b32 v102, 16, v39
v_and_b32 v103, v12, v39
v_pk_add_f32 v[100:101], v[92:93], v[102:103] neg_lo:[0,1] neg_hi:[0,1]
global_store_dwordx4 v9, v[36:39], s[22:23] sc1
v_add_u32 v9, 0x400, v9
v_lshlrev_b32 v90, 16, v40
v_and_b32 v91, v12, v40
v_pk_add_f32 v[90:91], v[90:91], v[100:101]
v_cvt_pk_bf16_f32 v40, v90, v91
v_pk_add_f32 v[90:91], v[90:91], v[14:15] op_sel_hi:[1,0]
v_lshlrev_b32 v102, 16, v40
v_and_b32 v103, v12, v40
v_pk_add_f32 v[100:101], v[90:91], v[102:103] neg_lo:[0,1] neg_hi:[0,1]
v_lshlrev_b32 v92, 16, v41
v_and_b32 v93, v12, v41
v_pk_add_f32 v[92:93], v[92:93], v[100:101]
v_cvt_pk_bf16_f32 v41, v92, v93
v_pk_add_f32 v[92:93], v[92:93], v[14:15] op_sel_hi:[1,0]
v_lshlrev_b32 v102, 16, v41
v_and_b32 v103, v12, v41
v_pk_add_f32 v[100:101], v[92:93], v[102:103] neg_lo:[0,1] neg_hi:[0,1]
v_lshlrev_b32 v90, 16, v42
v_and_b32 v91, v12, v42
v_pk_add_f32 v[90:91], v[90:91], v[100:101]
v_cvt_pk_bf16_f32 v42, v90, v91
v_pk_add_f32 v[90:91], v[90:91], v[14:15] op_sel_hi:[1,0]
v_lshlrev_b32 v102, 16, v42
v_and_b32 v103, v12, v42
v_pk_add_f32 v[100:101], v[90:91], v[102:103] neg_lo:[0,1] neg_hi:[0,1]
v_lshlrev_b32 v92, 16, v43
v_and_b32 v93, v12, v43
v_pk_add_f32 v[92:93], v[92:93], v[100:101]
v_cvt_pk_bf16_f32 v43, v92, v93
v_pk_add_f32 v[92:93], v[92:93], v[14:15] op_sel_hi:[1,0]
v_lshlrev_b32 v102, 16, v43
v_and_b32 v103, v12, v43
v_pk_add_f32 v[100:101], v[92:93], v[102:103] neg_lo:[0,1] neg_hi:[0,1]
global_store_dwordx4 v9, v[40:43], s[22:23] sc1
v_add_u32 v9, 0x400, v9
v_lshlrev_b32 v90, 16, v44
v_and_b32 v91, v12, v44
v_pk_add_f32 v[90:91], v[90:91], v[100:101]
v_cvt_pk_bf16_f32 v44, v90, v91
v_pk_add_f32 v[90:91], v[90:91], v[14:15] op_sel_hi:[1,0]
v_lshlrev_b32 v102, 16, v44
v_and_b32 v103, v12, v44
v_pk_add_f32 v[100:101], v[90:91], v[102:103] neg_lo:[0,1] neg_hi:[0,1]
v_lshlrev_b32 v92, 16, v45
v_and_b32 v93, v12, v45
v_pk_add_f32 v[92:93], v[92:93], v[100:101]
v_cvt_pk_bf16_f32 v45, v92, v93
v_pk_add_f32 v[92:93], v[92:93], v[14:15] op_sel_hi:[1,0]
v_lshlrev_b32 v102, 16, v45
v_and_b32 v103, v12, v45
v_pk_add_f32 v[100:101], v[92:93], v[102:103] neg_lo:[0,1] neg_hi:[0,1]
v_lshlrev_b32 v90, 16, v46
v_and_b32 v91, v12, v46
v_pk_add_f32 v[90:91], v[90:91], v[100:101]
v_cvt_pk_bf16_f32 v46, v90, v91
v_pk_add_f32 v[90:91], v[90:91], v[14:15] op_sel_hi:[1,0]
v_lshlrev_b32 v102, 16, v46
v_and_b32 v103, v12, v46
v_pk_add_f32 v[100:101], v[90:91], v[102:103] neg_lo:[0,1] neg_hi:[0,1]
v_lshlrev_b32 v92, 16, v47
v_and_b32 v93, v12, v47
v_pk_add_f32 v[92:93], v[92:93], v[100:101]
v_cvt_pk_bf16_f32 v47, v92, v93
v_pk_add_f32 v[92:93], v[92:93], v[14:15] op_sel_hi:[1,0]
v_lshlrev_b32 v102, 16, v47
v_and_b32 v103, v12, v47
v_pk_add_f32 v[100:101], v[92:93], v[102:103] neg_lo:[0,1] neg_hi:[0,1]
global_store_dwordx4 v9, v[44:47], s[22:23] sc1
v_add_u32 v9, 0x400, v9
v_lshlrev_b32 v90, 16, v48
v_and_b32 v91, v12, v48
v_pk_add_f32 v[90:91], v[90:91], v[100:101]
v_cvt_pk_bf16_f32 v48, v90, v91
v_pk_add_f32 v[90:91], v[90:91], v[14:15] op_sel_hi:[1,0]
v_lshlrev_b32 v102, 16, v48
v_and_b32 v103, v12, v48
v_pk_add_f32 v[100:101], v[90:91], v[102:103] neg_lo:[0,1] neg_hi:[0,1]
v_lshlrev_b32 v92, 16, v49
v_and_b32 v93, v12, v49
v_pk_add_f32 v[92:93], v[92:93], v[100:101]
v_cvt_pk_bf16_f32 v49, v92, v93
v_pk_add_f32 v[92:93], v[92:93], v[14:15] op_sel_hi:[1,0]
v_lshlrev_b32 v102, 16, v49
v_and_b32 v103, v12, v49
v_pk_add_f32 v[100:101], v[92:93], v[102:103] neg_lo:[0,1] neg_hi:[0,1]
v_lshlrev_b32 v90, 16, v50
v_and_b32 v91, v12, v50
v_pk_add_f32 v[90:91], v[90:91], v[100:101]
v_cvt_pk_bf16_f32 v50, v90, v91
v_pk_add_f32 v[90:91], v[90:91], v[14:15] op_sel_hi:[1,0]
v_lshlrev_b32 v102, 16, v50
v_and_b32 v103, v12, v50
v_pk_add_f32 v[100:101], v[90:91], v[102:103] neg_lo:[0,1] neg_hi:[0,1]
v_lshlrev_b32 v92, 16, v51
v_and_b32 v93, v12, v51
v_pk_add_f32 v[92:93], v[92:93], v[100:101]
v_cvt_pk_bf16_f32 v51, v92, v93
v_pk_add_f32 v[92:93], v[92:93], v[14:15] op_sel_hi:[1,0]
v_lshlrev_b32 v102, 16, v51
v_and_b32 v103, v12, v51
v_pk_add_f32 v[100:101], v[92:93], v[102:103] neg_lo:[0,1] neg_hi:[0,1]
global_store_dwordx4 v9, v[48:51], s[22:23] sc1
v_add_u32 v9, 0x400, v9
v_lshlrev_b32 v90, 16, v52
v_and_b32 v91, v12, v52
v_pk_add_f32 v[90:91], v[90:91], v[100:101]
v_cvt_pk_bf16_f32 v52, v90, v91
v_pk_add_f32 v[90:91], v[90:91], v[14:15] op_sel_hi:[1,0]
v_lshlrev_b32 v102, 16, v52
v_and_b32 v103, v12, v52
v_pk_add_f32 v[100:101], v[90:91], v[102:103] neg_lo:[0,1] neg_hi:[0,1]
v_lshlrev_b32 v92, 16, v53
v_and_b32 v93, v12, v53
v_pk_add_f32 v[92:93], v[92:93], v[100:101]
v_cvt_pk_bf16_f32 v53, v92, v93
v_pk_add_f32 v[92:93], v[92:93], v[14:15] op_sel_hi:[1,0]
v_lshlrev_b32 v102, 16, v53
v_and_b32 v103, v12, v53
v_pk_add_f32 v[100:101], v[92:93], v[102:103] neg_lo:[0,1] neg_hi:[0,1]
v_lshlrev_b32 v90, 16, v54
v_and_b32 v91, v12, v54
v_pk_add_f32 v[90:91], v[90:91], v[100:101]
v_cvt_pk_bf16_f32 v54, v90, v91
v_pk_add_f32 v[90:91], v[90:91], v[14:15] op_sel_hi:[1,0]
v_lshlrev_b32 v102, 16, v54
v_and_b32 v103, v12, v54
v_pk_add_f32 v[100:101], v[90:91], v[102:103] neg_lo:[0,1] neg_hi:[0,1]
v_lshlrev_b32 v92, 16, v55
v_and_b32 v93, v12, v55
v_pk_add_f32 v[92:93], v[92:93], v[100:101]
v_cvt_pk_bf16_f32 v55, v92, v93
v_pk_add_f32 v[92:93], v[92:93], v[14:15] op_sel_hi:[1,0]
v_lshlrev_b32 v102, 16, v55
v_and_b32 v103, v12, v55
v_pk_add_f32 v[100:101], v[92:93], v[102:103] neg_lo:[0,1] neg_hi:[0,1]
global_store_dwordx4 v9, v[52:55], s[22:23] sc1
v_add_u32 v9, 0x400, v9
v_lshlrev_b32 v90, 16, v56
v_and_b32 v91, v12, v56
v_pk_add_f32 v[90:91], v[90:91], v[100:101]
v_cvt_pk_bf16_f32 v56, v90, v91
v_pk_add_f32 v[90:91], v[90:91], v[14:15] op_sel_hi:[1,0]
v_lshlrev_b32 v102, 16, v56
v_and_b32 v103, v12, v56
v_pk_add_f32 v[100:101], v[90:91], v[102:103] neg_lo:[0,1] neg_hi:[0,1]
v_lshlrev_b32 v92, 16, v57
v_and_b32 v93, v12, v57
v_pk_add_f32 v[92:93], v[92:93], v[100:101]
v_cvt_pk_bf16_f32 v57, v92, v93
v_pk_add_f32 v[92:93], v[92:93], v[14:15] op_sel_hi:[1,0]
v_lshlrev_b32 v102, 16, v57
v_and_b32 v103, v12, v57
v_pk_add_f32 v[100:101], v[92:93], v[102:103] neg_lo:[0,1] neg_hi:[0,1]
v_lshlrev_b32 v90, 16, v58
v_and_b32 v91, v12, v58
v_pk_add_f32 v[90:91], v[90:91], v[100:101]
v_cvt_pk_bf16_f32 v58, v90, v91
v_pk_add_f32 v[90:91], v[90:91], v[14:15] op_sel_hi:[1,0]
v_lshlrev_b32 v102, 16, v58
v_and_b32 v103, v12, v58
v_pk_add_f32 v[100:101], v[90:91], v[102:103] neg_lo:[0,1] neg_hi:[0,1]
v_lshlrev_b32 v92, 16, v59
v_and_b32 v93, v12, v59
v_pk_add_f32 v[92:93], v[92:93], v[100:101]
v_cvt_pk_bf16_f32 v59, v92, v93
v_pk_add_f32 v[92:93], v[92:93], v[14:15] op_sel_hi:[1,0]
v_lshlrev_b32 v102, 16, v59
v_and_b32 v103, v12, v59
v_pk_add_f32 v[100:101], v[92:93], v[102:103] neg_lo:[0,1] neg_hi:[0,1]
global_store_dwordx4 v9, v[56:59], s[22:23] sc1
v_add_u32 v9, 0x400, v9
v_lshlrev_b32 v90, 16, v60
v_and_b32 v91, v12, v60
v_pk_add_f32 v[90:91], v[90:91], v[100:101]
v_cvt_pk_bf16_f32 v60, v90, v91
v_pk_add_f32 v[90:91], v[90:91], v[14:15] op_sel_hi:[1,0]
v_lshlrev_b32 v102, 16, v60
v_and_b32 v103, v12, v60
v_pk_add_f32 v[100:101], v[90:91], v[102:103] neg_lo:[0,1] neg_hi:[0,1]
v_lshlrev_b32 v92, 16, v61
v_and_b32 v93, v12, v61
v_pk_add_f32 v[92:93], v[92:93], v[100:101]
v_cvt_pk_bf16_f32 v61, v92, v93
v_pk_add_f32 v[92:93], v[92:93], v[14:15] op_sel_hi:[1,0]
v_lshlrev_b32 v102, 16, v61
v_and_b32 v103, v12, v61
v_pk_add_f32 v[100:101], v[92:93], v[102:103] neg_lo:[0,1] neg_hi:[0,1]
v_lshlrev_b32 v90, 16, v62
v_and_b32 v91, v12, v62
v_pk_add_f32 v[90:91], v[90:91], v[100:101]
v_cvt_pk_bf16_f32 v62, v90, v91
v_pk_add_f32 v[90:91], v[90:91], v[14:15] op_sel_hi:[1,0]
v_lshlrev_b32 v102, 16, v62
v_and_b32 v103, v12, v62
v_pk_add_f32 v[100:101], v[90:91], v[102:103] neg_lo:[0,1] neg_hi:[0,1]
v_lshlrev_b32 v92, 16, v63
v_and_b32 v93, v12, v63
v_pk_add_f32 v[92:93], v[92:93], v[100:101]
v_cvt_pk_bf16_f32 v63, v92, v93
v_pk_add_f32 v[92:93], v[92:93], v[14:15] op_sel_hi:[1,0]
v_lshlrev_b32 v102, 16, v63
v_and_b32 v103, v12, v63
v_pk_add_f32 v[100:101], v[92:93], v[102:103] neg_lo:[0,1] neg_hi:[0,1]
global_store_dwordx4 v9, v[60:63], s[22:23] sc1
v_add_u32 v9, 0x400, v9
v_lshlrev_b32 v90, 16, v64
v_and_b32 v91, v12, v64
v_pk_add_f32 v[90:91], v[90:91], v[100:101]
v_cvt_pk_bf16_f32 v64, v90, v91
v_pk_add_f32 v[90:91], v[90:91], v[14:15] op_sel_hi:[1,0]
v_lshlrev_b32 v102, 16, v64
v_and_b32 v103, v12, v64
v_pk_add_f32 v[100:101], v[90:91], v[102:103] neg_lo:[0,1] neg_hi:[0,1]
v_lshlrev_b32 v92, 16, v65
v_and_b32 v93, v12, v65
v_pk_add_f32 v[92:93], v[92:93], v[100:101]
v_cvt_pk_bf16_f32 v65, v92, v93
v_pk_add_f32 v[92:93], v[92:93], v[14:15] op_sel_hi:[1,0]
v_lshlrev_b32 v102, 16, v65
v_and_b32 v103, v12, v65
v_pk_add_f32 v[100:101], v[92:93], v[102:103] neg_lo:[0,1] neg_hi:[0,1]
v_lshlrev_b32 v90, 16, v66
v_and_b32 v91, v12, v66
v_pk_add_f32 v[90:91], v[90:91], v[100:101]
v_cvt_pk_bf16_f32 v66, v90, v91
v_pk_add_f32 v[90:91], v[90:91], v[14:15] op_sel_hi:[1,0]
v_lshlrev_b32 v102, 16, v66
v_and_b32 v103, v12, v66
v_pk_add_f32 v[100:101], v[90:91], v[102:103] neg_lo:[0,1] neg_hi:[0,1]
v_lshlrev_b32 v92, 16, v67
v_and_b32 v93, v12, v67
v_pk_add_f32 v[92:93], v[92:93], v[100:101]
v_cvt_pk_bf16_f32 v67, v92, v93
v_pk_add_f32 v[92:93], v[92:93], v[14:15] op_sel_hi:[1,0]
v_lshlrev_b32 v102, 16, v67
v_and_b32 v103, v12, v67
v_pk_add_f32 v[100:101], v[92:93], v[102:103] neg_lo:[0,1] neg_hi:[0,1]
global_store_dwordx4 v9, v[64:67], s[22:23] sc1
v_add_u32 v9, 0x400, v9
v_lshlrev_b32 v90, 16, v68
v_and_b32 v91, v12, v68
v_pk_add_f32 v[90:91], v[90:91], v[100:101]
v_cvt_pk_bf16_f32 v68, v90, v91
v_pk_add_f32 v[90:91], v[90:91], v[14:15] op_sel_hi:[1,0]
v_lshlrev_b32 v102, 16, v68
v_and_b32 v103, v12, v68
v_pk_add_f32 v[100:101], v[90:91], v[102:103] neg_lo:[0,1] neg_hi:[0,1]
v_lshlrev_b32 v92, 16, v69
v_and_b32 v93, v12, v69
v_pk_add_f32 v[92:93], v[92:93], v[100:101]
v_cvt_pk_bf16_f32 v69, v92, v93
v_pk_add_f32 v[92:93], v[92:93], v[14:15] op_sel_hi:[1,0]
v_lshlrev_b32 v102, 16, v69
v_and_b32 v103, v12, v69
v_pk_add_f32 v[100:101], v[92:93], v[102:103] neg_lo:[0,1] neg_hi:[0,1]
v_lshlrev_b32 v90, 16, v70
v_and_b32 v91, v12, v70
v_pk_add_f32 v[90:91], v[90:91], v[100:101]
v_cvt_pk_bf16_f32 v70, v90, v91
v_pk_add_f32 v[90:91], v[90:91], v[14:15] op_sel_hi:[1,0]
v_lshlrev_b32 v102, 16, v70
v_and_b32 v103, v12, v70
v_pk_add_f32 v[100:101], v[90:91], v[102:103] neg_lo:[0,1] neg_hi:[0,1]
v_lshlrev_b32 v92, 16, v71
v_and_b32 v93, v12, v71
v_pk_add_f32 v[92:93], v[92:93], v[100:101]
v_cvt_pk_bf16_f32 v71, v92, v93
v_pk_add_f32 v[92:93], v[92:93], v[14:15] op_sel_hi:[1,0]
v_lshlrev_b32 v102, 16, v71
v_and_b32 v103, v12, v71
v_pk_add_f32 v[100:101], v[92:93], v[102:103] neg_lo:[0,1] neg_hi:[0,1]
global_store_dwordx4 v9, v[68:71], s[22:23] sc1
v_add_u32 v9, 0x400, v9
v_lshlrev_b32 v90, 16, v72
v_and_b32 v91, v12, v72
v_pk_add_f32 v[90:91], v[90:91], v[100:101]
v_cvt_pk_bf16_f32 v72, v90, v91
v_pk_add_f32 v[90:91], v[90:91], v[14:15] op_sel_hi:[1,0]
v_lshlrev_b32 v102, 16, v72
v_and_b32 v103, v12, v72
v_pk_add_f32 v[100:101], v[90:91], v[102:103] neg_lo:[0,1] neg_hi:[0,1]
v_lshlrev_b32 v92, 16, v73
v_and_b32 v93, v12, v73
v_pk_add_f32 v[92:93], v[92:93], v[100:101]
v_cvt_pk_bf16_f32 v73, v92, v93
v_pk_add_f32 v[92:93], v[92:93], v[14:15] op_sel_hi:[1,0]
v_lshlrev_b32 v102, 16, v73
v_and_b32 v103, v12, v73
v_pk_add_f32 v[100:101], v[92:93], v[102:103] neg_lo:[0,1] neg_hi:[0,1]
v_lshlrev_b32 v90, 16, v74
v_and_b32 v91, v12, v74
v_pk_add_f32 v[90:91], v[90:91], v[100:101]
v_cvt_pk_bf16_f32 v74, v90, v91
v_pk_add_f32 v[90:91], v[90:91], v[14:15] op_sel_hi:[1,0]
v_lshlrev_b32 v102, 16, v74
v_and_b32 v103, v12, v74
v_pk_add_f32 v[100:101], v[90:91], v[102:103] neg_lo:[0,1] neg_hi:[0,1]
v_lshlrev_b32 v92, 16, v75
v_and_b32 v93, v12, v75
v_pk_add_f32 v[92:93], v[92:93], v[100:101]
v_cvt_pk_bf16_f32 v75, v92, v93
v_pk_add_f32 v[92:93], v[92:93], v[14:15] op_sel_hi:[1,0]
v_lshlrev_b32 v102, 16, v75
v_and_b32 v103, v12, v75
v_pk_add_f32 v[100:101], v[92:93], v[102:103] neg_lo:[0,1] neg_hi:[0,1]
global_store_dwordx4 v9, v[72:75], s[22:23] sc1
v_add_u32 v9, 0x400, v9
v_lshlrev_b32 v90, 16, v76
v_and_b32 v91, v12, v76
v_pk_add_f32 v[90:91], v[90:91], v[100:101]
v_cvt_pk_bf16_f32 v76, v90, v91
v_pk_add_f32 v[90:91], v[90:91], v[14:15] op_sel_hi:[1,0]
v_lshlrev_b32 v102, 16, v76
v_and_b32 v103, v12, v76
v_pk_add_f32 v[100:101], v[90:91], v[102:103] neg_lo:[0,1] neg_hi:[0,1]
v_lshlrev_b32 v92, 16, v77
v_and_b32 v93, v12, v77
v_pk_add_f32 v[92:93], v[92:93], v[100:101]
v_cvt_pk_bf16_f32 v77, v92, v93
v_pk_add_f32 v[92:93], v[92:93], v[14:15] op_sel_hi:[1,0]
v_lshlrev_b32 v102, 16, v77
v_and_b32 v103, v12, v77
v_pk_add_f32 v[100:101], v[92:93], v[102:103] neg_lo:[0,1] neg_hi:[0,1]
v_lshlrev_b32 v90, 16, v78
v_and_b32 v91, v12, v78
v_pk_add_f32 v[90:91], v[90:91], v[100:101]
v_cvt_pk_bf16_f32 v78, v90, v91
v_pk_add_f32 v[90:91], v[90:91], v[14:15] op_sel_hi:[1,0]
v_lshlrev_b32 v102, 16, v78
v_and_b32 v103, v12, v78
v_pk_add_f32 v[100:101], v[90:91], v[102:103] neg_lo:[0,1] neg_hi:[0,1]
v_lshlrev_b32 v92, 16, v79
v_and_b32 v93, v12, v79
v_pk_add_f32 v[92:93], v[92:93], v[100:101]
v_cvt_pk_bf16_f32 v79, v92, v93
v_pk_add_f32 v[92:93], v[92:93], v[14:15] op_sel_hi:[1,0]
v_lshlrev_b32 v102, 16, v79
v_and_b32 v103, v12, v79
v_pk_add_f32 v[100:101], v[92:93], v[102:103] neg_lo:[0,1] neg_hi:[0,1]
global_store_dwordx4 v9, v[76:79], s[22:23] sc1
v_add_u32 v9, 0x400, v9
v_lshlrev_b32 v90, 16, v80
v_and_b32 v91, v12, v80
v_pk_add_f32 v[90:91], v[90:91], v[100:101]
v_cvt_pk_bf16_f32 v80, v90, v91
v_pk_add_f32 v[90:91], v[90:91], v[14:15] op_sel_hi:[1,0]
v_lshlrev_b32 v102, 16, v80
v_and_b32 v103, v12, v80
v_pk_add_f32 v[100:101], v[90:91], v[102:103] neg_lo:[0,1] neg_hi:[0,1]
v_lshlrev_b32 v92, 16, v81
v_and_b32 v93, v12, v81
v_pk_add_f32 v[92:93], v[92:93], v[100:101]
v_cvt_pk_bf16_f32 v81, v92, v93
v_pk_add_f32 v[92:93], v[92:93], v[14:15] op_sel_hi:[1,0]
v_lshlrev_b32 v102, 16, v81
v_and_b32 v103, v12, v81
v_pk_add_f32 v[100:101], v[92:93], v[102:103] neg_lo:[0,1] neg_hi:[0,1]
v_lshlrev_b32 v90, 16, v82
v_and_b32 v91, v12, v82
v_pk_add_f32 v[90:91], v[90:91], v[100:101]
v_cvt_pk_bf16_f32 v82, v90, v91
v_pk_add_f32 v[90:91], v[90:91], v[14:15] op_sel_hi:[1,0]
v_lshlrev_b32 v102, 16, v82
v_and_b32 v103, v12, v82
v_pk_add_f32 v[100:101], v[90:91], v[102:103] neg_lo:[0,1] neg_hi:[0,1]
v_lshlrev_b32 v92, 16, v83
v_and_b32 v93, v12, v83
v_pk_add_f32 v[92:93], v[92:93], v[100:101]
v_cvt_pk_bf16_f32 v83, v92, v93
v_pk_add_f32 v[92:93], v[92:93], v[14:15] op_sel_hi:[1,0]
v_lshlrev_b32 v102, 16, v83
v_and_b32 v103, v12, v83
v_pk_add_f32 v[100:101], v[92:93], v[102:103] neg_lo:[0,1] neg_hi:[0,1]
global_store_dwordx4 v9, v[80:83], s[22:23] sc1
v_add_u32 v9, 0x400, v9
v_lshlrev_b32 v90, 16, v84
v_and_b32 v91, v12, v84
v_pk_add_f32 v[90:91], v[90:91], v[100:101]
v_cvt_pk_bf16_f32 v84, v90, v91
v_pk_add_f32 v[90:91], v[90:91], v[14:15] op_sel_hi:[1,0]
v_lshlrev_b32 v102, 16, v84
v_and_b32 v103, v12, v84
v_pk_add_f32 v[100:101], v[90:91], v[102:103] neg_lo:[0,1] neg_hi:[0,1]
v_lshlrev_b32 v92, 16, v85
v_and_b32 v93, v12, v85
v_pk_add_f32 v[92:93], v[92:93], v[100:101]
v_cvt_pk_bf16_f32 v85, v92, v93
v_pk_add_f32 v[92:93], v[92:93], v[14:15] op_sel_hi:[1,0]
v_lshlrev_b32 v102, 16, v85
v_and_b32 v103, v12, v85
v_pk_add_f32 v[100:101], v[92:93], v[102:103] neg_lo:[0,1] neg_hi:[0,1]
v_lshlrev_b32 v90, 16, v86
v_and_b32 v91, v12, v86
v_pk_add_f32 v[90:91], v[90:91], v[100:101]
v_cvt_pk_bf16_f32 v86, v90, v91
v_pk_add_f32 v[90:91], v[90:91], v[14:15] op_sel_hi:[1,0]
v_lshlrev_b32 v102, 16, v86
v_and_b32 v103, v12, v86
v_pk_add_f32 v[100:101], v[90:91], v[102:103] neg_lo:[0,1] neg_hi:[0,1]
v_lshlrev_b32 v92, 16, v87
v_and_b32 v93, v12, v87
v_pk_add_f32 v[92:93], v[92:93], v[100:101]
v_cvt_pk_bf16_f32 v87, v92, v93
v_pk_add_f32 v[92:93], v[92:93], v[14:15] op_sel_hi:[1,0]
v_lshlrev_b32 v102, 16, v87
v_and_b32 v103, v12, v87
v_pk_add_f32 v[100:101], v[92:93], v[102:103] neg_lo:[0,1] neg_hi:[0,1]
global_store_dwordx4 v9, v[84:87], s[22:23] sc1
v_add_u32 v9, 0x400, v9
v_lshlrev_b32 v88, 16, v88
v_mul_f32 v88, 0x3fb8aa3b, v88
v_lshlrev_b32 v94, 1, v94
v_add_u32 v94, 13729792, v94
s_cmp_lg_u32 s24, 0
s_cbranch_scc1 L_p_wm_end
global_store_dword v94, v88, s[22:23] sc1
s_branch L_p_wm_end
L_p_w2:
s_mov_b32 s28, s16
s_and_b32 s29, s17, 0xffff
s_mov_b32 s30, 5308416
s_mov_b32 s31, 0x20000
s_sub_u32 s38, s2, 168
s_mul_i32 s36, s38, 57
s_lshr_b32 s36, s36, 9
s_mul_i32 s37, s36, 9
s_sub_u32 s37, s38, s37
s_mul_i32 s32, s36, 663552
s_lshl_b32 s33, s37, 7
s_add_u32 s32, s32, s33
v_lshrrev_b32 v8, 3, v1
v_mul_u32_u24 v8, 1152, v8
v_and_b32 v9, 7, v1
v_lshl_add_u32 v8, v9, 4, v8
s_mul_i32 s34, s24, 18432
s_add_u32 s32, s32, s34
s_mul_i32 s34, s24, 2048
s_add_u32 m0, s34, 88064
s_nop 0
buffer_load_dwordx4 v8, s[28:31], s32 offen lds
s_add_u32 s32, s32, 9216
s_add_u32 m0, m0, 1024
s_nop 0
buffer_load_dwordx4 v8, s[28:31], s32 offen lds
s_add_u32 s32, s32, 64512
s_add_u32 m0, m0, 7168
s_nop 0
buffer_load_dwordx4 v8, s[28:31], s32 offen lds
s_add_u32 s32, s32, 9216
s_add_u32 m0, m0, 1024
s_nop 0
buffer_load_dwordx4 v8, s[28:31], s32 offen lds
s_add_u32 s32, s32, 64512
s_add_u32 m0, m0, 7168
v_lshl_add_u32 v10, v5, 2, v4
v_lshlrev_b32 v10, 7, v10
v_lshl_add_u32 v10, v3, 3, v10
s_lshl_b32 s35, s24, 5
s_add_u32 s35, s35, 88064
v_add_u32 v10, s35, v10
v_add_u32 v11, 0x10000, v10
s_sub_u32 s38, s37, s36
s_add_u32 s38, s38, 7
s_and_b32 s38, s38, 7
s_add_u32 s38, s38, 1
s_cmp_eq_u32 s37, 8
s_cselect_b32 s38, 0, s38
s_mul_i32 s39, s38, 18
s_cmp_lt_u32 s38, 2
s_cselect_b32 s39, s38, s39
s_cselect_b32 s43, 2, 1
s_lshl_b32 s43, s43, 10
s_add_u32 s39, s39, 162
s_lshl_b32 s39, s39, 10
s_lshl_b32 s41, s36, 2
s_add_u32 s41, s41, s24
s_mul_i32 s41, s41, 331776
s_add_u32 s41, s41, s39
s_add_u32 s41, s41, 3112960
v_add_u32 v9, s41, v7
s_waitcnt vmcnt(2)
s_barrier
ds_read_b64_tr_b16 v[16:17], v10 offset:0
ds_read_b64_tr_b16 v[18:19], v10 offset:2048
ds_read_b64_tr_b16 v[20:21], v10 offset:4096
ds_read_b64_tr_b16 v[22:23], v10 offset:6144
s_waitcnt lgkmcnt(2)
global_store_dwordx4 v9, v[16:19], s[22:23] sc1
v_add_u32 v9, s43, v9
s_waitcnt lgkmcnt(0)
global_store_dwordx4 v9, v[20:23], s[22:23] sc1
v_add_u32 v9, s43, v9
s_nop 0
buffer_load_dwordx4 v8, s[28:31], s32 offen lds
s_add_u32 s32, s32, 9216
s_add_u32 m0, m0, 1024
s_nop 0
buffer_load_dwordx4 v8, s[28:31], s32 offen lds
s_add_u32 s32, s32, 64512
s_add_u32 m0, m0, 7168
s_waitcnt vmcnt(4)
s_barrier
ds_read_b64_tr_b16 v[24:25], v10 offset:8192
ds_read_b64_tr_b16 v[26:27], v10 offset:10240
ds_read_b64_tr_b16 v[28:29], v10 offset:12288
ds_read_b64_tr_b16 v[30:31], v10 offset:14336
s_waitcnt lgkmcnt(2)
global_store_dwordx4 v9, v[24:27], s[22:23] sc1
v_add_u32 v9, s43, v9
s_waitcnt lgkmcnt(0)
global_store_dwordx4 v9, v[28:31], s[22:23] sc1
v_add_u32 v9, s43, v9
s_nop 0
buffer_load_dwordx4 v8, s[28:31], s32 offen lds
s_add_u32 s32, s32, 9216
s_add_u32 m0, m0, 1024
s_nop 0
buffer_load_dwordx4 v8, s[28:31], s32 offen lds
s_add_u32 s32, s32, 64512
s_add_u32 m0, m0, 7168
s_waitcnt vmcnt(4)
s_barrier
ds_read_b64_tr_b16 v[32:33], v10 offset:16384
ds_read_b64_tr_b16 v[34:35], v10 offset:18432
ds_read_b64_tr_b16 v[36:37], v10 offset:20480
ds_read_b64_tr_b16 v[38:39], v10 offset:22528
s_waitcnt lgkmcnt(2)
global_store_dwordx4 v9, v[32:35], s[22:23] sc1
v_add_u32 v9, s43, v9
s_waitcnt lgkmcnt(0)
global_store_dwordx4 v9, v[36:39], s[22:23] sc1
v_add_u32 v9, s43, v9
s_nop 0
buffer_load_dwordx4 v8, s[28:31], s32 offen lds
s_add_u32 s32, s32, 9216
s_add_u32 m0, m0, 1024
s_nop 0
buffer_load_dwordx4 v8, s[28:31], s32 offen lds
s_add_u32 s32, s32, 64512
s_add_u32 m0, m0, 7168
s_waitcnt vmcnt(4)
s_barrier
ds_read_b64_tr_b16 v[40:41], v10 offset:24576
ds_read_b64_tr_b16 v[42:43], v10 offset:26624
ds_read_b64_tr_b16 v[44:45], v10 offset:28672
ds_read_b64_tr_b16 v[46:47], v10 offset:30720
s_waitcnt lgkmcnt(2)
global_store_dwordx4 v9, v[40:43], s[22:23] sc1
v_add_u32 v9, s43, v9
s_waitcnt lgkmcnt(0)
global_store_dwordx4 v9, v[44:47], s[22:23] sc1
v_add_u32 v9, s43, v9
s_nop 0
buffer_load_dwordx4 v8, s[28:31], s32 offen lds
s_add_u32 s32, s32, 9216
s_add_u32 m0, m0, 1024
s_nop 0
buffer_load_dwordx4 v8, s[28:31], s32 offen lds
s_add_u32 s32, s32, 64512
s_add_u32 m0, m0, 7168
s_waitcnt vmcnt(4)
s_barrier
ds_read_b64_tr_b16 v[48:49], v10 offset:32768
ds_read_b64_tr_b16 v[50:51], v10 offset:34816
ds_read_b64_tr_b16 v[52:53], v10 offset:36864
ds_read_b64_tr_b16 v[54:55], v10 offset:38912
s_waitcnt lgkmcnt(2)
global_store_dwordx4 v9, v[48:51], s[22:23] sc1
v_add_u32 v9, s43, v9
s_waitcnt lgkmcnt(0)
global_store_dwordx4 v9, v[52:55], s[22:23] sc1
v_add_u32 v9, s43, v9
s_nop 0
buffer_load_dwordx4 v8, s[28:31], s32 offen lds
s_add_u32 s32, s32, 9216
s_add_u32 m0, m0, 1024
s_nop 0
buffer_load_dwordx4 v8, s[28:31], s32 offen lds
s_add_u32 s32, s32, 64512
s_add_u32 m0, m0, 7168
s_waitcnt vmcnt(4)
s_barrier
ds_read_b64_tr_b16 v[56:57], v10 offset:40960
ds_read_b64_tr_b16 v[58:59], v10 offset:43008
ds_read_b64_tr_b16 v[60:61], v10 offset:45056
ds_read_b64_tr_b16 v[62:63], v10 offset:47104
s_waitcnt lgkmcnt(2)
global_store_dwordx4 v9, v[56:59], s[22:23] sc1
v_add_u32 v9, s43, v9
s_waitcnt lgkmcnt(0)
global_store_dwordx4 v9, v[60:63], s[22:23] sc1
v_add_u32 v9, s43, v9
s_nop 0
buffer_load_dwordx4 v8, s[28:31], s32 offen lds
s_add_u32 s32, s32, 9216
s_add_u32 m0, m0, 1024
s_nop 0
buffer_load_dwordx4 v8, s[28:31], s32 offen lds
s_add_u32 s32, s32, 64512
s_add_u32 m0, m0, 7168
s_waitcnt vmcnt(4)
s_barrier
ds_read_b64_tr_b16 v[64:65], v10 offset:49152
ds_read_b64_tr_b16 v[66:67], v10 offset:51200
ds_read_b64_tr_b16 v[68:69], v10 offset:53248
ds_read_b64_tr_b16 v[70:71], v10 offset:55296
s_waitcnt lgkmcnt(2)
global_store_dwordx4 v9, v[64:67], s[22:23] sc1
v_add_u32 v9, s43, v9
s_waitcnt lgkmcnt(0)
global_store_dwordx4 v9, v[68:71], s[22:23] sc1
v_add_u32 v9, s43, v9
s_nop 0
buffer_load_dwordx4 v8, s[28:31], s32 offen lds
s_add_u32 s32, s32, 9216
s_add_u32 m0, m0, 1024
s_nop 0
buffer_load_dwordx4 v8, s[28:31], s32 offen lds
s_add_u32 s32, s32, 64512
s_add_u32 m0, m0, 7168
s_waitcnt vmcnt(4)
s_barrier
ds_read_b64_tr_b16 v[72:73], v10 offset:57344
ds_read_b64_tr_b16 v[74:75], v10 offset:59392
ds_read_b64_tr_b16 v[76:77], v10 offset:61440
ds_read_b64_tr_b16 v[78:79], v10 offset:63488
s_waitcnt lgkmcnt(2)
global_store_dwordx4 v9, v[72:75], s[22:23] sc1
v_add_u32 v9, s43, v9
s_waitcnt lgkmcnt(0)
global_store_dwordx4 v9, v[76:79], s[22:23] sc1
v_add_u32 v9, s43, v9
s_waitcnt vmcnt(2)
s_barrier
ds_read_b64_tr_b16 v[80:81], v11 offset:0
ds_read_b64_tr_b16 v[82:83], v11 offset:2048
ds_read_b64_tr_b16 v[84:85], v11 offset:4096
ds_read_b64_tr_b16 v[86:87], v11 offset:6144
s_waitcnt lgkmcnt(2)
global_store_dwordx4 v9, v[80:83], s[22:23] sc1
v_add_u32 v9, s43, v9
s_waitcnt lgkmcnt(0)
global_store_dwordx4 v9, v[84:87], s[22:23] sc1
v_add_u32 v9, s43, v9
L_p_wm_end:
s_lshl_b32 s40, s36, 8
s_add_u32 s40, s40, 16525568
s_branch L_p_fin
L_p_wo:
s_mov_b32 s28, s8
s_and_b32 s29, s9, 0xffff
s_mov_b32 s30, 663552
s_mov_b32 s31, 0x20000
s_sub_u32 s37, s2, 240
s_lshl_b32 s32, s37, 7
v_lshrrev_b32 v8, 3, v1
v_mul_u32_u24 v8, 1152, v8
v_and_b32 v9, 7, v1
v_lshl_add_u32 v8, v9, 4, v8
s_mul_i32 s34, s24, 18432
s_add_u32 s32, s32, s34
s_mul_i32 s34, s24, 2048
s_add_u32 m0, s34, 88064
s_nop 0
buffer_load_dwordx4 v8, s[28:31], s32 offen lds
s_add_u32 s32, s32, 9216
s_add_u32 m0, m0, 1024
s_nop 0
buffer_load_dwordx4 v8, s[28:31], s32 offen lds
s_add_u32 s32, s32, 64512
s_add_u32 m0, m0, 7168
s_nop 0
buffer_load_dwordx4 v8, s[28:31], s32 offen lds
s_add_u32 s32, s32, 9216
s_add_u32 m0, m0, 1024
s_nop 0
buffer_load_dwordx4 v8, s[28:31], s32 offen lds
s_add_u32 s32, s32, 64512
s_add_u32 m0, m0, 7168
v_lshrrev_b32 v10, 1, v5
v_mul_u32_u24 v10, 20, v10
v_and_b32 v11, 1, v5
v_lshl_add_u32 v10, v11, 3, v10
v_add_u32 v10, v10, v4
v_lshlrev_b32 v10, 7, v10
v_lshl_add_u32 v10, v3, 3, v10
s_lshl_b32 s35, s24, 5
s_add_u32 s35, s35, 88064
v_add_u32 v10, s35, v10
v_add_u32 v11, 36864, v10
v_mul_u32_u24 v12, 72, v5
v_add3_u32 v12, v12, v4, 16
v_lshlrev_b32 v12, 7, v12
v_lshl_add_u32 v12, v3, 3, v12
s_lshl_b32 s35, s24, 5
s_add_u32 s35, s35, 88064
v_add_u32 v12, s35, v12
s_mul_i32 s38, s37, 94208
s_lshl_b32 s39, s24, 10
s_add_u32 s38, s38, s39
s_mul_i32 s39, s24, 188416
s_add_u32 s39, s39, 4096
s_cmp_eq_u32 s37, 8
s_cselect_b32 s38, s39, s38
s_cselect_b32 s39, 94080, 0
s_add_u32 s38, s38, 2359296
v_lshrrev_b32 v9, 3, v6
v_mul_u32_u24 v9, s39, v9
v_add3_u32 v9, v9, v7, s38
s_waitcnt vmcnt(2)
s_barrier
ds_read_b64_tr_b16 v[16:17], v10 offset:0
ds_read_b64_tr_b16 v[18:19], v10 offset:512
s_waitcnt lgkmcnt(0)
global_store_dwordx4 v9, v[16:19], s[22:23] sc1
v_add_u32 v9, 0x1400, v9
s_nop 0
buffer_load_dwordx4 v8, s[28:31], s32 offen lds
s_add_u32 s32, s32, 9216
s_add_u32 m0, m0, 1024
s_nop 0
buffer_load_dwordx4 v8, s[28:31], s32 offen lds
s_add_u32 s32, s32, 64512
s_add_u32 m0, m0, 7168
s_waitcnt vmcnt(3)
s_barrier
ds_read_b64_tr_b16 v[20:21], v10 offset:4608
ds_read_b64_tr_b16 v[22:23], v10 offset:5120
ds_read_b64_tr_b16 v[24:25], v10 offset:9216
ds_read_b64_tr_b16 v[26:27], v10 offset:9728
s_waitcnt lgkmcnt(2)
global_store_dwordx4 v9, v[20:23], s[22:23] sc1
v_add_u32 v9, 0x1400, v9
s_waitcnt lgkmcnt(0)
global_store_dwordx4 v9, v[24:27], s[22:23] sc1
v_add_u32 v9, 0x1400, v9
s_nop 0
buffer_load_dwordx4 v8, s[28:31], s32 offen lds
s_add_u32 s32, s32, 9216
s_add_u32 m0, m0, 1024
s_nop 0
buffer_load_dwordx4 v8, s[28:31], s32 offen lds
s_add_u32 s32, s32, 64512
s_add_u32 m0, m0, 7168
s_waitcnt vmcnt(4)
s_barrier
ds_read_b64_tr_b16 v[28:29], v10 offset:13824
ds_read_b64_tr_b16 v[30:31], v10 offset:14336
ds_read_b64_tr_b16 v[32:33], v10 offset:18432
ds_read_b64_tr_b16 v[34:35], v10 offset:18944
s_waitcnt lgkmcnt(2)
global_store_dwordx4 v9, v[28:31], s[22:23] sc1
v_add_u32 v9, 0x1400, v9
s_waitcnt lgkmcnt(0)
global_store_dwordx4 v9, v[32:35], s[22:23] sc1
v_add_u32 v9, 0x1400, v9
s_nop 0
buffer_load_dwordx4 v8, s[28:31], s32 offen lds
s_add_u32 s32, s32, 9216
s_add_u32 m0, m0, 1024
s_nop 0
buffer_load_dwordx4 v8, s[28:31], s32 offen lds
s_add_u32 s32, s32, 64512
s_add_u32 m0, m0, 7168
s_waitcnt vmcnt(4)
s_barrier
ds_read_b64_tr_b16 v[36:37], v10 offset:23040
ds_read_b64_tr_b16 v[38:39], v10 offset:23552
ds_read_b64_tr_b16 v[40:41], v10 offset:27648
ds_read_b64_tr_b16 v[42:43], v10 offset:28160
s_waitcnt lgkmcnt(2)
global_store_dwordx4 v9, v[36:39], s[22:23] sc1
v_add_u32 v9, 0x1400, v9
s_waitcnt lgkmcnt(0)
global_store_dwordx4 v9, v[40:43], s[22:23] sc1
v_add_u32 v9, 0x1400, v9
s_nop 0
buffer_load_dwordx4 v8, s[28:31], s32 offen lds
s_add_u32 s32, s32, 9216
s_add_u32 m0, m0, 1024
s_nop 0
buffer_load_dwordx4 v8, s[28:31], s32 offen lds
s_add_u32 s32, s32, 64512
s_add_u32 m0, m0, 7168
s_waitcnt vmcnt(4)
s_barrier
ds_read_b64_tr_b16 v[44:45], v10 offset:32256
ds_read_b64_tr_b16 v[46:47], v10 offset:32768
s_waitcnt lgkmcnt(0)
global_store_dwordx4 v9, v[44:47], s[22:23] sc1
v_add_u32 v9, 0x1400, v9
s_nop 0
buffer_load_dwordx4 v8, s[28:31], s32 offen lds
s_add_u32 s32, s32, 9216
s_add_u32 m0, m0, 1024
s_nop 0
buffer_load_dwordx4 v8, s[28:31], s32 offen lds
s_add_u32 s32, s32, 64512
s_add_u32 m0, m0, 7168
s_waitcnt vmcnt(3)
s_barrier
ds_read_b64_tr_b16 v[48:49], v11 offset:0
ds_read_b64_tr_b16 v[50:51], v11 offset:512
ds_read_b64_tr_b16 v[52:53], v11 offset:4608
ds_read_b64_tr_b16 v[54:55], v11 offset:5120
s_waitcnt lgkmcnt(2)
global_store_dwordx4 v9, v[48:51], s[22:23] sc1
v_add_u32 v9, 0x1400, v9
s_waitcnt lgkmcnt(0)
global_store_dwordx4 v9, v[52:55], s[22:23] sc1
v_add_u32 v9, 0x1400, v9
s_nop 0
buffer_load_dwordx4 v8, s[28:31], s32 offen lds
s_add_u32 s32, s32, 9216
s_add_u32 m0, m0, 1024
s_nop 0
buffer_load_dwordx4 v8, s[28:31], s32 offen lds
s_add_u32 s32, s32, 64512
s_add_u32 m0, m0, 7168
s_waitcnt vmcnt(4)
s_barrier
ds_read_b64_tr_b16 v[56:57], v11 offset:9216
ds_read_b64_tr_b16 v[58:59], v11 offset:9728
ds_read_b64_tr_b16 v[60:61], v11 offset:13824
ds_read_b64_tr_b16 v[62:63], v11 offset:14336
s_waitcnt lgkmcnt(2)
global_store_dwordx4 v9, v[56:59], s[22:23] sc1
v_add_u32 v9, 0x1400, v9
s_waitcnt lgkmcnt(0)
global_store_dwordx4 v9, v[60:63], s[22:23] sc1
v_add_u32 v9, 0x1400, v9
s_nop 0
buffer_load_dwordx4 v8, s[28:31], s32 offen lds
s_add_u32 s32, s32, 9216
s_add_u32 m0, m0, 1024
s_nop 0
buffer_load_dwordx4 v8, s[28:31], s32 offen lds
s_add_u32 s32, s32, 64512
s_add_u32 m0, m0, 7168
s_waitcnt vmcnt(4)
s_barrier
ds_read_b64_tr_b16 v[64:65], v11 offset:18432
ds_read_b64_tr_b16 v[66:67], v11 offset:18944
ds_read_b64_tr_b16 v[68:69], v11 offset:23040
ds_read_b64_tr_b16 v[70:71], v11 offset:23552
s_waitcnt lgkmcnt(2)
global_store_dwordx4 v9, v[64:67], s[22:23] sc1
v_add_u32 v9, 0x1400, v9
s_waitcnt lgkmcnt(0)
global_store_dwordx4 v9, v[68:71], s[22:23] sc1
v_add_u32 v9, 0x1400, v9
s_waitcnt vmcnt(2)
s_barrier
ds_read_b64_tr_b16 v[72:73], v11 offset:27648
ds_read_b64_tr_b16 v[74:75], v11 offset:28160
ds_read_b64_tr_b16 v[76:77], v11 offset:32256
ds_read_b64_tr_b16 v[78:79], v11 offset:32768
ds_read_b64_tr_b16 v[80:81], v12 offset:0
ds_read_b64_tr_b16 v[82:83], v12 offset:4608
ds_read_b64_tr_b16 v[84:85], v12 offset:36864
ds_read_b64_tr_b16 v[86:87], v12 offset:41472
s_waitcnt lgkmcnt(6)
global_store_dwordx4 v9, v[72:75], s[22:23] sc1
v_add_u32 v9, 0x1400, v9
s_waitcnt lgkmcnt(4)
global_store_dwordx4 v9, v[76:79], s[22:23] sc1
v_add_u32 v9, 0x1400, v9
s_waitcnt lgkmcnt(2)
global_store_dwordx4 v9, v[80:83], s[22:23] sc1
v_add_u32 v9, 0x1400, v9
s_waitcnt lgkmcnt(0)
global_store_dwordx4 v9, v[84:87], s[22:23] sc1
v_add_u32 v9, 0x1400, v9
s_mov_b32 s40, 16527616
s_branch L_p_fin
L_p_zero:
s_mov_b32 s33, 0
s_mov_b32 s40, 0
s_cmp_ge_u32 s2, 96
s_cbranch_scc1 L_p_fin0
s_and_b32 s39, s2, 31
v_mov_b32 v12, 0
v_mov_b32 v13, 0
v_mov_b32 v14, 0
v_mov_b32 v15, 0
s_cmp_ge_u32 s39, 28
s_cbranch_scc1 L_p_bulk
s_lshl_b32 s38, s24, 8
s_add_u32 s38, s38, s2
s_cmp_lg_u32 s38, 27
s_cbranch_scc1 L_p_fin0
v_add_u32 v9, 16524288, v7
global_store_dwordx4 v9, v[12:15], s[22:23] offset:-1024 sc1
global_store_dwordx4 v9, v[12:15], s[22:23] offset:0 sc1
global_store_dwordx4 v9, v[12:15], s[22:23] offset:1024 sc1
global_store_dwordx4 v9, v[12:15], s[22:23] offset:2048 sc1
global_store_dwordx4 v9, v[12:15], s[22:23] offset:3072 sc1
s_mov_b32 s28, 1
s_waitcnt vmcnt(0) lgkmcnt(0)
s_atomic_or s28, s[20:21], 128
s_waitcnt lgkmcnt(0)
s_branch L_p_fin0
L_p_bulk:
s_lshr_b32 s38, s2, 5
s_lshl_b32 s38, s38, 2
s_and_b32 s39, s2, 3
s_add_u32 s38, s38, s39
s_lshl_b32 s38, s38, 2
s_add_u32 s38, s38, s24
s_lshl_b32 s39, s38, 13
s_add_u32 s39, s39, 16134144
v_add_u32 v9, s39, v7
global_store_dwordx4 v9, v[12:15], s[22:23] offset:-4096 sc1
global_store_dwordx4 v9, v[12:15], s[22:23] offset:-3072 sc1
global_store_dwordx4 v9, v[12:15], s[22:23] offset:-2048 sc1
global_store_dwordx4 v9, v[12:15], s[22:23] offset:-1024 sc1
global_store_dwordx4 v9, v[12:15], s[22:23] offset:0 sc1
global_store_dwordx4 v9, v[12:15], s[22:23] offset:1024 sc1
global_store_dwordx4 v9, v[12:15], s[22:23] offset:2048 sc1
global_store_dwordx4 v9, v[12:15], s[22:23] offset:3072 sc1
s_mov_b32 s40, 16527872
L_p_fin:
s_mov_b32 s33, 1
L_p_fin0:
s_add_u32 s70, s22, s40
s_addc_u32 s71, s23, 0
s_mov_b32 s65, s33
v_mov_b32 v2, 0
global_load_dword v3, v2, s[20:21] offset:128 sc1
s_mov_b32 s3, 0
s_add_u32 s48, s22, 17178624
s_addc_u32 s49, s23, 0
s_add_u32 s68, s22, 16130048
s_addc_u32 s69, s23, 0
s_mov_b32 s38, 128
s_mov_b32 s39, 256
s_mov_b32 s64, 32
s_mul_i32 s42, s27, 18432
s_lshl_b32 s43, s25, 2
s_max_u32 s43, s43, 1
s_sub_u32 s43, s43, 1
s_mul_i32 s43, s43, 18432
s_lshr_b32 s44, s24, 1
s_mul_i32 s44, s44, 128
s_add_u32 s43, s43, s44
s_add_u32 s32, s4, s42
s_addc_u32 s33, s5, 0
s_add_u32 s34, s4, s43
s_addc_u32 s35, s5, 0
s_add_u32 s36, s24, 1
s_mul_i32 s36, s36, 18432
s_lshl_b32 s37, s24, 10
v_lshrrev_b32 v13, 1, v5
v_and_b32 v10, 7, v1
v_lshrrev_b32 v12, 3, v6
s_lshr_b32 s44, s24, 1
s_lshl_b32 s44, s44, 3
v_lshrrev_b32 v9, 3, v1
v_mul_u32_u24 v8, 1152, v9
v_xor_b32 v9, v10, v5
v_lshl_add_u32 v8, v9, 4, v8
v_xor_b32 v155, 64, v8
v_add_u32 v155, 9216, v155
v_lshl_add_u32 v9, v12, 3, v9
v_xor_b32 v13, v10, v13
v_xor_b32 v15, s26, v10
v_lshl_add_u32 v9, v10, 4, v9
v_lshl_add_u32 v13, v10, 4, v13
v_lshl_add_u32 v15, v10, 4, v15
v_lshlrev_b32 v9, 4, v9
v_xor_b32 v157, 64, v9
v_add_u32 v13, s44, v13
v_add_u32 v15, s44, v15
s_bitcmp1_b32 s24, 0
s_cselect_b64 vcc, -1, 0
s_cselect_b32 s45, 3, 1
s_mul_i32 s45, s45, 18432
v_add_u32 v158, 55296, v157
v_cndmask_b32 v156, v8, v155, vcc
v_and_b32 v164, 1, v5
v_mul_u32_u24 v11, 18432, v12
v_lshl_add_u32 v11, v164, 3, v11
s_lshl_b32 s44, s26, 11
s_add_u32 s44, s44, s45
s_add_u32 s45, s45, 16384
v_lshl_add_u32 v13, v13, 4, v11
v_add_u32 v13, s44, v13
v_lshl_add_u32 v15, v15, 4, v11
v_add_u32 v15, s45, v15
v_xor_b32 v14, s64, v13
s_lshl_b32 s64, s64, 1
v_xor_b32 v159, s64, v13
v_xor_b32 v160, s64, v14
v_mad_u32_u24 v12, v12, 40, v10
v_add_u32 v10, 55296, v9
s_lshl_b32 s47, s24, 5
s_add_u32 s47, s47, 92160
v_mul_u32_u24 v11, 144, v12
v_lshl_add_u32 v11, v5, 3, v11
v_add_u32 v11, s47, v11
v_lshrrev_b32 v163, 1, v5
v_mul_u32_u24 v163, 40, v163
v_lshl_add_u32 v163, v164, 2, v163
v_and_b32 v164, 3, v6
v_add_u32 v165, v163, v164
v_mul_u32_u24 v165, 144, v165
v_lshrrev_b32 v164, 2, v6
v_lshl_add_u32 v165, v164, 3, v165
v_add_u32 v165, s47, v165
v_mul_u32_u24 v161, 640, v5
v_lshl_add_u32 v161, v12, 2, v161
v_add_u32 v161, 127680, v161
v_and_b32 v164, 1, v6
v_add_u32 v164, v164, v163
v_lshrrev_b32 v166, 1, v6
v_mul_u32_u24 v166, 640, v166
v_lshl_add_u32 v166, v164, 3, v166
v_add_u32 v166, 130240, v166
v_lshlrev_b32 v163, 2, v163
v_add_u32 v163, 126720, v163
v_lshlrev_b32 v162, 2, v12
v_add_u32 v162, 127040, v162
v_add_u32 v164, 133120, v7
s_mov_b32 vcc_lo, 0xf0000f
s_mov_b32 vcc_hi, 0xf0000f00
v_cndmask_b32 v162, v164, v162, vcc
s_mov_b32 vcc_lo, 0x1000100
s_mov_b32 vcc_hi, 0x1000100
v_cndmask_b32 v163, v164, v163, vcc
s_mov_b32 vcc_lo, 0xff00ff
s_mov_b32 vcc_hi, 0xff00ff
v_cndmask_b32 v166, v164, v166, vcc
s_mov_b32 s50, 0x22222222
s_mov_b32 s51, 0x22222222
s_mov_b32 s52, 0x44444444
s_mov_b32 s53, 0x44444444
s_mov_b32 s54, 0x88888888
s_mov_b32 s55, 0x88888888
s_lshl_b32 s44, s26, 8
s_sub_u32 s44, 2048, s44
v_and_b32 v154, 1, v1
v_mul_u32_u24 v153, s44, v154
v_sub_u32 v153, 16527616, v153
v_mad_u32_u24 v154, v154, 9, 9
s_mov_b32 exec_lo, 0
v_mov_b32 v153, 16527872
v_mov_b32 v154, 12
s_mov_b32 exec_lo, -1
s_lshl_b32 s46, s26, 2
s_add_u32 s46, s46, s24
s_mul_i32 s46, s46, 73728
s_add_u32 s46, s46, 4096
s_add_u32 s30, s22, s46
s_addc_u32 s31, s23, 0
s_lshl_b32 s40, s26, 8
s_add_u32 s40, s40, 16523264
s_add_u32 s66, s22, s40
s_addc_u32 s67, s23, 0
s_waitcnt vmcnt(0)
s_barrier
s_cmp_lg_u32 s24, 0
s_cbranch_scc1 L_f_na
s_mov_b32 s41, 0
s_branch L_sp_c_2
L_sp_p_1:
global_load_dword v3, v2, s[20:21] offset:128 sc1
s_waitcnt vmcnt(0)
L_sp_c_2:
v_cmp_ne_u32 vcc, 1, v3
s_add_u32 s41, s41, 1
s_cmp_gt_u32 s41, 2097152
s_cbranch_scc1 L_sp_k_3
s_cbranch_vccz L_sp_k_3
s_sleep 4
s_branch L_sp_p_1
L_sp_k_3:
s_cmp_eq_u32 s65, 0
s_cbranch_scc1 L_f_na
s_atomic_add s65, s[70:71], 0 glc
s_cmp_ge_u32 s2, 96
s_cbranch_scc1 L_f_na
s_waitcnt lgkmcnt(0)
s_cmp_lg_u32 s65, 8
s_cbranch_scc1 L_f_na
s_and_b32 s29, s2, 31
s_cmp_ge_u32 s29, 27
s_cbranch_scc1 L_f_na
s_mov_b32 s29, 9
s_atomic_add s29, s[70:71], 128
L_f_na:
s_mov_b32 m0, s36
s_add_u32 s36, s36, 0x400
global_load_lds_dwordx4 v8, s[32:33] sc1
s_mov_b32 m0, s36
s_add_u32 s36, s36, 0x400
global_load_lds_dwordx4 v155, s[32:33] sc1
s_add_u32 s32, s32, s38
s_addc_u32 s33, s33, 0
s_mov_b32 m0, s36
s_add_u32 s36, s36, 0x400
global_load_lds_dwordx4 v8, s[32:33] sc1
s_mov_b32 m0, s36
s_add_u32 s36, s36, 0x400
global_load_lds_dwordx4 v155, s[32:33] sc1
s_add_u32 s32, s32, s38
s_addc_u32 s33, s33, 0
s_mov_b32 m0, s36
s_add_u32 s36, s36, 0x400
global_load_lds_dwordx4 v8, s[32:33] sc1
s_mov_b32 m0, s36
s_add_u32 s36, s36, 0x400
global_load_lds_dwordx4 v155, s[32:33] sc1
s_add_u32 s32, s32, s38
s_addc_u32 s33, s33, 0
s_mov_b32 m0, s37
s_add_u32 s37, s37, 0x1000
global_load_lds_dwordx4 v156, s[34:35] sc1
s_add_u32 s34, s34, s39
s_addc_u32 s35, s35, 0
s_mov_b32 m0, s37
s_add_u32 s37, s37, 0x1000
global_load_lds_dwordx4 v156, s[34:35] sc1
s_add_u32 s34, s34, s39
s_addc_u32 s35, s35, 0
s_mov_b32 m0, s36
s_add_u32 s36, s36, 0x400
global_load_lds_dwordx4 v8, s[32:33] sc1
s_mov_b32 m0, s36
s_add_u32 s36, s36, 0x400
global_load_lds_dwordx4 v155, s[32:33] sc1
s_add_u32 s32, s32, s38
s_addc_u32 s33, s33, 0
s_mov_b32 m0, s36
s_add_u32 s36, s36, 0x400
global_load_lds_dwordx4 v8, s[32:33] sc1
s_mov_b32 m0, s36
s_add_u32 s36, s36, 0x400
global_load_lds_dwordx4 v155, s[32:33] sc1
s_add_u32 s32, s32, s38
s_addc_u32 s33, s33, 0
s_mov_b32 m0, s36
s_add_u32 s36, s36, 0x400
global_load_lds_dwordx4 v8, s[32:33] sc1
s_mov_b32 m0, s36
s_add_u32 s36, s36, 0x400
global_load_lds_dwordx4 v155, s[32:33] sc1
s_add_u32 s32, s32, s38
s_addc_u32 s33, s33, 0
s_mov_b32 m0, s37
s_add_u32 s37, s37, 0x1000
global_load_lds_dwordx4 v156, s[34:35] sc1
s_add_u32 s34, s34, s39
s_addc_u32 s35, s35, 0
s_cmp_lg_u32 s24, 0
s_cbranch_scc1 L_f_go
v_and_b32 v2, 1, v1
v_lshlrev_b32 v2, 8, v2
s_mov_b32 s41, 0
L_sp_p_4:
global_load_dword v3, v2, s[66:67] offset:128 sc1
s_waitcnt vmcnt(0)
L_sp_c_5:
v_cmp_ne_u32 vcc, 9, v3
s_add_u32 s41, s41, 1
s_cmp_gt_u32 s41, 2097152
s_cbranch_scc1 L_sp_k_6
s_cbranch_vccz L_sp_k_6
s_sleep 4
s_branch L_sp_p_4
L_sp_k_6:
s_waitcnt lgkmcnt(0)
L_f_go:
s_waitcnt vmcnt(7)
s_barrier
global_load_dwordx4 a[0:3], v7, s[30:31] offset:-4096 sc1
global_load_dwordx4 a[4:7], v7, s[30:31] offset:-3072 sc1
global_load_dwordx4 a[8:11], v7, s[30:31] offset:-2048 sc1
s_cmp_ge_u32 s24, 2
s_cbranch_scc1 L_qp_7
global_load_dwordx4 a[12:15], v7, s[30:31] offset:-1024 sc1
L_qp_7:
global_load_dwordx4 a[16:19], v7, s[30:31] offset:0 sc1
global_load_dwordx4 a[20:23], v7, s[30:31] offset:1024 sc1
global_load_dwordx4 a[24:27], v7, s[30:31] offset:2048 sc1
s_cmp_ge_u32 s24, 2
s_cbranch_scc1 L_qp_8
global_load_dwordx4 a[28:31], v7, s[30:31] offset:3072 sc1
L_qp_8:
s_add_u32 s30, s30, 0x2000
s_addc_u32 s31, s31, 0
global_load_dwordx4 a[32:35], v7, s[30:31] offset:-4096 sc1
global_load_dwordx4 a[36:39], v7, s[30:31] offset:-3072 sc1
global_load_dwordx4 a[40:43], v7, s[30:31] offset:-2048 sc1
s_cmp_ge_u32 s24, 2
s_cbranch_scc1 L_qp_9
global_load_dwordx4 a[44:47], v7, s[30:31] offset:-1024 sc1
L_qp_9:
global_load_dwordx4 a[48:51], v7, s[30:31] offset:0 sc1
global_load_dwordx4 a[52:55], v7, s[30:31] offset:1024 sc1
global_load_dwordx4 a[56:59], v7, s[30:31] offset:2048 sc1
s_cmp_ge_u32 s24, 2
s_cbranch_scc1 L_qp_10
global_load_dwordx4 a[60:63], v7, s[30:31] offset:3072 sc1
L_qp_10:
s_add_u32 s30, s30, 0x2000
s_addc_u32 s31, s31, 0
global_load_dwordx4 a[64:67], v7, s[30:31] offset:-4096 sc1
global_load_dwordx4 a[68:71], v7, s[30:31] offset:-3072 sc1
global_load_dwordx4 a[72:75], v7, s[30:31] offset:-2048 sc1
s_cmp_ge_u32 s24, 2
s_cbranch_scc1 L_qp_11
global_load_dwordx4 a[76:79], v7, s[30:31] offset:-1024 sc1
L_qp_11:
global_load_dwordx4 a[80:83], v7, s[30:31] offset:0 sc1
global_load_dwordx4 a[84:87], v7, s[30:31] offset:1024 sc1
global_load_dwordx4 a[88:91], v7, s[30:31] offset:2048 sc1
s_cmp_ge_u32 s24, 2
s_cbranch_scc1 L_qp_12
global_load_dwordx4 a[92:95], v7, s[30:31] offset:3072 sc1
L_qp_12:
s_add_u32 s30, s30, 0x2000
s_addc_u32 s31, s31, 0
s_branch L_q_join
global_load_dwordx4 a[0:3], v7, s[30:31] offset:-4096 sc1
global_load_dwordx4 a[4:7], v7, s[30:31] offset:-3072 sc1
global_load_dwordx4 a[8:11], v7, s[30:31] offset:-2048 sc1
s_cmp_ge_u32 s24, 2
s_cbranch_scc1 L_qp_13
global_load_dwordx4 a[12:15], v7, s[30:31] offset:-1024 sc1
L_qp_13:
global_load_dwordx4 a[16:19], v7, s[30:31] offset:0 sc1
global_load_dwordx4 a[20:23], v7, s[30:31] offset:1024 sc1
global_load_dwordx4 a[24:27], v7, s[30:31] offset:2048 sc1
s_cmp_ge_u32 s24, 2
s_cbranch_scc1 L_qp_14
global_load_dwordx4 a[28:31], v7, s[30:31] offset:3072 sc1
L_qp_14:
s_add_u32 s30, s30, 0x2000
s_addc_u32 s31, s31, 0
global_load_dwordx4 a[32:35], v7, s[30:31] offset:-4096 sc1
global_load_dwordx4 a[36:39], v7, s[30:31] offset:-3072 sc1
global_load_dwordx4 a[40:43], v7, s[30:31] offset:-2048 sc1
s_cmp_ge_u32 s24, 2
s_cbranch_scc1 L_qp_15
global_load_dwordx4 a[44:47], v7, s[30:31] offset:-1024 sc1
L_qp_15:
global_load_dwordx4 a[48:51], v7, s[30:31] offset:0 sc1
global_load_dwordx4 a[52:55], v7, s[30:31] offset:1024 sc1
global_load_dwordx4 a[56:59], v7, s[30:31] offset:2048 sc1
s_cmp_ge_u32 s24, 2
s_cbranch_scc1 L_qp_16
global_load_dwordx4 a[60:63], v7, s[30:31] offset:3072 sc1
L_qp_16:
s_add_u32 s30, s30, 0x2000
s_addc_u32 s31, s31, 0
global_load_dwordx4 a[64:67], v7, s[30:31] offset:-4096 sc1
global_load_dwordx4 a[68:71], v7, s[30:31] offset:-3072 sc1
global_load_dwordx4 a[72:75], v7, s[30:31] offset:-2048 sc1
s_cmp_ge_u32 s24, 2
s_cbranch_scc1 L_qp_17
global_load_dwordx4 a[76:79], v7, s[30:31] offset:-1024 sc1
L_qp_17:
global_load_dwordx4 a[80:83], v7, s[30:31] offset:0 sc1
global_load_dwordx4 a[84:87], v7, s[30:31] offset:1024 sc1
global_load_dwordx4 a[88:91], v7, s[30:31] offset:2048 sc1
s_cmp_ge_u32 s24, 2
s_cbranch_scc1 L_qp_18
global_load_dwordx4 a[92:95], v7, s[30:31] offset:3072 sc1
L_qp_18:
s_add_u32 s30, s30, 0x2000
s_addc_u32 s31, s31, 0
s_mov_b32 s3, 0
s_add_u32 s48, s22, 17178624
s_addc_u32 s49, s23, 0
s_add_u32 s68, s22, 16130048
s_addc_u32 s69, s23, 0
s_mov_b32 s38, 128
s_mov_b32 s39, 256
s_mov_b32 s64, 32
s_mul_i32 s42, s27, 18432
s_lshl_b32 s43, s25, 2
s_max_u32 s43, s43, 1
s_sub_u32 s43, s43, 1
s_mul_i32 s43, s43, 18432
s_lshr_b32 s44, s24, 1
s_mul_i32 s44, s44, 128
s_add_u32 s43, s43, s44
s_add_u32 s32, s4, s42
s_addc_u32 s33, s5, 0
s_add_u32 s34, s4, s43
s_addc_u32 s35, s5, 0
s_add_u32 s36, s24, 1
s_mul_i32 s36, s36, 18432
s_lshl_b32 s37, s24, 10
v_lshrrev_b32 v13, 1, v5
v_and_b32 v10, 7, v1
v_lshrrev_b32 v12, 3, v6
s_lshr_b32 s44, s24, 1
s_lshl_b32 s44, s44, 3
v_lshrrev_b32 v9, 3, v1
v_mul_u32_u24 v8, 1152, v9
v_xor_b32 v9, v10, v5
v_lshl_add_u32 v8, v9, 4, v8
v_xor_b32 v155, 64, v8
v_add_u32 v155, 9216, v155
v_lshl_add_u32 v9, v12, 3, v9
v_xor_b32 v13, v10, v13
v_xor_b32 v15, s26, v10
v_lshl_add_u32 v9, v10, 4, v9
v_lshl_add_u32 v13, v10, 4, v13
v_lshl_add_u32 v15, v10, 4, v15
v_lshlrev_b32 v9, 4, v9
v_xor_b32 v157, 64, v9
v_add_u32 v13, s44, v13
v_add_u32 v15, s44, v15
s_bitcmp1_b32 s24, 0
s_cselect_b64 vcc, -1, 0
s_cselect_b32 s45, 3, 1
s_mul_i32 s45, s45, 18432
v_add_u32 v158, 55296, v157
v_cndmask_b32 v156, v8, v155, vcc
v_and_b32 v164, 1, v5
v_mul_u32_u24 v11, 18432, v12
v_lshl_add_u32 v11, v164, 3, v11
s_lshl_b32 s44, s26, 11
s_add_u32 s44, s44, s45
s_add_u32 s45, s45, 16384
v_lshl_add_u32 v13, v13, 4, v11
v_add_u32 v13, s44, v13
v_lshl_add_u32 v15, v15, 4, v11
v_add_u32 v15, s45, v15
v_xor_b32 v14, s64, v13
s_lshl_b32 s64, s64, 1
v_xor_b32 v159, s64, v13
v_xor_b32 v160, s64, v14
v_mad_u32_u24 v12, v12, 40, v10
v_add_u32 v10, 55296, v9
s_lshl_b32 s47, s24, 5
s_add_u32 s47, s47, 92160
v_mul_u32_u24 v11, 144, v12
v_lshl_add_u32 v11, v5, 3, v11
v_add_u32 v11, s47, v11
v_lshrrev_b32 v163, 1, v5
v_mul_u32_u24 v163, 40, v163
v_lshl_add_u32 v163, v164, 2, v163
v_and_b32 v164, 3, v6
v_add_u32 v165, v163, v164
v_mul_u32_u24 v165, 144, v165
v_lshrrev_b32 v164, 2, v6
v_lshl_add_u32 v165, v164, 3, v165
v_add_u32 v165, s47, v165
v_mul_u32_u24 v161, 640, v5
v_lshl_add_u32 v161, v12, 2, v161
v_add_u32 v161, 127680, v161
v_and_b32 v164, 1, v6
v_add_u32 v164, v164, v163
v_lshrrev_b32 v166, 1, v6
v_mul_u32_u24 v166, 640, v166
v_lshl_add_u32 v166, v164, 3, v166
v_add_u32 v166, 130240, v166
v_lshlrev_b32 v163, 2, v163
v_add_u32 v163, 126720, v163
v_lshlrev_b32 v162, 2, v12
v_add_u32 v162, 127040, v162
v_add_u32 v164, 133120, v7
s_mov_b32 vcc_lo, 0xf0000f
s_mov_b32 vcc_hi, 0xf0000f00
v_cndmask_b32 v162, v164, v162, vcc
s_mov_b32 vcc_lo, 0x1000100
s_mov_b32 vcc_hi, 0x1000100
v_cndmask_b32 v163, v164, v163, vcc
s_mov_b32 vcc_lo, 0xff00ff
s_mov_b32 vcc_hi, 0xff00ff
v_cndmask_b32 v166, v164, v166, vcc
s_mov_b32 s50, 0x22222222
s_mov_b32 s51, 0x22222222
s_mov_b32 s52, 0x44444444
s_mov_b32 s53, 0x44444444
s_mov_b32 s54, 0x88888888
s_mov_b32 s55, 0x88888888
s_lshl_b32 s44, s26, 8
s_sub_u32 s44, 2048, s44
v_and_b32 v154, 1, v1
v_mul_u32_u24 v153, s44, v154
v_sub_u32 v153, 16527616, v153
v_mad_u32_u24 v154, v154, 9, 9
s_mov_b32 exec_lo, 0
v_mov_b32 v153, 16527872
v_mov_b32 v154, 12
s_mov_b32 exec_lo, -1
L_layer:
s_mov_b32 m0, s36
s_add_u32 s36, s36, 0x400
global_load_lds_dwordx4 v8, s[32:33] sc1
s_mov_b32 m0, s36
s_add_u32 s36, s36, 0x400
global_load_lds_dwordx4 v155, s[32:33] sc1
s_add_u32 s32, s32, s38
s_addc_u32 s33, s33, 0
s_mov_b32 m0, s36
s_add_u32 s36, s36, 0x400
global_load_lds_dwordx4 v8, s[32:33] sc1
s_mov_b32 m0, s36
s_add_u32 s36, s36, 0x400
global_load_lds_dwordx4 v155, s[32:33] sc1
s_add_u32 s32, s32, s38
s_addc_u32 s33, s33, 0
s_mov_b32 m0, s36
s_add_u32 s36, s36, 0x400
global_load_lds_dwordx4 v8, s[32:33] sc1
s_mov_b32 m0, s36
s_add_u32 s36, s36, 0x400
global_load_lds_dwordx4 v155, s[32:33] sc1
s_add_u32 s32, s32, s38
s_addc_u32 s33, s33, 0
s_mov_b32 m0, s37
s_add_u32 s37, s37, 0x1000
global_load_lds_dwordx4 v156, s[34:35] sc1
s_add_u32 s34, s34, s39
s_addc_u32 s35, s35, 0
s_mov_b32 m0, s37
s_add_u32 s37, s37, 0x1000
global_load_lds_dwordx4 v156, s[34:35] sc1
s_add_u32 s34, s34, s39
s_addc_u32 s35, s35, 0
s_mov_b32 m0, s36
s_add_u32 s36, s36, 0x400
global_load_lds_dwordx4 v8, s[32:33] sc1
s_mov_b32 m0, s36
s_add_u32 s36, s36, 0x400
global_load_lds_dwordx4 v155, s[32:33] sc1
s_add_u32 s32, s32, s38
s_addc_u32 s33, s33, 0
s_mov_b32 m0, s36
s_add_u32 s36, s36, 0x400
global_load_lds_dwordx4 v8, s[32:33] sc1
s_mov_b32 m0, s36
s_add_u32 s36, s36, 0x400
global_load_lds_dwordx4 v155, s[32:33] sc1
s_add_u32 s32, s32, s38
s_addc_u32 s33, s33, 0
s_mov_b32 m0, s36
s_add_u32 s36, s36, 0x400
global_load_lds_dwordx4 v8, s[32:33] sc1
s_mov_b32 m0, s36
s_add_u32 s36, s36, 0x400
global_load_lds_dwordx4 v155, s[32:33] sc1
s_add_u32 s32, s32, s38
s_addc_u32 s33, s33, 0
s_mov_b32 m0, s37
s_add_u32 s37, s37, 0x1000
global_load_lds_dwordx4 v156, s[34:35] sc1
s_add_u32 s34, s34, s39
s_addc_u32 s35, s35, 0
s_waitcnt vmcnt(7)
s_barrier
L_q_join:
s_cmp_eq_u32 s24, 2
s_cbranch_scc1 L_q_w2
s_cmp_eq_u32 s24, 3
s_cbranch_scc1 L_q_w3
ds_read_b128 v[92:95], v9 offset:18432
ds_read_b128 v[96:99], v157 offset:18432
ds_read_b128 v[100:103], v9 offset:36864
ds_read_b128 v[104:107], v157 offset:36864
ds_read_b128 v[108:111], v10 offset:0
ds_read_b128 v[112:115], v158 offset:0
ds_read_b128 v[116:119], v10 offset:18432
s_waitcnt vmcnt(22) lgkmcnt(6)
v_mfma_f32_16x16x32_bf16 v[36:39], a[4:7], v[92:95], 0
s_waitcnt vmcnt(18) lgkmcnt(5)
s_mul_i32 s46, s24, 320
s_lshl_b32 s62, s46, 1
v_mfma_f32_16x16x32_bf16 v[36:39], a[20:23], v[96:99], v[36:39]
s_add_u32 s46, s46, 127680
ds_read_b128 v[120:123], v158 offset:18432
s_add_u32 s62, s62, 130240
v_mfma_f32_16x16x32_bf16 v[56:59], v[92:95], a[8:11], 0
s_waitcnt vmcnt(17)
s_mov_b32 s56, 0x11111111
s_mov_b32 s57, 0x11111111
v_mfma_f32_16x16x32_bf16 v[56:59], v[96:99], a[24:27], v[56:59]
s_mov_b32 s58, 0x33333333
s_mov_b32 s59, 0x33333333
s_mov_b32 s60, 0x77777777
v_mfma_f32_16x16x32_bf16 v[16:19], a[0:3], v[92:95], 0
s_mov_b32 s61, 0x77777777
s_mul_i32 s42, s25, 73728
s_lshl_b32 s43, s26, 11
v_mfma_f32_16x16x32_bf16 v[16:19], a[16:19], v[96:99], v[16:19]
s_add_u32 s42, s42, s43
s_lshl_b32 s43, s24, 9
s_add_u32 s42, s42, s43
v_mfma_f32_16x16x32_bf16 v[76:79], a[12:15], v[92:95], 0
s_waitcnt vmcnt(16) lgkmcnt(5)
s_lshl_b32 s43, s25, 5
s_lshl_b32 s44, s26, 2
v_mfma_f32_16x16x32_bf16 v[76:79], a[28:31], v[96:99], v[76:79]
s_add_u32 s43, s43, s44
s_add_u32 s43, s43, s24
s_lshl_b32 s43, s43, 8
v_mfma_f32_16x16x32_bf16 v[40:43], a[4:7], v[100:103], 0
s_waitcnt lgkmcnt(4)
ds_read_b128 v[124:127], v9 offset:0
s_add_u32 s43, s43, 4849664
v_mfma_f32_16x16x32_bf16 v[40:43], a[20:23], v[104:107], v[40:43]
s_mul_i32 s44, s24, 3072
ds_read_b128 v[128:131], v157 offset:0
s_sub_u32 s44, 65536, s44
v_mfma_f32_16x16x32_bf16 v[60:63], v[100:103], a[8:11], 0
s_lshl_b32 s45, s24, 11
s_sub_u32 s45, 21504, s45
v_mfma_f32_16x16x32_bf16 v[60:63], v[104:107], a[24:27], v[60:63]
global_load_dwordx4 a[100:103], v7, s[30:31] offset:-3072 sc1
v_mfma_f32_16x16x32_bf16 v[20:23], a[0:3], v[100:103], 0
global_load_dwordx4 a[116:119], v7, s[30:31] offset:1024 sc1
ds_read_b128 v[132:135], v9 offset:20480
v_mfma_f32_16x16x32_bf16 v[20:23], a[16:19], v[104:107], v[20:23]
global_load_dwordx4 a[104:107], v7, s[30:31] offset:-2048 sc1
ds_read_b128 v[136:139], v157 offset:20480
v_mfma_f32_16x16x32_bf16 v[80:83], a[12:15], v[100:103], 0
global_load_dwordx4 a[120:123], v7, s[30:31] offset:2048 sc1
v_mfma_f32_16x16x32_bf16 v[80:83], a[28:31], v[104:107], v[80:83]
s_waitcnt lgkmcnt(6)
v_mfma_f32_16x16x32_bf16 v[44:47], a[4:7], v[108:111], 0
v_mfma_f32_16x16x32_bf16 v[44:47], a[20:23], v[112:115], v[44:47]
v_mfma_f32_16x16x32_bf16 v[64:67], v[108:111], a[8:11], 0
global_load_dwordx4 a[96:99], v7, s[30:31] offset:-4096 sc1
v_mfma_f32_16x16x32_bf16 v[64:67], v[112:115], a[24:27], v[64:67]
v_mfma_f32_16x16x32_bf16 v[24:27], a[0:3], v[108:111], 0
ds_read_b128 v[92:95], v9 offset:38912
v_mfma_f32_16x16x32_bf16 v[24:27], a[16:19], v[112:115], v[24:27]
ds_read_b128 v[96:99], v157 offset:38912
v_mfma_f32_16x16x32_bf16 v[84:87], a[12:15], v[108:111], 0
v_mfma_f32_16x16x32_bf16 v[84:87], a[28:31], v[112:115], v[84:87]
s_waitcnt lgkmcnt(6)
global_load_dwordx4 a[112:115], v7, s[30:31] offset:0 sc1
v_mfma_f32_16x16x32_bf16 v[48:51], a[4:7], v[116:119], 0
v_mfma_f32_16x16x32_bf16 v[48:51], a[20:23], v[120:123], v[48:51]
v_mfma_f32_16x16x32_bf16 v[68:71], v[116:119], a[8:11], 0
v_mfma_f32_16x16x32_bf16 v[68:71], v[120:123], a[24:27], v[68:71]
global_load_dwordx4 a[108:111], v7, s[30:31] offset:-1024 sc1
v_mfma_f32_16x16x32_bf16 v[28:31], a[0:3], v[116:119], 0
ds_read_b128 v[100:103], v10 offset:2048
v_mfma_f32_16x16x32_bf16 v[28:31], a[16:19], v[120:123], v[28:31]
ds_read_b128 v[104:107], v158 offset:2048
v_mfma_f32_16x16x32_bf16 v[88:91], a[12:15], v[116:119], 0
v_mfma_f32_16x16x32_bf16 v[88:91], a[28:31], v[120:123], v[88:91]
s_waitcnt lgkmcnt(6)
global_load_dwordx4 a[124:127], v7, s[30:31] offset:3072 sc1
s_add_u32 s30, s30, 0x2000
v_mfma_f32_16x16x32_bf16 v[32:35], a[4:7], v[124:127], 0
s_addc_u32 s31, s31, 0
s_mov_b32 m0, s36
s_add_u32 s36, s36, 0x400
v_mfma_f32_16x16x32_bf16 v[32:35], a[20:23], v[128:131], v[32:35]
v_mfma_f32_16x16x32_bf16 v[52:55], v[124:127], a[8:11], 0
v_mfma_f32_16x16x32_bf16 v[52:55], v[128:131], a[24:27], v[52:55]
s_waitcnt vmcnt(18) lgkmcnt(4)
v_mfma_f32_16x16x32_bf16 v[36:39], a[36:39], v[132:135], v[36:39]
global_load_lds_dwordx4 v8, s[32:33] sc1
ds_read_b128 v[108:111], v10 offset:20480
v_mfma_f32_16x16x32_bf16 v[36:39], a[52:55], v[136:139], v[36:39]
s_waitcnt vmcnt(18)
ds_read_b128 v[112:115], v158 offset:20480
s_mov_b32 m0, s36
v_mfma_f32_16x16x32_bf16 v[56:59], v[136:139], a[56:59], v[56:59]
s_add_u32 s36, s36, 0x400
v_mfma_f32_16x16x32_bf16 v[56:59], v[132:135], a[40:43], v[56:59]
v_mfma_f32_16x16x32_bf16 v[16:19], a[32:35], v[132:135], v[16:19]
global_load_lds_dwordx4 v155, s[32:33] sc1
s_add_u32 s32, s32, s38
v_mfma_f32_16x16x32_bf16 v[16:19], a[48:51], v[136:139], v[16:19]
s_waitcnt vmcnt(18)
s_addc_u32 s33, s33, 0
s_mov_b32 m0, s36
v_mfma_f32_16x16x32_bf16 v[76:79], a[60:63], v[136:139], v[76:79]
s_add_u32 s36, s36, 0x400
v_mfma_f32_16x16x32_bf16 v[76:79], a[44:47], v[132:135], v[76:79]
s_waitcnt lgkmcnt(4)
v_mfma_f32_16x16x32_bf16 v[40:43], a[36:39], v[92:95], v[40:43]
ds_read_b128 v[116:119], v9 offset:2048
v_mfma_f32_16x16x32_bf16 v[40:43], a[52:55], v[96:99], v[40:43]
global_load_lds_dwordx4 v8, s[32:33] sc1
ds_read_b128 v[120:123], v157 offset:2048
v_mfma_f32_16x16x32_bf16 v[60:63], v[96:99], a[56:59], v[60:63]
s_mov_b32 m0, s36
s_add_u32 s36, s36, 0x400
v_mfma_f32_16x16x32_bf16 v[60:63], v[92:95], a[40:43], v[60:63]
v_mfma_f32_16x16x32_bf16 v[20:23], a[32:35], v[92:95], v[20:23]
ds_read_b128 v[124:127], v9 offset:22528
v_mfma_f32_16x16x32_bf16 v[20:23], a[48:51], v[96:99], v[20:23]
global_load_lds_dwordx4 v155, s[32:33] sc1
ds_read_b128 v[128:131], v157 offset:22528
v_mfma_f32_16x16x32_bf16 v[80:83], a[60:63], v[96:99], v[80:83]
s_add_u32 s32, s32, s38
s_addc_u32 s33, s33, 0
s_mov_b32 m0, s36
v_mfma_f32_16x16x32_bf16 v[80:83], a[44:47], v[92:95], v[80:83]
s_waitcnt lgkmcnt(6)
s_add_u32 s36, s36, 0x400
v_mfma_f32_16x16x32_bf16 v[44:47], a[36:39], v[100:103], v[44:47]
v_mfma_f32_16x16x32_bf16 v[44:47], a[52:55], v[104:107], v[44:47]
v_mfma_f32_16x16x32_bf16 v[64:67], v[104:107], a[56:59], v[64:67]
global_load_lds_dwordx4 v8, s[32:33] sc1
s_mov_b32 m0, s36
v_mfma_f32_16x16x32_bf16 v[64:67], v[100:103], a[40:43], v[64:67]
s_add_u32 s36, s36, 0x400
v_mfma_f32_16x16x32_bf16 v[24:27], a[32:35], v[100:103], v[24:27]
ds_read_b128 v[132:135], v9 offset:40960
v_mfma_f32_16x16x32_bf16 v[24:27], a[48:51], v[104:107], v[24:27]
ds_read_b128 v[136:139], v157 offset:40960
v_mfma_f32_16x16x32_bf16 v[84:87], a[60:63], v[104:107], v[84:87]
global_load_lds_dwordx4 v155, s[32:33] sc1
s_add_u32 s32, s32, s38
v_mfma_f32_16x16x32_bf16 v[84:87], a[44:47], v[100:103], v[84:87]
s_waitcnt lgkmcnt(6)
s_addc_u32 s33, s33, 0
s_mov_b32 m0, s37
v_mfma_f32_16x16x32_bf16 v[48:51], a[36:39], v[108:111], v[48:51]
s_add_u32 s37, s37, 0x1000
v_mfma_f32_16x16x32_bf16 v[48:51], a[52:55], v[112:115], v[48:51]
v_mfma_f32_16x16x32_bf16 v[68:71], v[112:115], a[56:59], v[68:71]
global_load_lds_dwordx4 v156, s[34:35] sc1
s_add_u32 s34, s34, s39
v_mfma_f32_16x16x32_bf16 v[68:71], v[108:111], a[40:43], v[68:71]
s_addc_u32 s35, s35, 0
s_lshr_b32 s40, s24, 1
s_mul_i32 s41, s40, s38
v_mfma_f32_16x16x32_bf16 v[28:31], a[32:35], v[108:111], v[28:31]
s_sub_u32 s34, s34, s41
ds_read_b128 v[92:95], v10 offset:4096
s_subb_u32 s35, s35, 0
v_mfma_f32_16x16x32_bf16 v[28:31], a[48:51], v[112:115], v[28:31]
s_lshl_b32 s41, s40, 11
ds_read_b128 v[96:99], v158 offset:4096
s_sub_u32 s37, s37, s41
v_mfma_f32_16x16x32_bf16 v[88:91], a[60:63], v[112:115], v[88:91]
s_mov_b32 m0, s37
s_add_u32 s37, s37, 0x1000
v_mfma_f32_16x16x32_bf16 v[88:91], a[44:47], v[108:111], v[88:91]
s_waitcnt lgkmcnt(6)
global_load_lds_dwordx4 v156, s[34:35] sc1
s_add_u32 s34, s34, s39
v_mfma_f32_16x16x32_bf16 v[32:35], a[36:39], v[116:119], v[32:35]
s_addc_u32 s35, s35, 0
v_mfma_f32_16x16x32_bf16 v[32:35], a[52:55], v[120:123], v[32:35]
v_mfma_f32_16x16x32_bf16 v[52:55], v[120:123], a[56:59], v[52:55]
v_mfma_f32_16x16x32_bf16 v[52:55], v[116:119], a[40:43], v[52:55]
s_waitcnt vmcnt(18) lgkmcnt(4)
global_load_dwordx4 a[132:135], v7, s[30:31] offset:-3072 sc1
v_mfma_f32_16x16x32_bf16 v[36:39], a[68:71], v[124:127], v[36:39]
ds_read_b128 v[100:103], v10 offset:22528
v_mfma_f32_16x16x32_bf16 v[36:39], a[84:87], v[128:131], v[36:39]
s_waitcnt vmcnt(18)
ds_read_b128 v[104:107], v158 offset:22528
v_mfma_f32_16x16x32_bf16 v[56:59], v[128:131], a[88:91], v[56:59]
v_mfma_f32_16x16x32_bf16 v[56:59], v[124:127], a[72:75], v[56:59]
v_mfma_f32_16x16x32_bf16 v[16:19], a[64:67], v[124:127], v[16:19]
global_load_dwordx4 a[148:151], v7, s[30:31] offset:1024 sc1
v_mfma_f32_16x16x32_bf16 v[16:19], a[80:83], v[128:131], v[16:19]
s_waitcnt vmcnt(18)
v_mfma_f32_16x16x32_bf16 v[76:79], a[92:95], v[128:131], v[76:79]
v_mfma_f32_16x16x32_bf16 v[76:79], a[76:79], v[124:127], v[76:79]
s_waitcnt lgkmcnt(4)
v_mfma_f32_16x16x32_bf16 v[40:43], a[68:71], v[132:135], v[40:43]
global_load_dwordx4 a[136:139], v7, s[30:31] offset:-2048 sc1
ds_read_b128 v[108:111], v9 offset:4096
v_mfma_f32_16x16x32_bf16 v[40:43], a[84:87], v[136:139], v[40:43]
ds_read_b128 v[112:115], v157 offset:4096
v_mfma_f32_16x16x32_bf16 v[60:63], v[136:139], a[88:91], v[60:63]
v_mfma_f32_16x16x32_bf16 v[60:63], v[132:135], a[72:75], v[60:63]
v_mfma_f32_16x16x32_bf16 v[20:23], a[64:67], v[132:135], v[20:23]
global_load_dwordx4 a[152:155], v7, s[30:31] offset:2048 sc1
s_waitcnt vmcnt(20)
s_barrier
ds_read_b128 v[116:119], v9 offset:24576
v_mfma_f32_16x16x32_bf16 v[20:23], a[80:83], v[136:139], v[20:23]
ds_read_b128 v[120:123], v157 offset:24576
v_mfma_f32_16x16x32_bf16 v[80:83], a[92:95], v[136:139], v[80:83]
v_mfma_f32_16x16x32_bf16 v[80:83], a[76:79], v[132:135], v[80:83]
s_waitcnt lgkmcnt(6)
v_mfma_f32_16x16x32_bf16 v[44:47], a[68:71], v[92:95], v[44:47]
v_mfma_f32_16x16x32_bf16 v[44:47], a[84:87], v[96:99], v[44:47]
global_load_dwordx4 a[128:131], v7, s[30:31] offset:-4096 sc1
v_mfma_f32_16x16x32_bf16 v[64:67], v[96:99], a[88:91], v[64:67]
v_mfma_f32_16x16x32_bf16 v[64:67], v[92:95], a[72:75], v[64:67]
v_mfma_f32_16x16x32_bf16 v[24:27], a[64:67], v[92:95], v[24:27]
ds_read_b128 v[124:127], v9 offset:43008
v_mfma_f32_16x16x32_bf16 v[24:27], a[80:83], v[96:99], v[24:27]
global_load_dwordx4 a[144:147], v7, s[30:31] offset:0 sc1
ds_read_b128 v[128:131], v157 offset:43008
v_mfma_f32_16x16x32_bf16 v[84:87], a[92:95], v[96:99], v[84:87]
v_mfma_f32_16x16x32_bf16 v[84:87], a[76:79], v[92:95], v[84:87]
s_waitcnt lgkmcnt(6)
v_mfma_f32_16x16x32_bf16 v[48:51], a[68:71], v[100:103], v[48:51]
v_mfma_f32_16x16x32_bf16 v[48:51], a[84:87], v[104:107], v[48:51]
v_mfma_f32_16x16x32_bf16 v[68:71], v[104:107], a[88:91], v[68:71]
global_load_dwordx4 a[140:143], v7, s[30:31] offset:-1024 sc1
v_mfma_f32_16x16x32_bf16 v[68:71], v[100:103], a[72:75], v[68:71]
v_mfma_f32_16x16x32_bf16 v[28:31], a[64:67], v[100:103], v[28:31]
ds_read_b128 v[132:135], v10 offset:6144
v_mfma_f32_16x16x32_bf16 v[28:31], a[80:83], v[104:107], v[28:31]
ds_read_b128 v[136:139], v158 offset:6144
v_mfma_f32_16x16x32_bf16 v[88:91], a[92:95], v[104:107], v[88:91]
global_load_dwordx4 a[156:159], v7, s[30:31] offset:3072 sc1
s_add_u32 s30, s30, 0x2000
v_mfma_f32_16x16x32_bf16 v[88:91], a[76:79], v[100:103], v[88:91]
s_waitcnt lgkmcnt(6)
s_addc_u32 s31, s31, 0
v_mfma_f32_16x16x32_bf16 v[32:35], a[68:71], v[108:111], v[32:35]
v_mfma_f32_16x16x32_bf16 v[32:35], a[84:87], v[112:115], v[32:35]
v_mfma_f32_16x16x32_bf16 v[52:55], v[112:115], a[88:91], v[52:55]
v_mfma_f32_16x16x32_bf16 v[52:55], v[108:111], a[72:75], v[52:55]
s_waitcnt vmcnt(22) lgkmcnt(4)
global_load_dwordx4 a[164:167], v7, s[30:31] offset:-3072 sc1
v_mfma_f32_16x16x32_bf16 v[36:39], a[100:103], v[116:119], v[36:39]
ds_read_b128 v[92:95], v10 offset:24576
v_mfma_f32_16x16x32_bf16 v[36:39], a[116:119], v[120:123], v[36:39]
s_waitcnt vmcnt(21)
ds_read_b128 v[96:99], v158 offset:24576
v_mfma_f32_16x16x32_bf16 v[56:59], v[120:123], a[120:123], v[56:59]
v_mfma_f32_16x16x32_bf16 v[56:59], v[116:119], a[104:107], v[56:59]
s_waitcnt vmcnt(19)
global_load_dwordx4 a[180:183], v7, s[30:31] offset:1024 sc1
v_mfma_f32_16x16x32_bf16 v[16:19], a[96:99], v[116:119], v[16:19]
v_mfma_f32_16x16x32_bf16 v[16:19], a[112:115], v[120:123], v[16:19]
s_waitcnt vmcnt(18)
v_mfma_f32_16x16x32_bf16 v[76:79], a[124:127], v[120:123], v[76:79]
v_mfma_f32_16x16x32_bf16 v[76:79], a[108:111], v[116:119], v[76:79]
s_waitcnt lgkmcnt(4)
global_load_dwordx4 a[168:171], v7, s[30:31] offset:-2048 sc1
v_mfma_f32_16x16x32_bf16 v[40:43], a[100:103], v[124:127], v[40:43]
ds_read_b128 v[100:103], v9 offset:6144
v_mfma_f32_16x16x32_bf16 v[40:43], a[116:119], v[128:131], v[40:43]
ds_read_b128 v[104:107], v157 offset:6144
v_mfma_f32_16x16x32_bf16 v[60:63], v[128:131], a[120:123], v[60:63]
v_mfma_f32_16x16x32_bf16 v[60:63], v[124:127], a[104:107], v[60:63]
v_mfma_f32_16x16x32_bf16 v[20:23], a[96:99], v[124:127], v[20:23]
global_load_dwordx4 a[184:187], v7, s[30:31] offset:2048 sc1
ds_read_b128 v[108:111], v9 offset:26624
v_mfma_f32_16x16x32_bf16 v[20:23], a[112:115], v[128:131], v[20:23]
ds_read_b128 v[112:115], v157 offset:26624
v_mfma_f32_16x16x32_bf16 v[80:83], a[124:127], v[128:131], v[80:83]
v_mfma_f32_16x16x32_bf16 v[80:83], a[108:111], v[124:127], v[80:83]
s_waitcnt lgkmcnt(6)
v_mfma_f32_16x16x32_bf16 v[44:47], a[100:103], v[132:135], v[44:47]
global_load_dwordx4 a[160:163], v7, s[30:31] offset:-4096 sc1
v_mfma_f32_16x16x32_bf16 v[44:47], a[116:119], v[136:139], v[44:47]
v_mfma_f32_16x16x32_bf16 v[64:67], v[136:139], a[120:123], v[64:67]
v_mfma_f32_16x16x32_bf16 v[64:67], v[132:135], a[104:107], v[64:67]
v_mfma_f32_16x16x32_bf16 v[24:27], a[96:99], v[132:135], v[24:27]
ds_read_b128 v[116:119], v9 offset:45056
v_mfma_f32_16x16x32_bf16 v[24:27], a[112:115], v[136:139], v[24:27]
global_load_dwordx4 a[176:179], v7, s[30:31] offset:0 sc1
ds_read_b128 v[120:123], v157 offset:45056
v_mfma_f32_16x16x32_bf16 v[84:87], a[124:127], v[136:139], v[84:87]
v_mfma_f32_16x16x32_bf16 v[84:87], a[108:111], v[132:135], v[84:87]
s_waitcnt lgkmcnt(6)
v_mfma_f32_16x16x32_bf16 v[48:51], a[100:103], v[92:95], v[48:51]
v_mfma_f32_16x16x32_bf16 v[48:51], a[116:119], v[96:99], v[48:51]
global_load_dwordx4 a[172:175], v7, s[30:31] offset:-1024 sc1
v_mfma_f32_16x16x32_bf16 v[68:71], v[96:99], a[120:123], v[68:71]
v_mfma_f32_16x16x32_bf16 v[68:71], v[92:95], a[104:107], v[68:71]
v_mfma_f32_16x16x32_bf16 v[28:31], a[96:99], v[92:95], v[28:31]
ds_read_b128 v[124:127], v10 offset:8192
v_mfma_f32_16x16x32_bf16 v[28:31], a[112:115], v[96:99], v[28:31]
ds_read_b128 v[128:131], v158 offset:8192
v_mfma_f32_16x16x32_bf16 v[88:91], a[124:127], v[96:99], v[88:91]
global_load_dwordx4 a[188:191], v7, s[30:31] offset:3072 sc1
s_add_u32 s30, s30, 0x2000
v_mfma_f32_16x16x32_bf16 v[88:91], a[108:111], v[92:95], v[88:91]
s_waitcnt lgkmcnt(6)
s_addc_u32 s31, s31, 0
v_mfma_f32_16x16x32_bf16 v[32:35], a[100:103], v[100:103], v[32:35]
v_mfma_f32_16x16x32_bf16 v[32:35], a[116:119], v[104:107], v[32:35]
v_mfma_f32_16x16x32_bf16 v[52:55], v[104:107], a[120:123], v[52:55]
global_load_dwordx4 a[196:199], v7, s[30:31] offset:-3072 sc1
v_mfma_f32_16x16x32_bf16 v[52:55], v[100:103], a[104:107], v[52:55]
s_waitcnt vmcnt(15) lgkmcnt(4)
v_mfma_f32_16x16x32_bf16 v[36:39], a[132:135], v[108:111], v[36:39]
ds_read_b128 v[132:135], v10 offset:26624
v_mfma_f32_16x16x32_bf16 v[36:39], a[148:151], v[112:115], v[36:39]
s_waitcnt vmcnt(13)
ds_read_b128 v[136:139], v158 offset:26624
v_mfma_f32_16x16x32_bf16 v[56:59], v[112:115], a[152:155], v[56:59]
global_load_dwordx4 a[212:215], v7, s[30:31] offset:1024 sc1
v_mfma_f32_16x16x32_bf16 v[56:59], v[108:111], a[136:139], v[56:59]
s_waitcnt vmcnt(12)
v_mfma_f32_16x16x32_bf16 v[16:19], a[128:131], v[108:111], v[16:19]
v_mfma_f32_16x16x32_bf16 v[16:19], a[144:147], v[112:115], v[16:19]
s_waitcnt vmcnt(10)
v_mfma_f32_16x16x32_bf16 v[76:79], a[156:159], v[112:115], v[76:79]
v_mfma_f32_16x16x32_bf16 v[76:79], a[140:143], v[108:111], v[76:79]
s_waitcnt lgkmcnt(4)
global_load_dwordx4 a[200:203], v7, s[30:31] offset:-2048 sc1
v_mfma_f32_16x16x32_bf16 v[40:43], a[132:135], v[116:119], v[40:43]
ds_read_b128 v[92:95], v9 offset:8192
v_mfma_f32_16x16x32_bf16 v[40:43], a[148:151], v[120:123], v[40:43]
ds_read_b128 v[96:99], v157 offset:8192
v_mfma_f32_16x16x32_bf16 v[60:63], v[120:123], a[152:155], v[60:63]
v_mfma_f32_16x16x32_bf16 v[60:63], v[116:119], a[136:139], v[60:63]
global_load_dwordx4 a[216:219], v7, s[30:31] offset:2048 sc1
v_mfma_f32_16x16x32_bf16 v[20:23], a[128:131], v[116:119], v[20:23]
ds_read_b128 v[100:103], v9 offset:28672
v_mfma_f32_16x16x32_bf16 v[20:23], a[144:147], v[120:123], v[20:23]
ds_read_b128 v[104:107], v157 offset:28672
v_mfma_f32_16x16x32_bf16 v[80:83], a[156:159], v[120:123], v[80:83]
v_mfma_f32_16x16x32_bf16 v[80:83], a[140:143], v[116:119], v[80:83]
s_waitcnt lgkmcnt(6)
v_mfma_f32_16x16x32_bf16 v[44:47], a[132:135], v[124:127], v[44:47]
global_load_dwordx4 a[192:195], v7, s[30:31] offset:-4096 sc1
v_mfma_f32_16x16x32_bf16 v[44:47], a[148:151], v[128:131], v[44:47]
v_mfma_f32_16x16x32_bf16 v[64:67], v[128:131], a[152:155], v[64:67]
v_mfma_f32_16x16x32_bf16 v[64:67], v[124:127], a[136:139], v[64:67]
v_mfma_f32_16x16x32_bf16 v[24:27], a[128:131], v[124:127], v[24:27]
global_load_dwordx4 a[208:211], v7, s[30:31] offset:0 sc1
ds_read_b128 v[108:111], v9 offset:47104
v_mfma_f32_16x16x32_bf16 v[24:27], a[144:147], v[128:131], v[24:27]
ds_read_b128 v[112:115], v157 offset:47104
v_mfma_f32_16x16x32_bf16 v[84:87], a[156:159], v[128:131], v[84:87]
v_mfma_f32_16x16x32_bf16 v[84:87], a[140:143], v[124:127], v[84:87]
s_waitcnt lgkmcnt(6)
v_mfma_f32_16x16x32_bf16 v[48:51], a[132:135], v[132:135], v[48:51]
global_load_dwordx4 a[204:207], v7, s[30:31] offset:-1024 sc1
v_mfma_f32_16x16x32_bf16 v[48:51], a[148:151], v[136:139], v[48:51]
v_mfma_f32_16x16x32_bf16 v[68:71], v[136:139], a[152:155], v[68:71]
v_mfma_f32_16x16x32_bf16 v[68:71], v[132:135], a[136:139], v[68:71]
v_mfma_f32_16x16x32_bf16 v[28:31], a[128:131], v[132:135], v[28:31]
ds_read_b128 v[116:119], v10 offset:10240
v_mfma_f32_16x16x32_bf16 v[28:31], a[144:147], v[136:139], v[28:31]
global_load_dwordx4 a[220:223], v7, s[30:31] offset:3072 sc1
ds_read_b128 v[120:123], v158 offset:10240
v_mfma_f32_16x16x32_bf16 v[88:91], a[156:159], v[136:139], v[88:91]
s_add_u32 s30, s30, 0x2000
s_addc_u32 s31, s31, 0
v_mfma_f32_16x16x32_bf16 v[88:91], a[140:143], v[132:135], v[88:91]
s_waitcnt lgkmcnt(6)
v_mfma_f32_16x16x32_bf16 v[32:35], a[132:135], v[92:95], v[32:35]
v_mfma_f32_16x16x32_bf16 v[32:35], a[148:151], v[96:99], v[32:35]
global_load_dword v152, v153, s[22:23] sc1
v_mfma_f32_16x16x32_bf16 v[52:55], v[96:99], a[152:155], v[52:55]
v_mfma_f32_16x16x32_bf16 v[52:55], v[92:95], a[136:139], v[52:55]
s_waitcnt vmcnt(15) lgkmcnt(4)
v_mfma_f32_16x16x32_bf16 v[36:39], a[164:167], v[100:103], v[36:39]
ds_read_b128 v[124:127], v10 offset:28672
v_mfma_f32_16x16x32_bf16 v[36:39], a[180:183], v[104:107], v[36:39]
s_waitcnt vmcnt(13)
ds_read_b128 v[128:131], v158 offset:28672
v_mfma_f32_16x16x32_bf16 v[56:59], v[104:107], a[184:187], v[56:59]
global_load_dwordx4 a[228:231], v7, s[30:31] offset:-3072 sc1
v_mfma_f32_16x16x32_bf16 v[56:59], v[100:103], a[168:171], v[56:59]
s_waitcnt vmcnt(12)
v_mfma_f32_16x16x32_bf16 v[16:19], a[160:163], v[100:103], v[16:19]
v_mfma_f32_16x16x32_bf16 v[16:19], a[176:179], v[104:107], v[16:19]
s_waitcnt vmcnt(10)
v_mfma_f32_16x16x32_bf16 v[76:79], a[188:191], v[104:107], v[76:79]
global_load_dwordx4 a[244:247], v7, s[30:31] offset:1024 sc1
v_mfma_f32_16x16x32_bf16 v[76:79], a[172:175], v[100:103], v[76:79]
s_waitcnt lgkmcnt(4)
v_mfma_f32_16x16x32_bf16 v[40:43], a[164:167], v[108:111], v[40:43]
ds_read_b128 v[132:135], v9 offset:10240
v_mfma_f32_16x16x32_bf16 v[40:43], a[180:183], v[112:115], v[40:43]
ds_read_b128 v[136:139], v157 offset:10240
v_mfma_f32_16x16x32_bf16 v[60:63], v[112:115], a[184:187], v[60:63]
v_mfma_f32_16x16x32_bf16 v[60:63], v[108:111], a[168:171], v[60:63]
global_load_dwordx4 a[232:235], v7, s[30:31] offset:-2048 sc1
v_mfma_f32_16x16x32_bf16 v[20:23], a[160:163], v[108:111], v[20:23]
s_barrier
ds_read_b128 v[92:95], v9 offset:30720
v_mfma_f32_16x16x32_bf16 v[20:23], a[176:179], v[112:115], v[20:23]
ds_read_b128 v[96:99], v157 offset:30720
v_mfma_f32_16x16x32_bf16 v[80:83], a[188:191], v[112:115], v[80:83]
v_mfma_f32_16x16x32_bf16 v[80:83], a[172:175], v[108:111], v[80:83]
s_waitcnt lgkmcnt(6)
global_load_dwordx4 a[248:251], v7, s[30:31] offset:2048 sc1
v_mfma_f32_16x16x32_bf16 v[44:47], a[164:167], v[116:119], v[44:47]
v_mfma_f32_16x16x32_bf16 v[44:47], a[180:183], v[120:123], v[44:47]
v_mfma_f32_16x16x32_bf16 v[64:67], v[120:123], a[184:187], v[64:67]
v_mfma_f32_16x16x32_bf16 v[64:67], v[116:119], a[168:171], v[64:67]
global_load_dwordx4 a[224:227], v7, s[30:31] offset:-4096 sc1
v_mfma_f32_16x16x32_bf16 v[24:27], a[160:163], v[116:119], v[24:27]
ds_read_b128 v[100:103], v9 offset:49152
v_mfma_f32_16x16x32_bf16 v[24:27], a[176:179], v[120:123], v[24:27]
ds_read_b128 v[104:107], v157 offset:49152
v_mfma_f32_16x16x32_bf16 v[84:87], a[188:191], v[120:123], v[84:87]
v_mfma_f32_16x16x32_bf16 v[84:87], a[172:175], v[116:119], v[84:87]
s_waitcnt lgkmcnt(6)
v_mfma_f32_16x16x32_bf16 v[48:51], a[164:167], v[124:127], v[48:51]
global_load_dwordx4 a[240:243], v7, s[30:31] offset:0 sc1
v_mfma_f32_16x16x32_bf16 v[48:51], a[180:183], v[128:131], v[48:51]
v_mfma_f32_16x16x32_bf16 v[68:71], v[128:131], a[184:187], v[68:71]
v_mfma_f32_16x16x32_bf16 v[68:71], v[124:127], a[168:171], v[68:71]
v_mfma_f32_16x16x32_bf16 v[28:31], a[160:163], v[124:127], v[28:31]
global_load_dwordx4 a[236:239], v7, s[30:31] offset:-1024 sc1
ds_read_b128 v[108:111], v10 offset:12288
v_mfma_f32_16x16x32_bf16 v[28:31], a[176:179], v[128:131], v[28:31]
ds_read_b128 v[112:115], v158 offset:12288
v_mfma_f32_16x16x32_bf16 v[88:91], a[188:191], v[128:131], v[88:91]
v_mfma_f32_16x16x32_bf16 v[88:91], a[172:175], v[124:127], v[88:91]
s_waitcnt lgkmcnt(6)
v_mfma_f32_16x16x32_bf16 v[32:35], a[164:167], v[132:135], v[32:35]
v_mfma_f32_16x16x32_bf16 v[32:35], a[180:183], v[136:139], v[32:35]
global_load_dwordx4 a[252:255], v7, s[30:31] offset:3072 sc1
s_add_u32 s30, s30, 0x2000
v_mfma_f32_16x16x32_bf16 v[52:55], v[136:139], a[184:187], v[52:55]
s_addc_u32 s31, s31, 0
v_mfma_f32_16x16x32_bf16 v[52:55], v[132:135], a[168:171], v[52:55]
s_waitcnt vmcnt(15) lgkmcnt(4)
v_mfma_f32_16x16x32_bf16 v[36:39], a[196:199], v[92:95], v[36:39]
ds_read_b128 v[116:119], v10 offset:30720
v_mfma_f32_16x16x32_bf16 v[36:39], a[212:215], v[96:99], v[36:39]
s_waitcnt vmcnt(13)
global_load_dwordx4 v[196:199], v7, s[30:31] offset:-3072 sc1
ds_read_b128 v[120:123], v158 offset:30720
v_mfma_f32_16x16x32_bf16 v[56:59], v[96:99], a[216:219], v[56:59]
v_mfma_f32_16x16x32_bf16 v[56:59], v[92:95], a[200:203], v[56:59]
s_waitcnt vmcnt(12)
v_mfma_f32_16x16x32_bf16 v[16:19], a[192:195], v[92:95], v[16:19]
v_mfma_f32_16x16x32_bf16 v[16:19], a[208:211], v[96:99], v[16:19]
s_waitcnt vmcnt(10)
v_mfma_f32_16x16x32_bf16 v[76:79], a[220:223], v[96:99], v[76:79]
global_load_dwordx4 v[212:215], v7, s[30:31] offset:1024 sc1
v_mfma_f32_16x16x32_bf16 v[76:79], a[204:207], v[92:95], v[76:79]
s_waitcnt lgkmcnt(4)
v_mfma_f32_16x16x32_bf16 v[40:43], a[196:199], v[100:103], v[40:43]
ds_read_b128 v[124:127], v9 offset:12288
v_mfma_f32_16x16x32_bf16 v[40:43], a[212:215], v[104:107], v[40:43]
ds_read_b128 v[128:131], v157 offset:12288
v_mfma_f32_16x16x32_bf16 v[60:63], v[104:107], a[216:219], v[60:63]
global_load_dwordx4 v[200:203], v7, s[30:31] offset:-2048 sc1
v_mfma_f32_16x16x32_bf16 v[60:63], v[100:103], a[200:203], v[60:63]
v_mfma_f32_16x16x32_bf16 v[20:23], a[192:195], v[100:103], v[20:23]
ds_read_b128 v[132:135], v9 offset:32768
ds_read_b64 v[244:245], v13
v_mfma_f32_16x16x32_bf16 v[20:23], a[208:211], v[104:107], v[20:23]
ds_read_b128 v[136:139], v157 offset:32768
ds_read_b64 v[246:247], v14
v_mfma_f32_16x16x32_bf16 v[80:83], a[220:223], v[104:107], v[80:83]
global_load_dwordx4 v[216:219], v7, s[30:31] offset:2048 sc1
ds_read_b64 v[248:249], v159
v_mfma_f32_16x16x32_bf16 v[80:83], a[204:207], v[100:103], v[80:83]
s_waitcnt lgkmcnt(9)
ds_read_b64 v[250:251], v160
v_mfma_f32_16x16x32_bf16 v[44:47], a[196:199], v[108:111], v[44:47]
ds_read_b64 v[252:253], v15
v_mfma_f32_16x16x32_bf16 v[44:47], a[212:215], v[112:115], v[44:47]
v_lshrrev_b32 v2, 5, v1
v_mfma_f32_16x16x32_bf16 v[64:67], v[112:115], a[216:219], v[64:67]
v_lshl_add_u32 v2, v2, 3, v1
v_mfma_f32_16x16x32_bf16 v[64:67], v[108:111], a[200:203], v[64:67]
global_load_dwordx4 v[192:195], v7, s[30:31] offset:-4096 sc1
v_mul_u32_u24 v3, 144, v2
v_mfma_f32_16x16x32_bf16 v[24:27], a[192:195], v[108:111], v[24:27]
ds_read_b128 v[92:95], v9 offset:51200
v_add_u32 v13, s47, v3
v_mfma_f32_16x16x32_bf16 v[24:27], a[208:211], v[112:115], v[24:27]
ds_read_b128 v[96:99], v157 offset:51200
v_lshl_add_u32 v14, v2, 2, s46
v_mfma_f32_16x16x32_bf16 v[84:87], a[220:223], v[112:115], v[84:87]
v_and_b32 v243, -3, v2
v_mfma_f32_16x16x32_bf16 v[84:87], a[204:207], v[108:111], v[84:87]
s_waitcnt lgkmcnt(11)
global_load_dwordx4 v[208:211], v7, s[30:31] offset:0 sc1
v_lshl_add_u32 v243, v243, 3, s62
v_mfma_f32_16x16x32_bf16 v[48:51], a[196:199], v[116:119], v[48:51]
v_lshlrev_b32 v2, 2, v2
v_mfma_f32_16x16x32_bf16 v[48:51], a[212:215], v[120:123], v[48:51]
v_and_b32 v3, -16, v2
v_mfma_f32_16x16x32_bf16 v[68:71], v[120:123], a[216:219], v[68:71]
v_add_u32 v3, 127360, v3
v_mfma_f32_16x16x32_bf16 v[68:71], v[116:119], a[200:203], v[68:71]
v_add_u32 v2, 126752, v2
v_mfma_f32_16x16x32_bf16 v[28:31], a[192:195], v[116:119], v[28:31]
global_load_dwordx4 v[204:207], v7, s[30:31] offset:-1024 sc1
ds_read_b128 v[100:103], v10 offset:14336
v_mfma_f32_16x16x32_bf16 v[28:31], a[208:211], v[120:123], v[28:31]
ds_read_b128 v[104:107], v158 offset:14336
v_lshlrev_b32 v4, 2, v12
v_mfma_f32_16x16x32_bf16 v[88:91], a[220:223], v[120:123], v[88:91]
v_add_u32 v4, 126720, v4
v_mfma_f32_16x16x32_bf16 v[88:91], a[204:207], v[116:119], v[88:91]
s_waitcnt lgkmcnt(11)
v_lshl_add_u32 v242, v1, 2, s43
v_mfma_f32_16x16x32_bf16 v[32:35], a[196:199], v[124:127], v[32:35]
global_load_dwordx4 v[220:223], v7, s[30:31] offset:3072 sc1
s_add_u32 s30, s30, 0x2000
v_mfma_f32_16x16x32_bf16 v[32:35], a[212:215], v[128:131], v[32:35]
s_addc_u32 s31, s31, 0
s_mul_i32 s40, s26, 94208
s_mul_i32 s41, s24, 6144
v_mfma_f32_16x16x32_bf16 v[52:55], v[128:131], a[216:219], v[52:55]
s_add_u32 s40, s40, s41
s_add_u32 s40, s40, 2359296
s_add_u32 s34, s22, s40
v_mfma_f32_16x16x32_bf16 v[52:55], v[124:127], a[200:203], v[52:55]
s_waitcnt vmcnt(14) lgkmcnt(8)
s_addc_u32 s35, s23, 0
s_add_u32 m0, s41, 137216
v_mfma_f32_16x16x32_bf16 v[36:39], a[228:231], v[132:135], v[36:39]
s_lshl_b32 s40, s26, 2
ds_read_b128 v[108:111], v10 offset:32768
s_add_u32 s40, s40, s24
v_mfma_f32_16x16x32_bf16 v[36:39], a[244:247], v[136:139], v[36:39]
s_waitcnt vmcnt(12)
ds_read_b128 v[112:115], v158 offset:32768
s_mul_i32 s40, s40, 331776
v_mfma_f32_16x16x32_bf16 v[56:59], v[136:139], a[248:251], v[56:59]
s_add_u32 s40, s40, 3116032
s_add_u32 s30, s22, s40
s_addc_u32 s31, s23, 0
v_mfma_f32_16x16x32_bf16 v[56:59], v[132:135], a[232:235], v[56:59]
s_waitcnt vmcnt(10)
s_mov_b32 s10, s30
s_mov_b32 s11, s31
v_mfma_f32_16x16x32_bf16 v[16:19], a[224:227], v[132:135], v[16:19]
s_and_b32 s8, s25, 7
s_add_u32 s9, s8, 2
s_and_b32 s9, s9, 7
v_mfma_f32_16x16x32_bf16 v[16:19], a[240:243], v[136:139], v[16:19]
s_waitcnt vmcnt(8)
s_add_u32 s8, s8, 1
s_cmp_gt_u32 s8, 6
v_mfma_f32_16x16x32_bf16 v[76:79], a[252:255], v[136:139], v[76:79]
s_cselect_b32 s8, 63, s8
s_add_u32 s9, s9, 11
s_cmp_gt_u32 s9, 15
v_mfma_f32_16x16x32_bf16 v[76:79], a[236:239], v[132:135], v[76:79]
s_waitcnt lgkmcnt(4)
s_cselect_b32 s9, 63, s9
v_mul_u32_u24 v241, 18432, v5
v_mfma_f32_16x16x32_bf16 v[40:43], a[228:231], v[92:95], v[40:43]
v_cmp_ne_u32 vcc, v152, v154
s_cbranch_vccnz L_rdy_s_19
L_rdy_b_20:
ds_read_b128 v[116:119], v9 offset:14336
v_mfma_f32_16x16x32_bf16 v[40:43], a[244:247], v[96:99], v[40:43]
global_load_lds_dwordx4 v7, s[34:35] offset:0 sc1
ds_read_b128 v[120:123], v157 offset:14336
v_mfma_f32_16x16x32_bf16 v[60:63], v[96:99], a[248:251], v[60:63]
global_load_lds_dwordx4 v7, s[34:35] offset:1024 sc1
v_lshl_add_u32 v241, v6, 4, v241
v_mfma_f32_16x16x32_bf16 v[60:63], v[92:95], a[232:235], v[60:63]
global_load_lds_dwordx4 v7, s[34:35] offset:2048 sc1
s_add_u32 m0, m0, 0xc00
v_mfma_f32_16x16x32_bf16 v[20:23], a[224:227], v[92:95], v[20:23]
s_add_u32 s34, s34, 0xc00
ds_read_b128 v[124:127], v9 offset:34816
s_addc_u32 s35, s35, 0
v_mfma_f32_16x16x32_bf16 v[20:23], a[240:243], v[96:99], v[20:23]
global_load_lds_dwordx4 v7, s[34:35] offset:0 sc1
ds_read_b128 v[128:131], v157 offset:34816
v_mfma_f32_16x16x32_bf16 v[80:83], a[252:255], v[96:99], v[80:83]
v_add_u32 v15, s44, v7
v_mfma_f32_16x16x32_bf16 v[80:83], a[236:239], v[92:95], v[80:83]
s_waitcnt lgkmcnt(6)
v_add_u32 v241, s42, v241
v_mfma_f32_16x16x32_bf16 v[44:47], a[228:231], v[100:103], v[44:47]
global_load_lds_dwordx4 v7, s[34:35] offset:1024 sc1
v_mov_b32 v232, 0xffff
v_mfma_f32_16x16x32_bf16 v[44:47], a[244:247], v[104:107], v[44:47]
v_cndmask_b32 v230, -1, v232, s[56:57]
v_mfma_f32_16x16x32_bf16 v[64:67], v[104:107], a[248:251], v[64:67]
v_cndmask_b32 v231, -1, v232, s[60:61]
v_mfma_f32_16x16x32_bf16 v[64:67], v[100:103], a[232:235], v[64:67]
v_cndmask_b32 v231, v231, 0, s[58:59]
v_mfma_f32_16x16x32_bf16 v[24:27], a[224:227], v[100:103], v[24:27]
global_load_lds_dwordx4 v7, s[34:35] offset:2048 sc1
ds_read_b128 v[132:135], v9 offset:53248
v_mfma_f32_16x16x32_bf16 v[24:27], a[240:243], v[104:107], v[24:27]
s_add_u32 s34, s34, s45
ds_read_b128 v[136:139], v157 offset:53248
s_addc_u32 s35, s35, 0
v_mfma_f32_16x16x32_bf16 v[84:87], a[252:255], v[104:107], v[84:87]
s_lshl_b32 s41, s24, 10
s_add_u32 m0, s41, 161792
v_mfma_f32_16x16x32_bf16 v[84:87], a[236:239], v[100:103], v[84:87]
s_waitcnt lgkmcnt(6)
v_mfma_f32_16x16x32_bf16 v[48:51], a[228:231], v[108:111], v[48:51]
global_load_dwordx4 a[0:3], v7, s[30:31] offset:-3072 sc1
v_mfma_f32_16x16x32_bf16 v[48:51], a[244:247], v[112:115], v[48:51]
v_mfma_f32_16x16x32_bf16 v[68:71], v[112:115], a[248:251], v[68:71]
v_mfma_f32_16x16x32_bf16 v[68:71], v[108:111], a[232:235], v[68:71]
v_mfma_f32_16x16x32_bf16 v[28:31], a[224:227], v[108:111], v[28:31]
global_load_dwordx4 a[4:7], v7, s[30:31] offset:-2048 sc1
ds_read_b128 v[92:95], v10 offset:16384
v_mfma_f32_16x16x32_bf16 v[28:31], a[240:243], v[112:115], v[28:31]
ds_read_b128 v[96:99], v158 offset:16384
v_mfma_f32_16x16x32_bf16 v[88:91], a[252:255], v[112:115], v[88:91]
v_mfma_f32_16x16x32_bf16 v[88:91], a[236:239], v[108:111], v[88:91]
s_waitcnt lgkmcnt(6)
v_mfma_f32_16x16x32_bf16 v[32:35], a[228:231], v[116:119], v[32:35]
global_load_dwordx4 a[8:11], v7, s[30:31] offset:-1024 sc1
v_mfma_f32_16x16x32_bf16 v[32:35], a[244:247], v[120:123], v[32:35]
v_mfma_f32_16x16x32_bf16 v[52:55], v[120:123], a[248:251], v[52:55]
v_mfma_f32_16x16x32_bf16 v[52:55], v[116:119], a[232:235], v[52:55]
s_waitcnt vmcnt(15) lgkmcnt(4)
v_mfma_f32_16x16x32_bf16 v[36:39], v[196:199], v[124:127], v[36:39]
global_load_dwordx4 a[12:15], v7, s[30:31] offset:0 sc1
ds_read_b128 v[100:103], v10 offset:34816
v_mfma_f32_16x16x32_bf16 v[36:39], v[212:215], v[128:131], v[36:39]
s_waitcnt vmcnt(14)
ds_read_b128 v[104:107], v158 offset:34816
v_mfma_f32_16x16x32_bf16 v[56:59], v[128:131], v[216:219], v[56:59]
v_mfma_f32_16x16x32_bf16 v[56:59], v[124:127], v[200:203], v[56:59]
s_waitcnt vmcnt(12)
v_mfma_f32_16x16x32_bf16 v[16:19], v[192:195], v[124:127], v[16:19]
global_load_dwordx4 a[16:19], v7, s[30:31] offset:1024 sc1
v_mfma_f32_16x16x32_bf16 v[16:19], v[208:211], v[128:131], v[16:19]
s_waitcnt vmcnt(11)
v_cvt_pk_bf16_f32 v140, v36, v37
v_cvt_pk_bf16_f32 v141, v38, v39
v_mfma_f32_16x16x32_bf16 v[76:79], v[220:223], v[128:131], v[76:79]
ds_write_b64 v11, v[140:141] offset:12672
v_mfma_f32_16x16x32_bf16 v[76:79], v[204:207], v[124:127], v[76:79]
s_waitcnt lgkmcnt(5)
v_cvt_pk_bf16_f32 v142, v56, v57
v_cvt_pk_bf16_f32 v143, v58, v59
v_mfma_f32_16x16x32_bf16 v[40:43], v[196:199], v[132:135], v[40:43]
global_load_dwordx4 a[20:23], v7, s[30:31] offset:2048 sc1
ds_read_b128 v[108:111], v9 offset:16384
v_mfma_f32_16x16x32_bf16 v[40:43], v[212:215], v[136:139], v[40:43]
s_add_u32 s30, s30, 0x1800
ds_read_b128 v[112:115], v157 offset:16384
s_addc_u32 s31, s31, 0
v_mfma_f32_16x16x32_bf16 v[60:63], v[136:139], v[216:219], v[60:63]
ds_write_b64 v165, v[142:143] offset:24192
v_mfma_f32_16x16x32_bf16 v[60:63], v[132:135], v[200:203], v[60:63]
v_cvt_pk_bf16_f32 v144, v16, v17
v_cvt_pk_bf16_f32 v145, v18, v19
v_mfma_f32_16x16x32_bf16 v[20:23], v[192:195], v[132:135], v[20:23]
global_load_dwordx4 a[24:27], v7, s[30:31] offset:-3072 sc1
ds_write_b64 v11, v[144:145] offset:1152
v_mfma_f32_16x16x32_bf16 v[20:23], v[208:211], v[136:139], v[20:23]
v_cvt_pk_bf16_f32 v146, v76, v77
v_cvt_pk_bf16_f32 v147, v78, v79
v_mfma_f32_16x16x32_bf16 v[80:83], v[220:223], v[136:139], v[80:83]
ds_write_b64 v11, v[146:147] offset:1216
v_mfma_f32_16x16x32_bf16 v[80:83], v[204:207], v[132:135], v[80:83]
s_waitcnt lgkmcnt(8)
v_cvt_pk_bf16_f32 v148, v40, v41
v_cvt_pk_bf16_f32 v149, v42, v43
v_mfma_f32_16x16x32_bf16 v[44:47], v[196:199], v[92:95], v[44:47]
global_load_dwordx4 a[28:31], v7, s[30:31] offset:-2048 sc1
ds_write_b64 v11, v[148:149] offset:13824
v_mfma_f32_16x16x32_bf16 v[44:47], v[212:215], v[96:99], v[44:47]
v_cvt_pk_bf16_f32 v150, v60, v61
v_cvt_pk_bf16_f32 v151, v62, v63
v_mfma_f32_16x16x32_bf16 v[64:67], v[96:99], v[216:219], v[64:67]
ds_write_b64 v165, v[150:151] offset:25344
v_mfma_f32_16x16x32_bf16 v[64:67], v[92:95], v[200:203], v[64:67]
v_cvt_pk_bf16_f32 v140, v20, v21
v_cvt_pk_bf16_f32 v141, v22, v23
v_mfma_f32_16x16x32_bf16 v[24:27], v[192:195], v[92:95], v[24:27]
global_load_dwordx4 a[32:35], v7, s[30:31] offset:-1024 sc1
ds_write_b64 v11, v[140:141] offset:2304
v_mfma_f32_16x16x32_bf16 v[24:27], v[208:211], v[96:99], v[24:27]
v_cvt_pk_bf16_f32 v142, v80, v81
v_cvt_pk_bf16_f32 v143, v82, v83
v_mfma_f32_16x16x32_bf16 v[84:87], v[220:223], v[96:99], v[84:87]
ds_write_b64 v11, v[142:143] offset:2368
v_mfma_f32_16x16x32_bf16 v[84:87], v[204:207], v[92:95], v[84:87]
s_waitcnt lgkmcnt(10)
v_cvt_pk_bf16_f32 v144, v44, v45
v_cvt_pk_bf16_f32 v145, v46, v47
v_mfma_f32_16x16x32_bf16 v[48:51], v[196:199], v[100:103], v[48:51]
global_load_dwordx4 a[36:39], v7, s[30:31] offset:0 sc1
ds_write_b64 v11, v[144:145] offset:14976
v_mfma_f32_16x16x32_bf16 v[48:51], v[212:215], v[104:107], v[48:51]
v_cvt_pk_bf16_f32 v146, v64, v65
v_cvt_pk_bf16_f32 v147, v66, v67
v_mfma_f32_16x16x32_bf16 v[68:71], v[104:107], v[216:219], v[68:71]
ds_write_b64 v165, v[146:147] offset:26496
v_mfma_f32_16x16x32_bf16 v[68:71], v[100:103], v[200:203], v[68:71]
v_cvt_pk_bf16_f32 v148, v24, v25
v_cvt_pk_bf16_f32 v149, v26, v27
v_mfma_f32_16x16x32_bf16 v[28:31], v[192:195], v[100:103], v[28:31]
ds_write_b64 v11, v[148:149] offset:3456
v_mfma_f32_16x16x32_bf16 v[28:31], v[208:211], v[104:107], v[28:31]
v_cvt_pk_bf16_f32 v150, v84, v85
v_cvt_pk_bf16_f32 v151, v86, v87
v_mfma_f32_16x16x32_bf16 v[88:91], v[220:223], v[104:107], v[88:91]
ds_write_b64 v11, v[150:151] offset:3520
v_mfma_f32_16x16x32_bf16 v[88:91], v[204:207], v[100:103], v[88:91]
s_waitcnt lgkmcnt(11)
v_cvt_pk_bf16_f32 v140, v48, v49
v_cvt_pk_bf16_f32 v141, v50, v51
v_mfma_f32_16x16x32_bf16 v[32:35], v[196:199], v[108:111], v[32:35]
ds_write_b64 v11, v[140:141] offset:16128
v_mfma_f32_16x16x32_bf16 v[32:35], v[212:215], v[112:115], v[32:35]
v_cvt_pk_bf16_f32 v142, v68, v69
v_cvt_pk_bf16_f32 v143, v70, v71
v_mfma_f32_16x16x32_bf16 v[52:55], v[112:115], v[216:219], v[52:55]
ds_write_b64 v165, v[142:143] offset:27648
v_mfma_f32_16x16x32_bf16 v[52:55], v[108:111], v[200:203], v[52:55]
v_cvt_pk_bf16_f32 v144, v28, v29
v_cvt_pk_bf16_f32 v145, v30, v31
ds_write_b64 v11, v[144:145] offset:4608
v_cvt_pk_bf16_f32 v146, v88, v89
v_cvt_pk_bf16_f32 v147, v90, v91
ds_write_b64 v11, v[146:147] offset:4672
v_cvt_pk_bf16_f32 v148, v32, v33
v_cvt_pk_bf16_f32 v149, v34, v35
ds_write_b64 v11, v[148:149] offset:11520
v_cvt_pk_bf16_f32 v150, v52, v53
v_cvt_pk_bf16_f32 v151, v54, v55
ds_write_b64 v165, v[150:151] offset:23040
s_branch L_q_att
L_q_w2:
ds_read_b128 v[92:95], v9 offset:18432
ds_read_b128 v[96:99], v157 offset:18432
ds_read_b128 v[100:103], v9 offset:36864
ds_read_b128 v[104:107], v157 offset:36864
ds_read_b128 v[108:111], v10 offset:0
ds_read_b128 v[112:115], v158 offset:0
ds_read_b128 v[116:119], v10 offset:18432
ds_read_b128 v[120:123], v158 offset:18432
s_waitcnt vmcnt(16) lgkmcnt(7)
v_mfma_f32_16x16x32_bf16 v[36:39], a[4:7], v[92:95], 0
s_waitcnt vmcnt(13) lgkmcnt(6)
s_mul_i32 s46, s24, 320
s_lshl_b32 s62, s46, 1
v_mfma_f32_16x16x32_bf16 v[36:39], a[20:23], v[96:99], v[36:39]
s_add_u32 s46, s46, 127680
s_add_u32 s62, s62, 130240
s_mov_b32 s56, 0x11111111
v_mfma_f32_16x16x32_bf16 v[56:59], v[92:95], a[8:11], 0
s_waitcnt vmcnt(12)
s_mov_b32 s57, 0x11111111
s_mov_b32 s58, 0x33333333
v_mfma_f32_16x16x32_bf16 v[56:59], v[96:99], a[24:27], v[56:59]
s_mov_b32 s59, 0x33333333
s_mov_b32 s60, 0x77777777
s_mov_b32 s61, 0x77777777
v_mfma_f32_16x16x32_bf16 v[76:79], a[0:3], v[92:95], 0
s_mul_i32 s42, s25, 73728
ds_read_b128 v[124:127], v9 offset:0
s_lshl_b32 s43, s26, 11
v_mfma_f32_16x16x32_bf16 v[76:79], a[16:19], v[96:99], v[76:79]
s_add_u32 s42, s42, s43
ds_read_b128 v[128:131], v157 offset:0
s_lshl_b32 s43, s24, 9
v_mfma_f32_16x16x32_bf16 v[16:19], v[92:95], v[92:95], 0
s_add_u32 s42, s42, s43
s_lshl_b32 s43, s25, 5
s_lshl_b32 s44, s26, 2
v_mfma_f32_16x16x32_bf16 v[16:19], v[96:99], v[96:99], v[16:19]
s_waitcnt lgkmcnt(6)
s_add_u32 s43, s43, s44
s_add_u32 s43, s43, s24
v_mfma_f32_16x16x32_bf16 v[40:43], a[4:7], v[100:103], 0
s_lshl_b32 s43, s43, 8
s_add_u32 s43, s43, 4849664
s_mul_i32 s44, s24, 3072
v_mfma_f32_16x16x32_bf16 v[40:43], a[20:23], v[104:107], v[40:43]
s_sub_u32 s44, 65536, s44
s_lshl_b32 s45, s24, 11
s_sub_u32 s45, 21504, s45
v_mfma_f32_16x16x32_bf16 v[60:63], v[100:103], a[8:11], 0
global_load_dwordx4 a[100:103], v7, s[30:31] offset:-3072 sc1
v_mfma_f32_16x16x32_bf16 v[60:63], v[104:107], a[24:27], v[60:63]
global_load_dwordx4 a[116:119], v7, s[30:31] offset:1024 sc1
v_mfma_f32_16x16x32_bf16 v[80:83], a[0:3], v[100:103], 0
global_load_dwordx4 a[104:107], v7, s[30:31] offset:-2048 sc1
ds_read_b128 v[132:135], v9 offset:20480
v_mfma_f32_16x16x32_bf16 v[80:83], a[16:19], v[104:107], v[80:83]
s_waitcnt lgkmcnt(5)
ds_read_b128 v[136:139], v157 offset:20480
v_mfma_f32_16x16x32_bf16 v[44:47], a[4:7], v[108:111], 0
v_mfma_f32_16x16x32_bf16 v[44:47], a[20:23], v[112:115], v[44:47]
v_mfma_f32_16x16x32_bf16 v[64:67], v[108:111], a[8:11], 0
v_mfma_f32_16x16x32_bf16 v[64:67], v[112:115], a[24:27], v[64:67]
global_load_dwordx4 a[120:123], v7, s[30:31] offset:2048 sc1
v_mfma_f32_16x16x32_bf16 v[84:87], a[0:3], v[108:111], 0
v_mfma_f32_16x16x32_bf16 v[84:87], a[16:19], v[112:115], v[84:87]
v_mfma_f32_16x16x32_bf16 v[20:23], v[108:111], v[108:111], 0
ds_read_b128 v[92:95], v9 offset:38912
v_mfma_f32_16x16x32_bf16 v[20:23], v[112:115], v[112:115], v[20:23]
s_waitcnt lgkmcnt(5)
ds_read_b128 v[96:99], v157 offset:38912
v_mfma_f32_16x16x32_bf16 v[48:51], a[4:7], v[116:119], 0
v_mfma_f32_16x16x32_bf16 v[48:51], a[20:23], v[120:123], v[48:51]
global_load_dwordx4 a[96:99], v7, s[30:31] offset:-4096 sc1
v_mfma_f32_16x16x32_bf16 v[68:71], v[116:119], a[8:11], 0
v_mfma_f32_16x16x32_bf16 v[68:71], v[120:123], a[24:27], v[68:71]
v_mfma_f32_16x16x32_bf16 v[88:91], a[0:3], v[116:119], 0
ds_read_b128 v[100:103], v10 offset:2048
v_mfma_f32_16x16x32_bf16 v[88:91], a[16:19], v[120:123], v[88:91]
s_waitcnt lgkmcnt(5)
ds_read_b128 v[104:107], v158 offset:2048
v_mfma_f32_16x16x32_bf16 v[32:35], a[4:7], v[124:127], 0
global_load_dwordx4 a[112:115], v7, s[30:31] offset:0 sc1
s_add_u32 s30, s30, 0x2000
v_mfma_f32_16x16x32_bf16 v[32:35], a[20:23], v[128:131], v[32:35]
s_addc_u32 s31, s31, 0
s_mov_b32 m0, s36
s_add_u32 s36, s36, 0x400
v_mfma_f32_16x16x32_bf16 v[52:55], v[124:127], a[8:11], 0
v_mfma_f32_16x16x32_bf16 v[52:55], v[128:131], a[24:27], v[52:55]
v_mfma_f32_16x16x32_bf16 v[72:75], a[0:3], v[124:127], 0
v_mfma_f32_16x16x32_bf16 v[72:75], a[16:19], v[128:131], v[72:75]
v_mfma_f32_16x16x32_bf16 v[24:27], v[124:127], v[124:127], 0
global_load_lds_dwordx4 v8, s[32:33] sc1
ds_read_b128 v[108:111], v10 offset:20480
v_mfma_f32_16x16x32_bf16 v[24:27], v[128:131], v[128:131], v[24:27]
s_waitcnt vmcnt(14) lgkmcnt(5)
ds_read_b128 v[112:115], v158 offset:20480
s_mov_b32 m0, s36
v_mfma_f32_16x16x32_bf16 v[36:39], a[36:39], v[132:135], v[36:39]
s_add_u32 s36, s36, 0x400
v_mfma_f32_16x16x32_bf16 v[36:39], a[52:55], v[136:139], v[36:39]
s_waitcnt vmcnt(13)
v_mfma_f32_16x16x32_bf16 v[56:59], v[136:139], a[56:59], v[56:59]
v_mfma_f32_16x16x32_bf16 v[56:59], v[132:135], a[40:43], v[56:59]
v_mfma_f32_16x16x32_bf16 v[76:79], a[32:35], v[132:135], v[76:79]
global_load_lds_dwordx4 v155, s[32:33] sc1
ds_read_b128 v[116:119], v9 offset:2048
v_mfma_f32_16x16x32_bf16 v[76:79], a[48:51], v[136:139], v[76:79]
s_add_u32 s32, s32, s38
ds_read_b128 v[120:123], v157 offset:2048
s_addc_u32 s33, s33, 0
v_mfma_f32_16x16x32_bf16 v[16:19], v[136:139], v[136:139], v[16:19]
s_mov_b32 m0, s36
s_add_u32 s36, s36, 0x400
v_mfma_f32_16x16x32_bf16 v[16:19], v[132:135], v[132:135], v[16:19]
s_waitcnt lgkmcnt(6)
v_mfma_f32_16x16x32_bf16 v[40:43], a[36:39], v[92:95], v[40:43]
v_mfma_f32_16x16x32_bf16 v[40:43], a[52:55], v[96:99], v[40:43]
global_load_lds_dwordx4 v8, s[32:33] sc1
s_mov_b32 m0, s36
v_mfma_f32_16x16x32_bf16 v[60:63], v[96:99], a[56:59], v[60:63]
s_add_u32 s36, s36, 0x400
v_mfma_f32_16x16x32_bf16 v[60:63], v[92:95], a[40:43], v[60:63]
v_mfma_f32_16x16x32_bf16 v[80:83], a[32:35], v[92:95], v[80:83]
ds_read_b128 v[124:127], v9 offset:22528
v_mfma_f32_16x16x32_bf16 v[80:83], a[48:51], v[96:99], v[80:83]
s_waitcnt lgkmcnt(5)
ds_read_b128 v[128:131], v157 offset:22528
v_mfma_f32_16x16x32_bf16 v[44:47], a[36:39], v[100:103], v[44:47]
v_mfma_f32_16x16x32_bf16 v[44:47], a[52:55], v[104:107], v[44:47]
global_load_lds_dwordx4 v155, s[32:33] sc1
s_add_u32 s32, s32, s38
v_mfma_f32_16x16x32_bf16 v[64:67], v[104:107], a[56:59], v[64:67]
s_addc_u32 s33, s33, 0
s_mov_b32 m0, s36
s_add_u32 s36, s36, 0x400
v_mfma_f32_16x16x32_bf16 v[64:67], v[100:103], a[40:43], v[64:67]
v_mfma_f32_16x16x32_bf16 v[84:87], a[32:35], v[100:103], v[84:87]
v_mfma_f32_16x16x32_bf16 v[84:87], a[48:51], v[104:107], v[84:87]
v_mfma_f32_16x16x32_bf16 v[20:23], v[104:107], v[104:107], v[20:23]
global_load_lds_dwordx4 v8, s[32:33] sc1
ds_read_b128 v[132:135], v9 offset:40960
v_mfma_f32_16x16x32_bf16 v[20:23], v[100:103], v[100:103], v[20:23]
s_waitcnt lgkmcnt(5)
ds_read_b128 v[136:139], v157 offset:40960
s_mov_b32 m0, s36
v_mfma_f32_16x16x32_bf16 v[48:51], a[36:39], v[108:111], v[48:51]
s_add_u32 s36, s36, 0x400
v_mfma_f32_16x16x32_bf16 v[48:51], a[52:55], v[112:115], v[48:51]
v_mfma_f32_16x16x32_bf16 v[68:71], v[112:115], a[56:59], v[68:71]
v_mfma_f32_16x16x32_bf16 v[68:71], v[108:111], a[40:43], v[68:71]
v_mfma_f32_16x16x32_bf16 v[88:91], a[32:35], v[108:111], v[88:91]
global_load_lds_dwordx4 v155, s[32:33] sc1
ds_read_b128 v[92:95], v10 offset:4096
v_mfma_f32_16x16x32_bf16 v[88:91], a[48:51], v[112:115], v[88:91]
s_waitcnt lgkmcnt(5)
ds_read_b128 v[96:99], v158 offset:4096
s_add_u32 s32, s32, s38
v_mfma_f32_16x16x32_bf16 v[32:35], a[36:39], v[116:119], v[32:35]
s_addc_u32 s33, s33, 0
s_mov_b32 m0, s37
s_add_u32 s37, s37, 0x1000
v_mfma_f32_16x16x32_bf16 v[32:35], a[52:55], v[120:123], v[32:35]
v_mfma_f32_16x16x32_bf16 v[52:55], v[120:123], a[56:59], v[52:55]
v_mfma_f32_16x16x32_bf16 v[52:55], v[116:119], a[40:43], v[52:55]
v_mfma_f32_16x16x32_bf16 v[72:75], a[32:35], v[116:119], v[72:75]
global_load_lds_dwordx4 v156, s[34:35] sc1
s_add_u32 s34, s34, s39
v_mfma_f32_16x16x32_bf16 v[72:75], a[48:51], v[120:123], v[72:75]
s_addc_u32 s35, s35, 0
s_lshr_b32 s40, s24, 1
s_mul_i32 s41, s40, s38
v_mfma_f32_16x16x32_bf16 v[24:27], v[120:123], v[120:123], v[24:27]
s_sub_u32 s34, s34, s41
ds_read_b128 v[100:103], v10 offset:22528
s_subb_u32 s35, s35, 0
v_mfma_f32_16x16x32_bf16 v[24:27], v[116:119], v[116:119], v[24:27]
s_waitcnt vmcnt(14) lgkmcnt(5)
ds_read_b128 v[104:107], v158 offset:22528
s_lshl_b32 s41, s40, 11
v_mfma_f32_16x16x32_bf16 v[36:39], a[68:71], v[124:127], v[36:39]
s_sub_u32 s37, s37, s41
s_mov_b32 m0, s37
s_add_u32 s37, s37, 0x1000
v_mfma_f32_16x16x32_bf16 v[36:39], a[84:87], v[128:131], v[36:39]
s_waitcnt vmcnt(13)
global_load_lds_dwordx4 v156, s[34:35] sc1
s_add_u32 s34, s34, s39
v_mfma_f32_16x16x32_bf16 v[56:59], v[128:131], a[88:91], v[56:59]
s_addc_u32 s35, s35, 0
v_mfma_f32_16x16x32_bf16 v[56:59], v[124:127], a[72:75], v[56:59]
v_mfma_f32_16x16x32_bf16 v[76:79], a[64:67], v[124:127], v[76:79]
ds_read_b128 v[108:111], v9 offset:4096
v_mfma_f32_16x16x32_bf16 v[76:79], a[80:83], v[128:131], v[76:79]
ds_read_b128 v[112:115], v157 offset:4096
v_mfma_f32_16x16x32_bf16 v[16:19], v[128:131], v[128:131], v[16:19]
v_mfma_f32_16x16x32_bf16 v[16:19], v[124:127], v[124:127], v[16:19]
s_waitcnt lgkmcnt(6)
global_load_dwordx4 a[132:135], v7, s[30:31] offset:-3072 sc1
v_mfma_f32_16x16x32_bf16 v[40:43], a[68:71], v[132:135], v[40:43]
v_mfma_f32_16x16x32_bf16 v[40:43], a[84:87], v[136:139], v[40:43]
v_mfma_f32_16x16x32_bf16 v[60:63], v[136:139], a[88:91], v[60:63]
v_mfma_f32_16x16x32_bf16 v[60:63], v[132:135], a[72:75], v[60:63]
v_mfma_f32_16x16x32_bf16 v[80:83], a[64:67], v[132:135], v[80:83]
global_load_dwordx4 a[148:151], v7, s[30:31] offset:1024 sc1
s_waitcnt vmcnt(16)
s_barrier
ds_read_b128 v[116:119], v9 offset:24576
v_mfma_f32_16x16x32_bf16 v[80:83], a[80:83], v[136:139], v[80:83]
s_waitcnt lgkmcnt(5)
ds_read_b128 v[120:123], v157 offset:24576
v_mfma_f32_16x16x32_bf16 v[44:47], a[68:71], v[92:95], v[44:47]
v_mfma_f32_16x16x32_bf16 v[44:47], a[84:87], v[96:99], v[44:47]
v_mfma_f32_16x16x32_bf16 v[64:67], v[96:99], a[88:91], v[64:67]
v_mfma_f32_16x16x32_bf16 v[64:67], v[92:95], a[72:75], v[64:67]
v_mfma_f32_16x16x32_bf16 v[84:87], a[64:67], v[92:95], v[84:87]
global_load_dwordx4 a[136:139], v7, s[30:31] offset:-2048 sc1
v_mfma_f32_16x16x32_bf16 v[84:87], a[80:83], v[96:99], v[84:87]
v_mfma_f32_16x16x32_bf16 v[20:23], v[96:99], v[96:99], v[20:23]
ds_read_b128 v[124:127], v9 offset:43008
v_mfma_f32_16x16x32_bf16 v[20:23], v[92:95], v[92:95], v[20:23]
s_waitcnt lgkmcnt(5)
ds_read_b128 v[128:131], v157 offset:43008
v_mfma_f32_16x16x32_bf16 v[48:51], a[68:71], v[100:103], v[48:51]
v_mfma_f32_16x16x32_bf16 v[48:51], a[84:87], v[104:107], v[48:51]
v_mfma_f32_16x16x32_bf16 v[68:71], v[104:107], a[88:91], v[68:71]
global_load_dwordx4 a[152:155], v7, s[30:31] offset:2048 sc1
v_mfma_f32_16x16x32_bf16 v[68:71], v[100:103], a[72:75], v[68:71]
v_mfma_f32_16x16x32_bf16 v[88:91], a[64:67], v[100:103], v[88:91]
ds_read_b128 v[132:135], v10 offset:6144
v_mfma_f32_16x16x32_bf16 v[88:91], a[80:83], v[104:107], v[88:91]
s_waitcnt lgkmcnt(5)
ds_read_b128 v[136:139], v158 offset:6144
v_mfma_f32_16x16x32_bf16 v[32:35], a[68:71], v[108:111], v[32:35]
v_mfma_f32_16x16x32_bf16 v[32:35], a[84:87], v[112:115], v[32:35]
global_load_dwordx4 a[128:131], v7, s[30:31] offset:-4096 sc1
v_mfma_f32_16x16x32_bf16 v[52:55], v[112:115], a[88:91], v[52:55]
v_mfma_f32_16x16x32_bf16 v[52:55], v[108:111], a[72:75], v[52:55]
v_mfma_f32_16x16x32_bf16 v[72:75], a[64:67], v[108:111], v[72:75]
v_mfma_f32_16x16x32_bf16 v[72:75], a[80:83], v[112:115], v[72:75]
v_mfma_f32_16x16x32_bf16 v[24:27], v[112:115], v[112:115], v[24:27]
ds_read_b128 v[92:95], v10 offset:24576
v_mfma_f32_16x16x32_bf16 v[24:27], v[108:111], v[108:111], v[24:27]
s_waitcnt vmcnt(17) lgkmcnt(5)
global_load_dwordx4 a[144:147], v7, s[30:31] offset:0 sc1
ds_read_b128 v[96:99], v158 offset:24576
v_mfma_f32_16x16x32_bf16 v[36:39], a[100:103], v[116:119], v[36:39]
s_add_u32 s30, s30, 0x2000
s_addc_u32 s31, s31, 0
v_mfma_f32_16x16x32_bf16 v[36:39], a[116:119], v[120:123], v[36:39]
s_waitcnt vmcnt(16)
v_mfma_f32_16x16x32_bf16 v[56:59], v[120:123], a[120:123], v[56:59]
v_mfma_f32_16x16x32_bf16 v[56:59], v[116:119], a[104:107], v[56:59]
s_waitcnt vmcnt(14)
v_mfma_f32_16x16x32_bf16 v[76:79], a[96:99], v[116:119], v[76:79]
global_load_dwordx4 a[164:167], v7, s[30:31] offset:-3072 sc1
ds_read_b128 v[100:103], v9 offset:6144
v_mfma_f32_16x16x32_bf16 v[76:79], a[112:115], v[120:123], v[76:79]
ds_read_b128 v[104:107], v157 offset:6144
v_mfma_f32_16x16x32_bf16 v[16:19], v[120:123], v[120:123], v[16:19]
v_mfma_f32_16x16x32_bf16 v[16:19], v[116:119], v[116:119], v[16:19]
s_waitcnt lgkmcnt(6)
v_mfma_f32_16x16x32_bf16 v[40:43], a[100:103], v[124:127], v[40:43]
v_mfma_f32_16x16x32_bf16 v[40:43], a[116:119], v[128:131], v[40:43]
v_mfma_f32_16x16x32_bf16 v[60:63], v[128:131], a[120:123], v[60:63]
global_load_dwordx4 a[180:183], v7, s[30:31] offset:1024 sc1
v_mfma_f32_16x16x32_bf16 v[60:63], v[124:127], a[104:107], v[60:63]
v_mfma_f32_16x16x32_bf16 v[80:83], a[96:99], v[124:127], v[80:83]
ds_read_b128 v[108:111], v9 offset:26624
v_mfma_f32_16x16x32_bf16 v[80:83], a[112:115], v[128:131], v[80:83]
s_waitcnt lgkmcnt(5)
ds_read_b128 v[112:115], v157 offset:26624
v_mfma_f32_16x16x32_bf16 v[44:47], a[100:103], v[132:135], v[44:47]
v_mfma_f32_16x16x32_bf16 v[44:47], a[116:119], v[136:139], v[44:47]
v_mfma_f32_16x16x32_bf16 v[64:67], v[136:139], a[120:123], v[64:67]
global_load_dwordx4 a[168:171], v7, s[30:31] offset:-2048 sc1
v_mfma_f32_16x16x32_bf16 v[64:67], v[132:135], a[104:107], v[64:67]
v_mfma_f32_16x16x32_bf16 v[84:87], a[96:99], v[132:135], v[84:87]
v_mfma_f32_16x16x32_bf16 v[84:87], a[112:115], v[136:139], v[84:87]
v_mfma_f32_16x16x32_bf16 v[20:23], v[136:139], v[136:139], v[20:23]
ds_read_b128 v[116:119], v9 offset:45056
v_mfma_f32_16x16x32_bf16 v[20:23], v[132:135], v[132:135], v[20:23]
s_waitcnt lgkmcnt(5)
global_load_dwordx4 a[184:187], v7, s[30:31] offset:2048 sc1
ds_read_b128 v[120:123], v157 offset:45056
v_mfma_f32_16x16x32_bf16 v[48:51], a[100:103], v[92:95], v[48:51]
v_mfma_f32_16x16x32_bf16 v[48:51], a[116:119], v[96:99], v[48:51]
v_mfma_f32_16x16x32_bf16 v[68:71], v[96:99], a[120:123], v[68:71]
v_mfma_f32_16x16x32_bf16 v[68:71], v[92:95], a[104:107], v[68:71]
v_mfma_f32_16x16x32_bf16 v[88:91], a[96:99], v[92:95], v[88:91]
ds_read_b128 v[124:127], v10 offset:8192
v_mfma_f32_16x16x32_bf16 v[88:91], a[112:115], v[96:99], v[88:91]
s_waitcnt lgkmcnt(5)
global_load_dwordx4 a[160:163], v7, s[30:31] offset:-4096 sc1
ds_read_b128 v[128:131], v158 offset:8192
v_mfma_f32_16x16x32_bf16 v[32:35], a[100:103], v[100:103], v[32:35]
v_mfma_f32_16x16x32_bf16 v[32:35], a[116:119], v[104:107], v[32:35]
v_mfma_f32_16x16x32_bf16 v[52:55], v[104:107], a[120:123], v[52:55]
v_mfma_f32_16x16x32_bf16 v[52:55], v[100:103], a[104:107], v[52:55]
v_mfma_f32_16x16x32_bf16 v[72:75], a[96:99], v[100:103], v[72:75]
global_load_dwordx4 a[176:179], v7, s[30:31] offset:0 sc1
s_add_u32 s30, s30, 0x2000
v_mfma_f32_16x16x32_bf16 v[72:75], a[112:115], v[104:107], v[72:75]
s_addc_u32 s31, s31, 0
v_mfma_f32_16x16x32_bf16 v[24:27], v[104:107], v[104:107], v[24:27]
ds_read_b128 v[132:135], v10 offset:26624
v_mfma_f32_16x16x32_bf16 v[24:27], v[100:103], v[100:103], v[24:27]
s_waitcnt vmcnt(10) lgkmcnt(5)
ds_read_b128 v[136:139], v158 offset:26624
v_mfma_f32_16x16x32_bf16 v[36:39], a[132:135], v[108:111], v[36:39]
v_mfma_f32_16x16x32_bf16 v[36:39], a[148:151], v[112:115], v[36:39]
s_waitcnt vmcnt(8)
v_mfma_f32_16x16x32_bf16 v[56:59], v[112:115], a[152:155], v[56:59]
global_load_dwordx4 a[196:199], v7, s[30:31] offset:-3072 sc1
v_mfma_f32_16x16x32_bf16 v[56:59], v[108:111], a[136:139], v[56:59]
s_waitcnt vmcnt(7)
v_mfma_f32_16x16x32_bf16 v[76:79], a[128:131], v[108:111], v[76:79]
ds_read_b128 v[92:95], v9 offset:8192
v_mfma_f32_16x16x32_bf16 v[76:79], a[144:147], v[112:115], v[76:79]
ds_read_b128 v[96:99], v157 offset:8192
v_mfma_f32_16x16x32_bf16 v[16:19], v[112:115], v[112:115], v[16:19]
v_mfma_f32_16x16x32_bf16 v[16:19], v[108:111], v[108:111], v[16:19]
s_waitcnt lgkmcnt(6)
v_mfma_f32_16x16x32_bf16 v[40:43], a[132:135], v[116:119], v[40:43]
global_load_dwordx4 a[212:215], v7, s[30:31] offset:1024 sc1
v_mfma_f32_16x16x32_bf16 v[40:43], a[148:151], v[120:123], v[40:43]
v_mfma_f32_16x16x32_bf16 v[60:63], v[120:123], a[152:155], v[60:63]
v_mfma_f32_16x16x32_bf16 v[60:63], v[116:119], a[136:139], v[60:63]
v_mfma_f32_16x16x32_bf16 v[80:83], a[128:131], v[116:119], v[80:83]
ds_read_b128 v[100:103], v9 offset:28672
v_mfma_f32_16x16x32_bf16 v[80:83], a[144:147], v[120:123], v[80:83]
s_waitcnt lgkmcnt(5)
global_load_dwordx4 a[200:203], v7, s[30:31] offset:-2048 sc1
ds_read_b128 v[104:107], v157 offset:28672
v_mfma_f32_16x16x32_bf16 v[44:47], a[132:135], v[124:127], v[44:47]
v_mfma_f32_16x16x32_bf16 v[44:47], a[148:151], v[128:131], v[44:47]
v_mfma_f32_16x16x32_bf16 v[64:67], v[128:131], a[152:155], v[64:67]
v_mfma_f32_16x16x32_bf16 v[64:67], v[124:127], a[136:139], v[64:67]
v_mfma_f32_16x16x32_bf16 v[84:87], a[128:131], v[124:127], v[84:87]
v_mfma_f32_16x16x32_bf16 v[84:87], a[144:147], v[128:131], v[84:87]
global_load_dwordx4 a[216:219], v7, s[30:31] offset:2048 sc1
v_mfma_f32_16x16x32_bf16 v[20:23], v[128:131], v[128:131], v[20:23]
ds_read_b128 v[108:111], v9 offset:47104
v_mfma_f32_16x16x32_bf16 v[20:23], v[124:127], v[124:127], v[20:23]
s_waitcnt lgkmcnt(5)
ds_read_b128 v[112:115], v157 offset:47104
v_mfma_f32_16x16x32_bf16 v[48:51], a[132:135], v[132:135], v[48:51]
v_mfma_f32_16x16x32_bf16 v[48:51], a[148:151], v[136:139], v[48:51]
v_mfma_f32_16x16x32_bf16 v[68:71], v[136:139], a[152:155], v[68:71]
global_load_dwordx4 a[192:195], v7, s[30:31] offset:-4096 sc1
v_mfma_f32_16x16x32_bf16 v[68:71], v[132:135], a[136:139], v[68:71]
v_mfma_f32_16x16x32_bf16 v[88:91], a[128:131], v[132:135], v[88:91]
ds_read_b128 v[116:119], v10 offset:10240
v_mfma_f32_16x16x32_bf16 v[88:91], a[144:147], v[136:139], v[88:91]
s_waitcnt lgkmcnt(5)
ds_read_b128 v[120:123], v158 offset:10240
v_mfma_f32_16x16x32_bf16 v[32:35], a[132:135], v[92:95], v[32:35]
v_mfma_f32_16x16x32_bf16 v[32:35], a[148:151], v[96:99], v[32:35]
v_mfma_f32_16x16x32_bf16 v[52:55], v[96:99], a[152:155], v[52:55]
global_load_dwordx4 a[208:211], v7, s[30:31] offset:0 sc1
s_add_u32 s30, s30, 0x2000
v_mfma_f32_16x16x32_bf16 v[52:55], v[92:95], a[136:139], v[52:55]
s_addc_u32 s31, s31, 0
v_mfma_f32_16x16x32_bf16 v[72:75], a[128:131], v[92:95], v[72:75]
v_mfma_f32_16x16x32_bf16 v[72:75], a[144:147], v[96:99], v[72:75]
v_mfma_f32_16x16x32_bf16 v[24:27], v[96:99], v[96:99], v[24:27]
ds_read_b128 v[124:127], v10 offset:28672
v_mfma_f32_16x16x32_bf16 v[24:27], v[92:95], v[92:95], v[24:27]
s_waitcnt vmcnt(10) lgkmcnt(5)
ds_read_b128 v[128:131], v158 offset:28672
v_mfma_f32_16x16x32_bf16 v[36:39], a[164:167], v[100:103], v[36:39]
global_load_dword v152, v153, s[22:23] sc1
v_mfma_f32_16x16x32_bf16 v[36:39], a[180:183], v[104:107], v[36:39]
s_waitcnt vmcnt(9)
v_mfma_f32_16x16x32_bf16 v[56:59], v[104:107], a[184:187], v[56:59]
v_mfma_f32_16x16x32_bf16 v[56:59], v[100:103], a[168:171], v[56:59]
s_waitcnt vmcnt(7)
v_mfma_f32_16x16x32_bf16 v[76:79], a[160:163], v[100:103], v[76:79]
ds_read_b128 v[132:135], v9 offset:10240
v_mfma_f32_16x16x32_bf16 v[76:79], a[176:179], v[104:107], v[76:79]
global_load_dwordx4 a[228:231], v7, s[30:31] offset:-3072 sc1
ds_read_b128 v[136:139], v157 offset:10240
v_mfma_f32_16x16x32_bf16 v[16:19], v[104:107], v[104:107], v[16:19]
v_mfma_f32_16x16x32_bf16 v[16:19], v[100:103], v[100:103], v[16:19]
s_waitcnt lgkmcnt(6)
v_mfma_f32_16x16x32_bf16 v[40:43], a[164:167], v[108:111], v[40:43]
v_mfma_f32_16x16x32_bf16 v[40:43], a[180:183], v[112:115], v[40:43]
v_mfma_f32_16x16x32_bf16 v[60:63], v[112:115], a[184:187], v[60:63]
v_mfma_f32_16x16x32_bf16 v[60:63], v[108:111], a[168:171], v[60:63]
global_load_dwordx4 a[244:247], v7, s[30:31] offset:1024 sc1
v_mfma_f32_16x16x32_bf16 v[80:83], a[160:163], v[108:111], v[80:83]
s_barrier
ds_read_b128 v[92:95], v9 offset:30720
v_mfma_f32_16x16x32_bf16 v[80:83], a[176:179], v[112:115], v[80:83]
s_waitcnt lgkmcnt(5)
ds_read_b128 v[96:99], v157 offset:30720
v_mfma_f32_16x16x32_bf16 v[44:47], a[164:167], v[116:119], v[44:47]
v_mfma_f32_16x16x32_bf16 v[44:47], a[180:183], v[120:123], v[44:47]
v_mfma_f32_16x16x32_bf16 v[64:67], v[120:123], a[184:187], v[64:67]
global_load_dwordx4 a[232:235], v7, s[30:31] offset:-2048 sc1
v_mfma_f32_16x16x32_bf16 v[64:67], v[116:119], a[168:171], v[64:67]
v_mfma_f32_16x16x32_bf16 v[84:87], a[160:163], v[116:119], v[84:87]
v_mfma_f32_16x16x32_bf16 v[84:87], a[176:179], v[120:123], v[84:87]
v_mfma_f32_16x16x32_bf16 v[20:23], v[120:123], v[120:123], v[20:23]
ds_read_b128 v[100:103], v9 offset:49152
v_mfma_f32_16x16x32_bf16 v[20:23], v[116:119], v[116:119], v[20:23]
s_waitcnt lgkmcnt(5)
ds_read_b128 v[104:107], v157 offset:49152
v_mfma_f32_16x16x32_bf16 v[48:51], a[164:167], v[124:127], v[48:51]
global_load_dwordx4 a[248:251], v7, s[30:31] offset:2048 sc1
v_mfma_f32_16x16x32_bf16 v[48:51], a[180:183], v[128:131], v[48:51]
v_mfma_f32_16x16x32_bf16 v[68:71], v[128:131], a[184:187], v[68:71]
v_mfma_f32_16x16x32_bf16 v[68:71], v[124:127], a[168:171], v[68:71]
v_mfma_f32_16x16x32_bf16 v[88:91], a[160:163], v[124:127], v[88:91]
ds_read_b128 v[108:111], v10 offset:12288
v_mfma_f32_16x16x32_bf16 v[88:91], a[176:179], v[128:131], v[88:91]
s_waitcnt lgkmcnt(5)
ds_read_b128 v[112:115], v158 offset:12288
v_mfma_f32_16x16x32_bf16 v[32:35], a[164:167], v[132:135], v[32:35]
global_load_dwordx4 a[224:227], v7, s[30:31] offset:-4096 sc1
v_mfma_f32_16x16x32_bf16 v[32:35], a[180:183], v[136:139], v[32:35]
v_mfma_f32_16x16x32_bf16 v[52:55], v[136:139], a[184:187], v[52:55]
v_mfma_f32_16x16x32_bf16 v[52:55], v[132:135], a[168:171], v[52:55]
v_mfma_f32_16x16x32_bf16 v[72:75], a[160:163], v[132:135], v[72:75]
v_mfma_f32_16x16x32_bf16 v[72:75], a[176:179], v[136:139], v[72:75]
global_load_dwordx4 a[240:243], v7, s[30:31] offset:0 sc1
s_add_u32 s30, s30, 0x2000
v_mfma_f32_16x16x32_bf16 v[24:27], v[136:139], v[136:139], v[24:27]
s_addc_u32 s31, s31, 0
ds_read_b128 v[116:119], v10 offset:30720
v_mfma_f32_16x16x32_bf16 v[24:27], v[132:135], v[132:135], v[24:27]
s_waitcnt vmcnt(11) lgkmcnt(5)
ds_read_b128 v[120:123], v158 offset:30720
v_mfma_f32_16x16x32_bf16 v[36:39], a[196:199], v[92:95], v[36:39]
v_mfma_f32_16x16x32_bf16 v[36:39], a[212:215], v[96:99], v[36:39]
s_waitcnt vmcnt(9)
v_mfma_f32_16x16x32_bf16 v[56:59], v[96:99], a[216:219], v[56:59]
v_mfma_f32_16x16x32_bf16 v[56:59], v[92:95], a[200:203], v[56:59]
s_waitcnt vmcnt(7)
global_load_dwordx4 v[196:199], v7, s[30:31] offset:-3072 sc1
v_mfma_f32_16x16x32_bf16 v[76:79], a[192:195], v[92:95], v[76:79]
ds_read_b128 v[124:127], v9 offset:12288
v_mfma_f32_16x16x32_bf16 v[76:79], a[208:211], v[96:99], v[76:79]
ds_read_b128 v[128:131], v157 offset:12288
v_mfma_f32_16x16x32_bf16 v[16:19], v[96:99], v[96:99], v[16:19]
v_mfma_f32_16x16x32_bf16 v[16:19], v[92:95], v[92:95], v[16:19]
s_waitcnt lgkmcnt(6)
v_mfma_f32_16x16x32_bf16 v[40:43], a[196:199], v[100:103], v[40:43]
global_load_dwordx4 v[212:215], v7, s[30:31] offset:1024 sc1
v_mfma_f32_16x16x32_bf16 v[40:43], a[212:215], v[104:107], v[40:43]
v_mfma_f32_16x16x32_bf16 v[60:63], v[104:107], a[216:219], v[60:63]
v_mfma_f32_16x16x32_bf16 v[60:63], v[100:103], a[200:203], v[60:63]
v_mfma_f32_16x16x32_bf16 v[80:83], a[192:195], v[100:103], v[80:83]
ds_read_b128 v[132:135], v9 offset:32768
v_mfma_f32_16x16x32_bf16 v[80:83], a[208:211], v[104:107], v[80:83]
s_waitcnt lgkmcnt(5)
ds_read_b128 v[136:139], v157 offset:32768
ds_read_b64 v[244:245], v13
v_mfma_f32_16x16x32_bf16 v[44:47], a[196:199], v[108:111], v[44:47]
global_load_dwordx4 v[200:203], v7, s[30:31] offset:-2048 sc1
ds_read_b64 v[246:247], v14
v_mfma_f32_16x16x32_bf16 v[44:47], a[212:215], v[112:115], v[44:47]
ds_read_b64 v[248:249], v159
v_mfma_f32_16x16x32_bf16 v[64:67], v[112:115], a[216:219], v[64:67]
ds_read_b64 v[250:251], v160
v_mfma_f32_16x16x32_bf16 v[64:67], v[108:111], a[200:203], v[64:67]
ds_read_b64 v[252:253], v15
v_mfma_f32_16x16x32_bf16 v[84:87], a[192:195], v[108:111], v[84:87]
v_lshrrev_b32 v2, 5, v1
v_mfma_f32_16x16x32_bf16 v[84:87], a[208:211], v[112:115], v[84:87]
v_lshl_add_u32 v2, v2, 3, v1
v_mfma_f32_16x16x32_bf16 v[20:23], v[112:115], v[112:115], v[20:23]
global_load_dwordx4 v[216:219], v7, s[30:31] offset:2048 sc1
ds_read_b128 v[92:95], v9 offset:51200
v_mfma_f32_16x16x32_bf16 v[20:23], v[108:111], v[108:111], v[20:23]
s_waitcnt lgkmcnt(10)
ds_read_b128 v[96:99], v157 offset:51200
v_mul_u32_u24 v3, 144, v2
v_mfma_f32_16x16x32_bf16 v[48:51], a[196:199], v[116:119], v[48:51]
v_add_u32 v13, s47, v3
v_mfma_f32_16x16x32_bf16 v[48:51], a[212:215], v[120:123], v[48:51]
v_lshl_add_u32 v14, v2, 2, s46
v_mfma_f32_16x16x32_bf16 v[68:71], v[120:123], a[216:219], v[68:71]
v_and_b32 v243, -3, v2
v_mfma_f32_16x16x32_bf16 v[68:71], v[116:119], a[200:203], v[68:71]
global_load_dwordx4 v[192:195], v7, s[30:31] offset:-4096 sc1
v_lshl_add_u32 v243, v243, 3, s62
v_mfma_f32_16x16x32_bf16 v[88:91], a[192:195], v[116:119], v[88:91]
ds_read_b128 v[100:103], v10 offset:14336
v_lshlrev_b32 v2, 2, v2
v_mfma_f32_16x16x32_bf16 v[88:91], a[208:211], v[120:123], v[88:91]
s_waitcnt lgkmcnt(10)
ds_read_b128 v[104:107], v158 offset:14336
v_and_b32 v3, -16, v2
v_mfma_f32_16x16x32_bf16 v[32:35], a[196:199], v[124:127], v[32:35]
v_add_u32 v3, 127360, v3
v_mfma_f32_16x16x32_bf16 v[32:35], a[212:215], v[128:131], v[32:35]
v_add_u32 v2, 126752, v2
v_mfma_f32_16x16x32_bf16 v[52:55], v[128:131], a[216:219], v[52:55]
v_lshlrev_b32 v4, 2, v12
v_mfma_f32_16x16x32_bf16 v[52:55], v[124:127], a[200:203], v[52:55]
global_load_dwordx4 v[208:211], v7, s[30:31] offset:0 sc1
s_add_u32 s30, s30, 0x2000
v_mfma_f32_16x16x32_bf16 v[72:75], a[192:195], v[124:127], v[72:75]
s_addc_u32 s31, s31, 0
s_mul_i32 s40, s26, 94208
s_mul_i32 s41, s24, 6144
v_mfma_f32_16x16x32_bf16 v[72:75], a[208:211], v[128:131], v[72:75]
s_add_u32 s40, s40, s41
s_add_u32 s40, s40, 2359296
s_add_u32 s34, s22, s40
v_mfma_f32_16x16x32_bf16 v[24:27], v[128:131], v[128:131], v[24:27]
s_addc_u32 s35, s23, 0
ds_read_b128 v[108:111], v10 offset:32768
s_add_u32 m0, s41, 137216
v_mfma_f32_16x16x32_bf16 v[24:27], v[124:127], v[124:127], v[24:27]
s_waitcnt vmcnt(10) lgkmcnt(10)
ds_read_b128 v[112:115], v158 offset:32768
s_lshl_b32 s40, s26, 2
v_mfma_f32_16x16x32_bf16 v[36:39], a[228:231], v[132:135], v[36:39]
s_add_u32 s40, s40, s24
s_mul_i32 s40, s40, 331776
s_add_u32 s40, s40, 3116032
v_mfma_f32_16x16x32_bf16 v[36:39], a[244:247], v[136:139], v[36:39]
s_waitcnt vmcnt(8)
s_add_u32 s30, s22, s40
s_addc_u32 s31, s23, 0
v_mfma_f32_16x16x32_bf16 v[56:59], v[136:139], a[248:251], v[56:59]
s_mov_b32 s10, s30
s_mov_b32 s11, s31
s_and_b32 s8, s25, 7
v_mfma_f32_16x16x32_bf16 v[56:59], v[132:135], a[232:235], v[56:59]
s_waitcnt vmcnt(6)
s_add_u32 s9, s8, 2
s_and_b32 s9, s9, 7
v_mfma_f32_16x16x32_bf16 v[76:79], a[224:227], v[132:135], v[76:79]
s_add_u32 s8, s8, 1
ds_read_b128 v[116:119], v9 offset:14336
s_cmp_gt_u32 s8, 6
v_mfma_f32_16x16x32_bf16 v[76:79], a[240:243], v[136:139], v[76:79]
s_cselect_b32 s8, 63, s8
ds_read_b128 v[120:123], v157 offset:14336
s_add_u32 s9, s9, 11
v_mfma_f32_16x16x32_bf16 v[16:19], v[136:139], v[136:139], v[16:19]
s_cmp_gt_u32 s9, 15
s_cselect_b32 s9, 63, s9
v_add_u32 v4, 126720, v4
v_mfma_f32_16x16x32_bf16 v[16:19], v[132:135], v[132:135], v[16:19]
s_waitcnt lgkmcnt(6)
v_cmp_ne_u32 vcc, v152, v154
s_cbranch_vccnz L_rdy_s_21
L_rdy_b_22:
v_mfma_f32_16x16x32_bf16 v[40:43], a[228:231], v[92:95], v[40:43]
global_load_lds_dwordx4 v7, s[34:35] offset:0 sc1
v_lshl_add_u32 v242, v1, 2, s43
v_mfma_f32_16x16x32_bf16 v[40:43], a[244:247], v[96:99], v[40:43]
global_load_lds_dwordx4 v7, s[34:35] offset:1024 sc1
v_mul_u32_u24 v241, 18432, v5
v_mfma_f32_16x16x32_bf16 v[60:63], v[96:99], a[248:251], v[60:63]
global_load_lds_dwordx4 v7, s[34:35] offset:2048 sc1
s_add_u32 m0, m0, 0xc00
v_mfma_f32_16x16x32_bf16 v[60:63], v[92:95], a[232:235], v[60:63]
s_add_u32 s34, s34, 0xc00
s_addc_u32 s35, s35, 0
v_lshl_add_u32 v241, v6, 4, v241
v_mfma_f32_16x16x32_bf16 v[80:83], a[224:227], v[92:95], v[80:83]
global_load_lds_dwordx4 v7, s[34:35] offset:0 sc1
ds_read_b128 v[124:127], v9 offset:34816
v_mfma_f32_16x16x32_bf16 v[80:83], a[240:243], v[96:99], v[80:83]
s_waitcnt lgkmcnt(5)
ds_read_b128 v[128:131], v157 offset:34816
v_add_u32 v15, s44, v7
v_mfma_f32_16x16x32_bf16 v[44:47], a[228:231], v[100:103], v[44:47]
v_add_u32 v241, s42, v241
v_mfma_f32_16x16x32_bf16 v[44:47], a[244:247], v[104:107], v[44:47]
v_mov_b32 v232, 0xffff
v_mfma_f32_16x16x32_bf16 v[64:67], v[104:107], a[248:251], v[64:67]
global_load_lds_dwordx4 v7, s[34:35] offset:1024 sc1
v_cndmask_b32 v230, -1, v232, s[56:57]
v_mfma_f32_16x16x32_bf16 v[64:67], v[100:103], a[232:235], v[64:67]
v_cndmask_b32 v231, -1, v232, s[60:61]
v_mfma_f32_16x16x32_bf16 v[84:87], a[224:227], v[100:103], v[84:87]
v_cndmask_b32 v231, v231, 0, s[58:59]
v_mfma_f32_16x16x32_bf16 v[84:87], a[240:243], v[104:107], v[84:87]
v_mfma_f32_16x16x32_bf16 v[20:23], v[104:107], v[104:107], v[20:23]
global_load_lds_dwordx4 v7, s[34:35] offset:2048 sc1
ds_read_b128 v[132:135], v9 offset:53248
v_mfma_f32_16x16x32_bf16 v[20:23], v[100:103], v[100:103], v[20:23]
s_waitcnt lgkmcnt(5)
ds_read_b128 v[136:139], v157 offset:53248
s_add_u32 s34, s34, s45
v_mfma_f32_16x16x32_bf16 v[48:51], a[228:231], v[108:111], v[48:51]
s_addc_u32 s35, s35, 0
s_lshl_b32 s41, s24, 10
s_add_u32 m0, s41, 161792
v_mfma_f32_16x16x32_bf16 v[48:51], a[244:247], v[112:115], v[48:51]
v_mfma_f32_16x16x32_bf16 v[68:71], v[112:115], a[248:251], v[68:71]
global_load_dwordx4 a[0:3], v7, s[30:31] offset:-3072 sc1
v_mfma_f32_16x16x32_bf16 v[68:71], v[108:111], a[232:235], v[68:71]
v_mfma_f32_16x16x32_bf16 v[88:91], a[224:227], v[108:111], v[88:91]
ds_read_b128 v[92:95], v10 offset:16384
v_mfma_f32_16x16x32_bf16 v[88:91], a[240:243], v[112:115], v[88:91]
s_waitcnt lgkmcnt(5)
ds_read_b128 v[96:99], v158 offset:16384
v_mfma_f32_16x16x32_bf16 v[32:35], a[228:231], v[116:119], v[32:35]
global_load_dwordx4 a[4:7], v7, s[30:31] offset:-2048 sc1
v_mfma_f32_16x16x32_bf16 v[32:35], a[244:247], v[120:123], v[32:35]
v_mfma_f32_16x16x32_bf16 v[52:55], v[120:123], a[248:251], v[52:55]
v_mfma_f32_16x16x32_bf16 v[52:55], v[116:119], a[232:235], v[52:55]
v_mfma_f32_16x16x32_bf16 v[72:75], a[224:227], v[116:119], v[72:75]
global_load_dwordx4 a[8:11], v7, s[30:31] offset:-1024 sc1
v_mfma_f32_16x16x32_bf16 v[72:75], a[240:243], v[120:123], v[72:75]
v_mfma_f32_16x16x32_bf16 v[24:27], v[120:123], v[120:123], v[24:27]
ds_read_b128 v[100:103], v10 offset:34816
v_mfma_f32_16x16x32_bf16 v[24:27], v[116:119], v[116:119], v[24:27]
s_waitcnt vmcnt(13) lgkmcnt(5)
ds_read_b128 v[104:107], v158 offset:34816
v_mfma_f32_16x16x32_bf16 v[36:39], v[196:199], v[124:127], v[36:39]
global_load_dwordx4 a[12:15], v7, s[30:31] offset:0 sc1
v_mfma_f32_16x16x32_bf16 v[36:39], v[212:215], v[128:131], v[36:39]
s_waitcnt vmcnt(12)
v_mfma_f32_16x16x32_bf16 v[56:59], v[128:131], v[216:219], v[56:59]
v_mfma_f32_16x16x32_bf16 v[56:59], v[124:127], v[200:203], v[56:59]
s_waitcnt vmcnt(10)
v_mfma_f32_16x16x32_bf16 v[76:79], v[192:195], v[124:127], v[76:79]
global_load_dwordx4 a[16:19], v7, s[30:31] offset:1024 sc1
ds_read_b128 v[108:111], v9 offset:16384
v_mfma_f32_16x16x32_bf16 v[76:79], v[208:211], v[128:131], v[76:79]
ds_read_b128 v[112:115], v157 offset:16384
v_cvt_pk_bf16_f32 v140, v36, v37
v_cvt_pk_bf16_f32 v141, v38, v39
v_mfma_f32_16x16x32_bf16 v[16:19], v[128:131], v[128:131], v[16:19]
ds_write_b64 v11, v[140:141] offset:12672
v_mfma_f32_16x16x32_bf16 v[16:19], v[124:127], v[124:127], v[16:19]
s_waitcnt lgkmcnt(7)
v_cvt_pk_bf16_f32 v142, v56, v57
v_cvt_pk_bf16_f32 v143, v58, v59
v_mfma_f32_16x16x32_bf16 v[40:43], v[196:199], v[132:135], v[40:43]
global_load_dwordx4 a[20:23], v7, s[30:31] offset:2048 sc1
s_add_u32 s30, s30, 0x1800
v_mfma_f32_16x16x32_bf16 v[40:43], v[212:215], v[136:139], v[40:43]
s_addc_u32 s31, s31, 0
ds_write_b64 v165, v[142:143] offset:24192
v_mfma_f32_16x16x32_bf16 v[60:63], v[136:139], v[216:219], v[60:63]
v_cvt_pk_bf16_f32 v144, v76, v77
v_cvt_pk_bf16_f32 v145, v78, v79
v_mfma_f32_16x16x32_bf16 v[60:63], v[132:135], v[200:203], v[60:63]
ds_write2_b32 v161, v144, v145 offset0:8 offset1:88
v_mfma_f32_16x16x32_bf16 v[80:83], v[192:195], v[132:135], v[80:83]
global_load_dwordx4 a[24:27], v7, s[30:31] offset:-3072 sc1
v_cndmask_b32 v16, v16, v17, s[50:51]
v_cndmask_b32 v16, v16, v18, s[52:53]
v_cndmask_b32 v16, v16, v19, s[54:55]
v_mfma_f32_16x16x32_bf16 v[80:83], v[208:211], v[136:139], v[80:83]
s_waitcnt lgkmcnt(7)
ds_write_b32 v162, v16 offset:32
v_mfma_f32_16x16x32_bf16 v[44:47], v[196:199], v[92:95], v[44:47]
v_cvt_pk_bf16_f32 v146, v40, v41
v_cvt_pk_bf16_f32 v147, v42, v43
v_mfma_f32_16x16x32_bf16 v[44:47], v[212:215], v[96:99], v[44:47]
ds_write_b64 v11, v[146:147] offset:13824
v_mfma_f32_16x16x32_bf16 v[64:67], v[96:99], v[216:219], v[64:67]
global_load_dwordx4 a[28:31], v7, s[30:31] offset:-2048 sc1
v_cvt_pk_bf16_f32 v148, v60, v61
v_cvt_pk_bf16_f32 v149, v62, v63
v_mfma_f32_16x16x32_bf16 v[64:67], v[92:95], v[200:203], v[64:67]
ds_write_b64 v165, v[148:149] offset:25344
v_mfma_f32_16x16x32_bf16 v[84:87], v[192:195], v[92:95], v[84:87]
v_cvt_pk_bf16_f32 v150, v80, v81
v_cvt_pk_bf16_f32 v151, v82, v83
v_mfma_f32_16x16x32_bf16 v[84:87], v[208:211], v[96:99], v[84:87]
ds_write2_b32 v161, v150, v151 offset0:16 offset1:96
v_mfma_f32_16x16x32_bf16 v[20:23], v[96:99], v[96:99], v[20:23]
global_load_dwordx4 a[32:35], v7, s[30:31] offset:-1024 sc1
v_cvt_pk_bf16_f32 v140, v44, v45
v_cvt_pk_bf16_f32 v141, v46, v47
v_mfma_f32_16x16x32_bf16 v[20:23], v[92:95], v[92:95], v[20:23]
s_waitcnt lgkmcnt(9)
ds_write_b64 v11, v[140:141] offset:14976
v_mfma_f32_16x16x32_bf16 v[48:51], v[196:199], v[100:103], v[48:51]
v_cvt_pk_bf16_f32 v142, v64, v65
v_cvt_pk_bf16_f32 v143, v66, v67
v_mfma_f32_16x16x32_bf16 v[48:51], v[212:215], v[104:107], v[48:51]
ds_write_b64 v165, v[142:143] offset:26496
v_mfma_f32_16x16x32_bf16 v[68:71], v[104:107], v[216:219], v[68:71]
global_load_dwordx4 a[36:39], v7, s[30:31] offset:0 sc1
v_cvt_pk_bf16_f32 v144, v84, v85
v_cvt_pk_bf16_f32 v145, v86, v87
v_mfma_f32_16x16x32_bf16 v[68:71], v[100:103], v[200:203], v[68:71]
ds_write2_b32 v161, v144, v145 offset0:24 offset1:104
v_mfma_f32_16x16x32_bf16 v[88:91], v[192:195], v[100:103], v[88:91]
v_cndmask_b32 v20, v20, v21, s[50:51]
v_cndmask_b32 v20, v20, v22, s[52:53]
v_cndmask_b32 v20, v20, v23, s[54:55]
v_mfma_f32_16x16x32_bf16 v[88:91], v[208:211], v[104:107], v[88:91]
s_waitcnt lgkmcnt(10)
ds_write_b32 v162, v20 offset:96
v_mfma_f32_16x16x32_bf16 v[32:35], v[196:199], v[108:111], v[32:35]
v_cvt_pk_bf16_f32 v146, v48, v49
v_cvt_pk_bf16_f32 v147, v50, v51
v_mfma_f32_16x16x32_bf16 v[32:35], v[212:215], v[112:115], v[32:35]
ds_write_b64 v11, v[146:147] offset:16128
v_mfma_f32_16x16x32_bf16 v[52:55], v[112:115], v[216:219], v[52:55]
v_cvt_pk_bf16_f32 v148, v68, v69
v_cvt_pk_bf16_f32 v149, v70, v71
v_mfma_f32_16x16x32_bf16 v[52:55], v[108:111], v[200:203], v[52:55]
ds_write_b64 v165, v[148:149] offset:27648
v_mfma_f32_16x16x32_bf16 v[72:75], v[192:195], v[108:111], v[72:75]
v_cvt_pk_bf16_f32 v150, v88, v89
v_cvt_pk_bf16_f32 v151, v90, v91
v_mfma_f32_16x16x32_bf16 v[72:75], v[208:211], v[112:115], v[72:75]
ds_write2_b32 v161, v150, v151 offset0:32 offset1:112
v_mfma_f32_16x16x32_bf16 v[24:27], v[112:115], v[112:115], v[24:27]
v_cvt_pk_bf16_f32 v140, v32, v33
v_cvt_pk_bf16_f32 v141, v34, v35
v_mfma_f32_16x16x32_bf16 v[24:27], v[108:111], v[108:111], v[24:27]
ds_write_b64 v11, v[140:141] offset:11520
v_cvt_pk_bf16_f32 v142, v52, v53
v_cvt_pk_bf16_f32 v143, v54, v55
ds_write_b64 v165, v[142:143] offset:23040
v_cvt_pk_bf16_f32 v144, v72, v73
v_cvt_pk_bf16_f32 v145, v74, v75
ds_write2_b32 v161, v144, v145 offset0:0 offset1:80
s_nop 0
v_cndmask_b32 v24, v24, v25, s[50:51]
v_cndmask_b32 v24, v24, v26, s[52:53]
v_cndmask_b32 v24, v24, v27, s[54:55]
ds_write_b32 v162, v24 offset:0
s_branch L_q_att
L_q_w3:
ds_read_b128 v[92:95], v9 offset:18432
ds_read_b128 v[96:99], v157 offset:18432
ds_read_b128 v[100:103], v9 offset:36864
ds_read_b128 v[104:107], v157 offset:36864
ds_read_b128 v[108:111], v10 offset:0
ds_read_b128 v[112:115], v158 offset:0
ds_read_b128 v[116:119], v10 offset:18432
ds_read_b128 v[120:123], v158 offset:18432
s_waitcnt vmcnt(16) lgkmcnt(7)
v_mfma_f32_16x16x32_bf16 v[36:39], a[4:7], v[92:95], 0
s_waitcnt vmcnt(13) lgkmcnt(6)
s_mul_i32 s46, s24, 320
s_lshl_b32 s62, s46, 1
v_mfma_f32_16x16x32_bf16 v[36:39], a[20:23], v[96:99], v[36:39]
s_add_u32 s46, s46, 127680
s_add_u32 s62, s62, 130240
s_mov_b32 s56, 0x11111111
v_mfma_f32_16x16x32_bf16 v[56:59], v[92:95], a[8:11], 0
s_waitcnt vmcnt(12)
s_mov_b32 s57, 0x11111111
s_mov_b32 s58, 0x33333333
v_mfma_f32_16x16x32_bf16 v[56:59], v[96:99], a[24:27], v[56:59]
s_mov_b32 s59, 0x33333333
s_mov_b32 s60, 0x77777777
s_mov_b32 s61, 0x77777777
v_mfma_f32_16x16x32_bf16 v[76:79], v[92:95], a[0:3], 0
s_mul_i32 s42, s25, 73728
ds_read_b128 v[124:127], v9 offset:0
s_lshl_b32 s43, s26, 11
v_mfma_f32_16x16x32_bf16 v[76:79], v[96:99], a[16:19], v[76:79]
s_waitcnt lgkmcnt(5)
ds_read_b128 v[128:131], v157 offset:0
s_add_u32 s42, s42, s43
v_mfma_f32_16x16x32_bf16 v[40:43], a[4:7], v[100:103], 0
s_lshl_b32 s43, s24, 9
s_add_u32 s42, s42, s43
s_lshl_b32 s43, s25, 5
v_mfma_f32_16x16x32_bf16 v[40:43], a[20:23], v[104:107], v[40:43]
s_lshl_b32 s44, s26, 2
s_add_u32 s43, s43, s44
s_add_u32 s43, s43, s24
v_mfma_f32_16x16x32_bf16 v[60:63], v[100:103], a[8:11], 0
s_lshl_b32 s43, s43, 8
s_add_u32 s43, s43, 4849664
s_mul_i32 s44, s24, 3072
v_mfma_f32_16x16x32_bf16 v[60:63], v[104:107], a[24:27], v[60:63]
s_sub_u32 s44, 65536, s44
s_lshl_b32 s45, s24, 11
s_sub_u32 s45, 21504, s45
v_mfma_f32_16x16x32_bf16 v[80:83], v[100:103], a[0:3], 0
global_load_dwordx4 a[100:103], v7, s[30:31] offset:-3072 sc1
ds_read_b128 v[132:135], v9 offset:20480
v_mfma_f32_16x16x32_bf16 v[80:83], v[104:107], a[16:19], v[80:83]
global_load_dwordx4 a[116:119], v7, s[30:31] offset:1024 sc1
ds_read_b128 v[136:139], v157 offset:20480
v_mfma_f32_16x16x32_bf16 v[16:19], v[100:103], v[100:103], 0
global_load_dwordx4 a[104:107], v7, s[30:31] offset:-2048 sc1
v_mfma_f32_16x16x32_bf16 v[16:19], v[104:107], v[104:107], v[16:19]
s_waitcnt lgkmcnt(6)
v_mfma_f32_16x16x32_bf16 v[44:47], a[4:7], v[108:111], 0
v_mfma_f32_16x16x32_bf16 v[44:47], a[20:23], v[112:115], v[44:47]
v_mfma_f32_16x16x32_bf16 v[64:67], v[108:111], a[8:11], 0
global_load_dwordx4 a[120:123], v7, s[30:31] offset:2048 sc1
ds_read_b128 v[92:95], v9 offset:38912
v_mfma_f32_16x16x32_bf16 v[64:67], v[112:115], a[24:27], v[64:67]
ds_read_b128 v[96:99], v157 offset:38912
v_mfma_f32_16x16x32_bf16 v[84:87], v[108:111], a[0:3], 0
v_mfma_f32_16x16x32_bf16 v[84:87], v[112:115], a[16:19], v[84:87]
s_waitcnt lgkmcnt(6)
v_mfma_f32_16x16x32_bf16 v[48:51], a[4:7], v[116:119], 0
v_mfma_f32_16x16x32_bf16 v[48:51], a[20:23], v[120:123], v[48:51]
v_mfma_f32_16x16x32_bf16 v[68:71], v[116:119], a[8:11], 0
global_load_dwordx4 a[96:99], v7, s[30:31] offset:-4096 sc1
v_mfma_f32_16x16x32_bf16 v[68:71], v[120:123], a[24:27], v[68:71]
v_mfma_f32_16x16x32_bf16 v[88:91], v[116:119], a[0:3], 0
ds_read_b128 v[100:103], v10 offset:2048
v_mfma_f32_16x16x32_bf16 v[88:91], v[120:123], a[16:19], v[88:91]
ds_read_b128 v[104:107], v158 offset:2048
v_mfma_f32_16x16x32_bf16 v[20:23], v[116:119], v[116:119], 0
v_mfma_f32_16x16x32_bf16 v[20:23], v[120:123], v[120:123], v[20:23]
s_waitcnt lgkmcnt(6)
global_load_dwordx4 a[112:115], v7, s[30:31] offset:0 sc1
s_add_u32 s30, s30, 0x2000
v_mfma_f32_16x16x32_bf16 v[32:35], a[4:7], v[124:127], 0
s_addc_u32 s31, s31, 0
s_mov_b32 m0, s36
s_add_u32 s36, s36, 0x400
v_mfma_f32_16x16x32_bf16 v[32:35], a[20:23], v[128:131], v[32:35]
v_mfma_f32_16x16x32_bf16 v[52:55], v[124:127], a[8:11], 0
ds_read_b128 v[108:111], v10 offset:20480
v_mfma_f32_16x16x32_bf16 v[52:55], v[128:131], a[24:27], v[52:55]
ds_read_b128 v[112:115], v158 offset:20480
v_mfma_f32_16x16x32_bf16 v[72:75], v[124:127], a[0:3], 0
global_load_lds_dwordx4 v8, s[32:33] sc1
s_mov_b32 m0, s36
v_mfma_f32_16x16x32_bf16 v[72:75], v[128:131], a[16:19], v[72:75]
s_waitcnt vmcnt(14) lgkmcnt(6)
s_add_u32 s36, s36, 0x400
v_mfma_f32_16x16x32_bf16 v[36:39], a[36:39], v[132:135], v[36:39]
v_mfma_f32_16x16x32_bf16 v[36:39], a[52:55], v[136:139], v[36:39]
s_waitcnt vmcnt(13)
v_mfma_f32_16x16x32_bf16 v[56:59], v[136:139], a[56:59], v[56:59]
v_mfma_f32_16x16x32_bf16 v[56:59], v[132:135], a[40:43], v[56:59]
v_mfma_f32_16x16x32_bf16 v[76:79], v[132:135], a[32:35], v[76:79]
global_load_lds_dwordx4 v155, s[32:33] sc1
ds_read_b128 v[116:119], v9 offset:2048
v_mfma_f32_16x16x32_bf16 v[76:79], v[136:139], a[48:51], v[76:79]
s_waitcnt lgkmcnt(5)
ds_read_b128 v[120:123], v157 offset:2048
s_add_u32 s32, s32, s38
v_mfma_f32_16x16x32_bf16 v[40:43], a[36:39], v[92:95], v[40:43]
s_addc_u32 s33, s33, 0
s_mov_b32 m0, s36
s_add_u32 s36, s36, 0x400
v_mfma_f32_16x16x32_bf16 v[40:43], a[52:55], v[96:99], v[40:43]
v_mfma_f32_16x16x32_bf16 v[60:63], v[96:99], a[56:59], v[60:63]
v_mfma_f32_16x16x32_bf16 v[60:63], v[92:95], a[40:43], v[60:63]
global_load_lds_dwordx4 v8, s[32:33] sc1
s_mov_b32 m0, s36
v_mfma_f32_16x16x32_bf16 v[80:83], v[92:95], a[32:35], v[80:83]
s_add_u32 s36, s36, 0x400
ds_read_b128 v[124:127], v9 offset:22528
v_mfma_f32_16x16x32_bf16 v[80:83], v[96:99], a[48:51], v[80:83]
ds_read_b128 v[128:131], v157 offset:22528
v_mfma_f32_16x16x32_bf16 v[16:19], v[96:99], v[96:99], v[16:19]
v_mfma_f32_16x16x32_bf16 v[16:19], v[92:95], v[92:95], v[16:19]
s_waitcnt lgkmcnt(6)
v_mfma_f32_16x16x32_bf16 v[44:47], a[36:39], v[100:103], v[44:47]
global_load_lds_dwordx4 v155, s[32:33] sc1
s_add_u32 s32, s32, s38
v_mfma_f32_16x16x32_bf16 v[44:47], a[52:55], v[104:107], v[44:47]
s_addc_u32 s33, s33, 0
s_mov_b32 m0, s36
s_add_u32 s36, s36, 0x400
v_mfma_f32_16x16x32_bf16 v[64:67], v[104:107], a[56:59], v[64:67]
ds_read_b128 v[132:135], v9 offset:40960
v_mfma_f32_16x16x32_bf16 v[64:67], v[100:103], a[40:43], v[64:67]
ds_read_b128 v[136:139], v157 offset:40960
v_mfma_f32_16x16x32_bf16 v[84:87], v[100:103], a[32:35], v[84:87]
v_mfma_f32_16x16x32_bf16 v[84:87], v[104:107], a[48:51], v[84:87]
s_waitcnt lgkmcnt(6)
global_load_lds_dwordx4 v8, s[32:33] sc1
s_mov_b32 m0, s36
v_mfma_f32_16x16x32_bf16 v[48:51], a[36:39], v[108:111], v[48:51]
s_add_u32 s36, s36, 0x400
v_mfma_f32_16x16x32_bf16 v[48:51], a[52:55], v[112:115], v[48:51]
v_mfma_f32_16x16x32_bf16 v[68:71], v[112:115], a[56:59], v[68:71]
v_mfma_f32_16x16x32_bf16 v[68:71], v[108:111], a[40:43], v[68:71]
v_mfma_f32_16x16x32_bf16 v[88:91], v[108:111], a[32:35], v[88:91]
ds_read_b128 v[92:95], v10 offset:4096
v_mfma_f32_16x16x32_bf16 v[88:91], v[112:115], a[48:51], v[88:91]
global_load_lds_dwordx4 v155, s[32:33] sc1
ds_read_b128 v[96:99], v158 offset:4096
v_mfma_f32_16x16x32_bf16 v[20:23], v[112:115], v[112:115], v[20:23]
s_add_u32 s32, s32, s38
s_addc_u32 s33, s33, 0
s_mov_b32 m0, s37
v_mfma_f32_16x16x32_bf16 v[20:23], v[108:111], v[108:111], v[20:23]
s_waitcnt lgkmcnt(6)
s_add_u32 s37, s37, 0x1000
v_mfma_f32_16x16x32_bf16 v[32:35], a[36:39], v[116:119], v[32:35]
v_mfma_f32_16x16x32_bf16 v[32:35], a[52:55], v[120:123], v[32:35]
v_mfma_f32_16x16x32_bf16 v[52:55], v[120:123], a[56:59], v[52:55]
global_load_lds_dwordx4 v156, s[34:35] sc1
ds_read_b128 v[100:103], v10 offset:22528
v_mfma_f32_16x16x32_bf16 v[52:55], v[116:119], a[40:43], v[52:55]
s_add_u32 s34, s34, s39
ds_read_b128 v[104:107], v158 offset:22528
s_addc_u32 s35, s35, 0
v_mfma_f32_16x16x32_bf16 v[72:75], v[116:119], a[32:35], v[72:75]
s_lshr_b32 s40, s24, 1
s_mul_i32 s41, s40, s38
s_sub_u32 s34, s34, s41
v_mfma_f32_16x16x32_bf16 v[72:75], v[120:123], a[48:51], v[72:75]
s_waitcnt vmcnt(14) lgkmcnt(6)
s_subb_u32 s35, s35, 0
s_lshl_b32 s41, s40, 11
v_mfma_f32_16x16x32_bf16 v[36:39], a[68:71], v[124:127], v[36:39]
s_sub_u32 s37, s37, s41
s_mov_b32 m0, s37
s_add_u32 s37, s37, 0x1000
v_mfma_f32_16x16x32_bf16 v[36:39], a[84:87], v[128:131], v[36:39]
s_waitcnt vmcnt(13)
global_load_lds_dwordx4 v156, s[34:35] sc1
s_add_u32 s34, s34, s39
v_mfma_f32_16x16x32_bf16 v[56:59], v[128:131], a[88:91], v[56:59]
s_addc_u32 s35, s35, 0
v_mfma_f32_16x16x32_bf16 v[56:59], v[124:127], a[72:75], v[56:59]
v_mfma_f32_16x16x32_bf16 v[76:79], v[124:127], a[64:67], v[76:79]
ds_read_b128 v[108:111], v9 offset:4096
v_mfma_f32_16x16x32_bf16 v[76:79], v[128:131], a[80:83], v[76:79]
s_waitcnt lgkmcnt(5)
ds_read_b128 v[112:115], v157 offset:4096
v_mfma_f32_16x16x32_bf16 v[40:43], a[68:71], v[132:135], v[40:43]
v_mfma_f32_16x16x32_bf16 v[40:43], a[84:87], v[136:139], v[40:43]
global_load_dwordx4 a[132:135], v7, s[30:31] offset:-3072 sc1
v_mfma_f32_16x16x32_bf16 v[60:63], v[136:139], a[88:91], v[60:63]
v_mfma_f32_16x16x32_bf16 v[60:63], v[132:135], a[72:75], v[60:63]
v_mfma_f32_16x16x32_bf16 v[80:83], v[132:135], a[64:67], v[80:83]
s_waitcnt vmcnt(15)
s_barrier
ds_read_b128 v[116:119], v9 offset:24576
v_mfma_f32_16x16x32_bf16 v[80:83], v[136:139], a[80:83], v[80:83]
ds_read_b128 v[120:123], v157 offset:24576
v_mfma_f32_16x16x32_bf16 v[16:19], v[136:139], v[136:139], v[16:19]
global_load_dwordx4 a[148:151], v7, s[30:31] offset:1024 sc1
v_mfma_f32_16x16x32_bf16 v[16:19], v[132:135], v[132:135], v[16:19]
s_waitcnt lgkmcnt(6)
v_mfma_f32_16x16x32_bf16 v[44:47], a[68:71], v[92:95], v[44:47]
v_mfma_f32_16x16x32_bf16 v[44:47], a[84:87], v[96:99], v[44:47]
v_mfma_f32_16x16x32_bf16 v[64:67], v[96:99], a[88:91], v[64:67]
ds_read_b128 v[124:127], v9 offset:43008
v_mfma_f32_16x16x32_bf16 v[64:67], v[92:95], a[72:75], v[64:67]
global_load_dwordx4 a[136:139], v7, s[30:31] offset:-2048 sc1
ds_read_b128 v[128:131], v157 offset:43008
v_mfma_f32_16x16x32_bf16 v[84:87], v[92:95], a[64:67], v[84:87]
v_mfma_f32_16x16x32_bf16 v[84:87], v[96:99], a[80:83], v[84:87]
s_waitcnt lgkmcnt(6)
v_mfma_f32_16x16x32_bf16 v[48:51], a[68:71], v[100:103], v[48:51]
v_mfma_f32_16x16x32_bf16 v[48:51], a[84:87], v[104:107], v[48:51]
v_mfma_f32_16x16x32_bf16 v[68:71], v[104:107], a[88:91], v[68:71]
global_load_dwordx4 a[152:155], v7, s[30:31] offset:2048 sc1
v_mfma_f32_16x16x32_bf16 v[68:71], v[100:103], a[72:75], v[68:71]
v_mfma_f32_16x16x32_bf16 v[88:91], v[100:103], a[64:67], v[88:91]
ds_read_b128 v[132:135], v10 offset:6144
v_mfma_f32_16x16x32_bf16 v[88:91], v[104:107], a[80:83], v[88:91]
ds_read_b128 v[136:139], v158 offset:6144
v_mfma_f32_16x16x32_bf16 v[20:23], v[104:107], v[104:107], v[20:23]
v_mfma_f32_16x16x32_bf16 v[20:23], v[100:103], v[100:103], v[20:23]
s_waitcnt lgkmcnt(6)
v_mfma_f32_16x16x32_bf16 v[32:35], a[68:71], v[108:111], v[32:35]
global_load_dwordx4 a[128:131], v7, s[30:31] offset:-4096 sc1
v_mfma_f32_16x16x32_bf16 v[32:35], a[84:87], v[112:115], v[32:35]
v_mfma_f32_16x16x32_bf16 v[52:55], v[112:115], a[88:91], v[52:55]
ds_read_b128 v[92:95], v10 offset:24576
v_mfma_f32_16x16x32_bf16 v[52:55], v[108:111], a[72:75], v[52:55]
ds_read_b128 v[96:99], v158 offset:24576
v_mfma_f32_16x16x32_bf16 v[72:75], v[108:111], a[64:67], v[72:75]
v_mfma_f32_16x16x32_bf16 v[72:75], v[112:115], a[80:83], v[72:75]
s_waitcnt vmcnt(17) lgkmcnt(6)
global_load_dwordx4 a[144:147], v7, s[30:31] offset:0 sc1
s_add_u32 s30, s30, 0x2000
v_mfma_f32_16x16x32_bf16 v[36:39], a[100:103], v[116:119], v[36:39]
s_addc_u32 s31, s31, 0
v_mfma_f32_16x16x32_bf16 v[36:39], a[116:119], v[120:123], v[36:39]
s_waitcnt vmcnt(16)
v_mfma_f32_16x16x32_bf16 v[56:59], v[120:123], a[120:123], v[56:59]
v_mfma_f32_16x16x32_bf16 v[56:59], v[116:119], a[104:107], v[56:59]
s_waitcnt vmcnt(14)
v_mfma_f32_16x16x32_bf16 v[76:79], v[116:119], a[96:99], v[76:79]
global_load_dwordx4 a[164:167], v7, s[30:31] offset:-3072 sc1
ds_read_b128 v[100:103], v9 offset:6144
v_mfma_f32_16x16x32_bf16 v[76:79], v[120:123], a[112:115], v[76:79]
s_waitcnt lgkmcnt(5)
ds_read_b128 v[104:107], v157 offset:6144
v_mfma_f32_16x16x32_bf16 v[40:43], a[100:103], v[124:127], v[40:43]
v_mfma_f32_16x16x32_bf16 v[40:43], a[116:119], v[128:131], v[40:43]
v_mfma_f32_16x16x32_bf16 v[60:63], v[128:131], a[120:123], v[60:63]
v_mfma_f32_16x16x32_bf16 v[60:63], v[124:127], a[104:107], v[60:63]
v_mfma_f32_16x16x32_bf16 v[80:83], v[124:127], a[96:99], v[80:83]
global_load_dwordx4 a[180:183], v7, s[30:31] offset:1024 sc1
ds_read_b128 v[108:111], v9 offset:26624
v_mfma_f32_16x16x32_bf16 v[80:83], v[128:131], a[112:115], v[80:83]
ds_read_b128 v[112:115], v157 offset:26624
v_mfma_f32_16x16x32_bf16 v[16:19], v[128:131], v[128:131], v[16:19]
v_mfma_f32_16x16x32_bf16 v[16:19], v[124:127], v[124:127], v[16:19]
s_waitcnt lgkmcnt(6)
v_mfma_f32_16x16x32_bf16 v[44:47], a[100:103], v[132:135], v[44:47]
v_mfma_f32_16x16x32_bf16 v[44:47], a[116:119], v[136:139], v[44:47]
global_load_dwordx4 a[168:171], v7, s[30:31] offset:-2048 sc1
v_mfma_f32_16x16x32_bf16 v[64:67], v[136:139], a[120:123], v[64:67]
ds_read_b128 v[116:119], v9 offset:45056
v_mfma_f32_16x16x32_bf16 v[64:67], v[132:135], a[104:107], v[64:67]
ds_read_b128 v[120:123], v157 offset:45056
v_mfma_f32_16x16x32_bf16 v[84:87], v[132:135], a[96:99], v[84:87]
v_mfma_f32_16x16x32_bf16 v[84:87], v[136:139], a[112:115], v[84:87]
s_waitcnt lgkmcnt(6)
v_mfma_f32_16x16x32_bf16 v[48:51], a[100:103], v[92:95], v[48:51]
global_load_dwordx4 a[184:187], v7, s[30:31] offset:2048 sc1
v_mfma_f32_16x16x32_bf16 v[48:51], a[116:119], v[96:99], v[48:51]
v_mfma_f32_16x16x32_bf16 v[68:71], v[96:99], a[120:123], v[68:71]
v_mfma_f32_16x16x32_bf16 v[68:71], v[92:95], a[104:107], v[68:71]
v_mfma_f32_16x16x32_bf16 v[88:91], v[92:95], a[96:99], v[88:91]
ds_read_b128 v[124:127], v10 offset:8192
v_mfma_f32_16x16x32_bf16 v[88:91], v[96:99], a[112:115], v[88:91]
global_load_dwordx4 a[160:163], v7, s[30:31] offset:-4096 sc1
ds_read_b128 v[128:131], v158 offset:8192
v_mfma_f32_16x16x32_bf16 v[20:23], v[96:99], v[96:99], v[20:23]
v_mfma_f32_16x16x32_bf16 v[20:23], v[92:95], v[92:95], v[20:23]
s_waitcnt lgkmcnt(6)
v_mfma_f32_16x16x32_bf16 v[32:35], a[100:103], v[100:103], v[32:35]
v_mfma_f32_16x16x32_bf16 v[32:35], a[116:119], v[104:107], v[32:35]
v_mfma_f32_16x16x32_bf16 v[52:55], v[104:107], a[120:123], v[52:55]
ds_read_b128 v[132:135], v10 offset:26624
v_mfma_f32_16x16x32_bf16 v[52:55], v[100:103], a[104:107], v[52:55]
global_load_dwordx4 a[176:179], v7, s[30:31] offset:0 sc1
ds_read_b128 v[136:139], v158 offset:26624
v_mfma_f32_16x16x32_bf16 v[72:75], v[100:103], a[96:99], v[72:75]
s_add_u32 s30, s30, 0x2000
s_addc_u32 s31, s31, 0
v_mfma_f32_16x16x32_bf16 v[72:75], v[104:107], a[112:115], v[72:75]
s_waitcnt vmcnt(10) lgkmcnt(6)
v_mfma_f32_16x16x32_bf16 v[36:39], a[132:135], v[108:111], v[36:39]
v_mfma_f32_16x16x32_bf16 v[36:39], a[148:151], v[112:115], v[36:39]
s_waitcnt vmcnt(8)
v_mfma_f32_16x16x32_bf16 v[56:59], v[112:115], a[152:155], v[56:59]
global_load_dwordx4 a[196:199], v7, s[30:31] offset:-3072 sc1
v_mfma_f32_16x16x32_bf16 v[56:59], v[108:111], a[136:139], v[56:59]
s_waitcnt vmcnt(7)
v_mfma_f32_16x16x32_bf16 v[76:79], v[108:111], a[128:131], v[76:79]
ds_read_b128 v[92:95], v9 offset:8192
v_mfma_f32_16x16x32_bf16 v[76:79], v[112:115], a[144:147], v[76:79]
s_waitcnt lgkmcnt(5)
ds_read_b128 v[96:99], v157 offset:8192
v_mfma_f32_16x16x32_bf16 v[40:43], a[132:135], v[116:119], v[40:43]
v_mfma_f32_16x16x32_bf16 v[40:43], a[148:151], v[120:123], v[40:43]
global_load_dwordx4 a[212:215], v7, s[30:31] offset:1024 sc1
v_mfma_f32_16x16x32_bf16 v[60:63], v[120:123], a[152:155], v[60:63]
v_mfma_f32_16x16x32_bf16 v[60:63], v[116:119], a[136:139], v[60:63]
v_mfma_f32_16x16x32_bf16 v[80:83], v[116:119], a[128:131], v[80:83]
ds_read_b128 v[100:103], v9 offset:28672
v_mfma_f32_16x16x32_bf16 v[80:83], v[120:123], a[144:147], v[80:83]
ds_read_b128 v[104:107], v157 offset:28672
v_mfma_f32_16x16x32_bf16 v[16:19], v[120:123], v[120:123], v[16:19]
v_mfma_f32_16x16x32_bf16 v[16:19], v[116:119], v[116:119], v[16:19]
s_waitcnt lgkmcnt(6)
global_load_dwordx4 a[200:203], v7, s[30:31] offset:-2048 sc1
v_mfma_f32_16x16x32_bf16 v[44:47], a[132:135], v[124:127], v[44:47]
v_mfma_f32_16x16x32_bf16 v[44:47], a[148:151], v[128:131], v[44:47]
v_mfma_f32_16x16x32_bf16 v[64:67], v[128:131], a[152:155], v[64:67]
ds_read_b128 v[108:111], v9 offset:47104
v_mfma_f32_16x16x32_bf16 v[64:67], v[124:127], a[136:139], v[64:67]
ds_read_b128 v[112:115], v157 offset:47104
v_mfma_f32_16x16x32_bf16 v[84:87], v[124:127], a[128:131], v[84:87]
global_load_dwordx4 a[216:219], v7, s[30:31] offset:2048 sc1
v_mfma_f32_16x16x32_bf16 v[84:87], v[128:131], a[144:147], v[84:87]
s_waitcnt lgkmcnt(6)
v_mfma_f32_16x16x32_bf16 v[48:51], a[132:135], v[132:135], v[48:51]
v_mfma_f32_16x16x32_bf16 v[48:51], a[148:151], v[136:139], v[48:51]
v_mfma_f32_16x16x32_bf16 v[68:71], v[136:139], a[152:155], v[68:71]
v_mfma_f32_16x16x32_bf16 v[68:71], v[132:135], a[136:139], v[68:71]
global_load_dwordx4 a[192:195], v7, s[30:31] offset:-4096 sc1
v_mfma_f32_16x16x32_bf16 v[88:91], v[132:135], a[128:131], v[88:91]
ds_read_b128 v[116:119], v10 offset:10240
v_mfma_f32_16x16x32_bf16 v[88:91], v[136:139], a[144:147], v[88:91]
ds_read_b128 v[120:123], v158 offset:10240
v_mfma_f32_16x16x32_bf16 v[20:23], v[136:139], v[136:139], v[20:23]
v_mfma_f32_16x16x32_bf16 v[20:23], v[132:135], v[132:135], v[20:23]
s_waitcnt lgkmcnt(6)
v_mfma_f32_16x16x32_bf16 v[32:35], a[132:135], v[92:95], v[32:35]
global_load_dwordx4 a[208:211], v7, s[30:31] offset:0 sc1
s_add_u32 s30, s30, 0x2000
v_mfma_f32_16x16x32_bf16 v[32:35], a[148:151], v[96:99], v[32:35]
s_addc_u32 s31, s31, 0
v_mfma_f32_16x16x32_bf16 v[52:55], v[96:99], a[152:155], v[52:55]
ds_read_b128 v[124:127], v10 offset:28672
v_mfma_f32_16x16x32_bf16 v[52:55], v[92:95], a[136:139], v[52:55]
ds_read_b128 v[128:131], v158 offset:28672
v_mfma_f32_16x16x32_bf16 v[72:75], v[92:95], a[128:131], v[72:75]
v_mfma_f32_16x16x32_bf16 v[72:75], v[96:99], a[144:147], v[72:75]
s_waitcnt vmcnt(10) lgkmcnt(6)
v_mfma_f32_16x16x32_bf16 v[36:39], a[164:167], v[100:103], v[36:39]
global_load_dword v152, v153, s[22:23] sc1
v_mfma_f32_16x16x32_bf16 v[36:39], a[180:183], v[104:107], v[36:39]
s_waitcnt vmcnt(9)
v_mfma_f32_16x16x32_bf16 v[56:59], v[104:107], a[184:187], v[56:59]
v_mfma_f32_16x16x32_bf16 v[56:59], v[100:103], a[168:171], v[56:59]
s_waitcnt vmcnt(7)
v_mfma_f32_16x16x32_bf16 v[76:79], v[100:103], a[160:163], v[76:79]
ds_read_b128 v[132:135], v9 offset:10240
v_mfma_f32_16x16x32_bf16 v[76:79], v[104:107], a[176:179], v[76:79]
s_waitcnt lgkmcnt(5)
global_load_dwordx4 a[228:231], v7, s[30:31] offset:-3072 sc1
ds_read_b128 v[136:139], v157 offset:10240
v_mfma_f32_16x16x32_bf16 v[40:43], a[164:167], v[108:111], v[40:43]
v_mfma_f32_16x16x32_bf16 v[40:43], a[180:183], v[112:115], v[40:43]
v_mfma_f32_16x16x32_bf16 v[60:63], v[112:115], a[184:187], v[60:63]
v_mfma_f32_16x16x32_bf16 v[60:63], v[108:111], a[168:171], v[60:63]
v_mfma_f32_16x16x32_bf16 v[80:83], v[108:111], a[160:163], v[80:83]
global_load_dwordx4 a[244:247], v7, s[30:31] offset:1024 sc1
s_barrier
ds_read_b128 v[92:95], v9 offset:30720
v_mfma_f32_16x16x32_bf16 v[80:83], v[112:115], a[176:179], v[80:83]
ds_read_b128 v[96:99], v157 offset:30720
v_mfma_f32_16x16x32_bf16 v[16:19], v[112:115], v[112:115], v[16:19]
v_mfma_f32_16x16x32_bf16 v[16:19], v[108:111], v[108:111], v[16:19]
s_waitcnt lgkmcnt(6)
v_mfma_f32_16x16x32_bf16 v[44:47], a[164:167], v[116:119], v[44:47]
v_mfma_f32_16x16x32_bf16 v[44:47], a[180:183], v[120:123], v[44:47]
v_mfma_f32_16x16x32_bf16 v[64:67], v[120:123], a[184:187], v[64:67]
global_load_dwordx4 a[232:235], v7, s[30:31] offset:-2048 sc1
ds_read_b128 v[100:103], v9 offset:49152
v_mfma_f32_16x16x32_bf16 v[64:67], v[116:119], a[168:171], v[64:67]
ds_read_b128 v[104:107], v157 offset:49152
v_mfma_f32_16x16x32_bf16 v[84:87], v[116:119], a[160:163], v[84:87]
v_mfma_f32_16x16x32_bf16 v[84:87], v[120:123], a[176:179], v[84:87]
s_waitcnt lgkmcnt(6)
v_mfma_f32_16x16x32_bf16 v[48:51], a[164:167], v[124:127], v[48:51]
v_mfma_f32_16x16x32_bf16 v[48:51], a[180:183], v[128:131], v[48:51]
global_load_dwordx4 a[248:251], v7, s[30:31] offset:2048 sc1
v_mfma_f32_16x16x32_bf16 v[68:71], v[128:131], a[184:187], v[68:71]
v_mfma_f32_16x16x32_bf16 v[68:71], v[124:127], a[168:171], v[68:71]
v_mfma_f32_16x16x32_bf16 v[88:91], v[124:127], a[160:163], v[88:91]
ds_read_b128 v[108:111], v10 offset:12288
v_mfma_f32_16x16x32_bf16 v[88:91], v[128:131], a[176:179], v[88:91]
ds_read_b128 v[112:115], v158 offset:12288
v_mfma_f32_16x16x32_bf16 v[20:23], v[128:131], v[128:131], v[20:23]
global_load_dwordx4 a[224:227], v7, s[30:31] offset:-4096 sc1
v_mfma_f32_16x16x32_bf16 v[20:23], v[124:127], v[124:127], v[20:23]
s_waitcnt lgkmcnt(6)
v_mfma_f32_16x16x32_bf16 v[32:35], a[164:167], v[132:135], v[32:35]
v_mfma_f32_16x16x32_bf16 v[32:35], a[180:183], v[136:139], v[32:35]
v_mfma_f32_16x16x32_bf16 v[52:55], v[136:139], a[184:187], v[52:55]
ds_read_b128 v[116:119], v10 offset:30720
v_mfma_f32_16x16x32_bf16 v[52:55], v[132:135], a[168:171], v[52:55]
global_load_dwordx4 a[240:243], v7, s[30:31] offset:0 sc1
ds_read_b128 v[120:123], v158 offset:30720
v_mfma_f32_16x16x32_bf16 v[72:75], v[132:135], a[160:163], v[72:75]
s_add_u32 s30, s30, 0x2000
s_addc_u32 s31, s31, 0
v_mfma_f32_16x16x32_bf16 v[72:75], v[136:139], a[176:179], v[72:75]
s_waitcnt vmcnt(11) lgkmcnt(6)
v_mfma_f32_16x16x32_bf16 v[36:39], a[196:199], v[92:95], v[36:39]
v_mfma_f32_16x16x32_bf16 v[36:39], a[212:215], v[96:99], v[36:39]
s_waitcnt vmcnt(9)
v_mfma_f32_16x16x32_bf16 v[56:59], v[96:99], a[216:219], v[56:59]
v_mfma_f32_16x16x32_bf16 v[56:59], v[92:95], a[200:203], v[56:59]
s_waitcnt vmcnt(7)
global_load_dwordx4 v[196:199], v7, s[30:31] offset:-3072 sc1
v_mfma_f32_16x16x32_bf16 v[76:79], v[92:95], a[192:195], v[76:79]
ds_read_b128 v[124:127], v9 offset:12288
v_mfma_f32_16x16x32_bf16 v[76:79], v[96:99], a[208:211], v[76:79]
s_waitcnt lgkmcnt(5)
ds_read_b128 v[128:131], v157 offset:12288
v_mfma_f32_16x16x32_bf16 v[40:43], a[196:199], v[100:103], v[40:43]
v_mfma_f32_16x16x32_bf16 v[40:43], a[212:215], v[104:107], v[40:43]
v_mfma_f32_16x16x32_bf16 v[60:63], v[104:107], a[216:219], v[60:63]
global_load_dwordx4 v[212:215], v7, s[30:31] offset:1024 sc1
v_mfma_f32_16x16x32_bf16 v[60:63], v[100:103], a[200:203], v[60:63]
v_mfma_f32_16x16x32_bf16 v[80:83], v[100:103], a[192:195], v[80:83]
ds_read_b128 v[132:135], v9 offset:32768
v_mfma_f32_16x16x32_bf16 v[80:83], v[104:107], a[208:211], v[80:83]
ds_read_b128 v[136:139], v157 offset:32768
ds_read_b64 v[244:245], v13
v_mfma_f32_16x16x32_bf16 v[16:19], v[104:107], v[104:107], v[16:19]
ds_read_b64 v[246:247], v14
v_mfma_f32_16x16x32_bf16 v[16:19], v[100:103], v[100:103], v[16:19]
s_waitcnt lgkmcnt(8)
global_load_dwordx4 v[200:203], v7, s[30:31] offset:-2048 sc1
ds_read_b64 v[248:249], v159
v_mfma_f32_16x16x32_bf16 v[44:47], a[196:199], v[108:111], v[44:47]
ds_read_b64 v[250:251], v160
v_mfma_f32_16x16x32_bf16 v[44:47], a[212:215], v[112:115], v[44:47]
ds_read_b64 v[252:253], v15
v_mfma_f32_16x16x32_bf16 v[64:67], v[112:115], a[216:219], v[64:67]
ds_read_b128 v[92:95], v9 offset:51200
v_lshrrev_b32 v2, 5, v1
v_mfma_f32_16x16x32_bf16 v[64:67], v[108:111], a[200:203], v[64:67]
ds_read_b128 v[96:99], v157 offset:51200
v_lshl_add_u32 v2, v2, 3, v1
v_mfma_f32_16x16x32_bf16 v[84:87], v[108:111], a[192:195], v[84:87]
v_mul_u32_u24 v3, 144, v2
v_mfma_f32_16x16x32_bf16 v[84:87], v[112:115], a[208:211], v[84:87]
s_waitcnt lgkmcnt(11)
global_load_dwordx4 v[216:219], v7, s[30:31] offset:2048 sc1
v_add_u32 v13, s47, v3
v_mfma_f32_16x16x32_bf16 v[48:51], a[196:199], v[116:119], v[48:51]
v_lshl_add_u32 v14, v2, 2, s46
v_mfma_f32_16x16x32_bf16 v[48:51], a[212:215], v[120:123], v[48:51]
v_and_b32 v243, -3, v2
v_mfma_f32_16x16x32_bf16 v[68:71], v[120:123], a[216:219], v[68:71]
v_lshl_add_u32 v243, v243, 3, s62
v_mfma_f32_16x16x32_bf16 v[68:71], v[116:119], a[200:203], v[68:71]
v_lshlrev_b32 v2, 2, v2
v_mfma_f32_16x16x32_bf16 v[88:91], v[116:119], a[192:195], v[88:91]
global_load_dwordx4 v[192:195], v7, s[30:31] offset:-4096 sc1
ds_read_b128 v[100:103], v10 offset:14336
v_mfma_f32_16x16x32_bf16 v[88:91], v[120:123], a[208:211], v[88:91]
ds_read_b128 v[104:107], v158 offset:14336
v_and_b32 v3, -16, v2
v_mfma_f32_16x16x32_bf16 v[20:23], v[120:123], v[120:123], v[20:23]
v_add_u32 v3, 127360, v3
v_mfma_f32_16x16x32_bf16 v[20:23], v[116:119], v[116:119], v[20:23]
s_waitcnt lgkmcnt(11)
v_add_u32 v2, 126752, v2
v_mfma_f32_16x16x32_bf16 v[32:35], a[196:199], v[124:127], v[32:35]
v_lshlrev_b32 v4, 2, v12
v_mfma_f32_16x16x32_bf16 v[32:35], a[212:215], v[128:131], v[32:35]
global_load_dwordx4 v[208:211], v7, s[30:31] offset:0 sc1
s_add_u32 s30, s30, 0x2000
v_mfma_f32_16x16x32_bf16 v[52:55], v[128:131], a[216:219], v[52:55]
s_addc_u32 s31, s31, 0
ds_read_b128 v[108:111], v10 offset:32768
s_mul_i32 s40, s26, 94208
v_mfma_f32_16x16x32_bf16 v[52:55], v[124:127], a[200:203], v[52:55]
s_mul_i32 s41, s24, 6144
ds_read_b128 v[112:115], v158 offset:32768
s_add_u32 s40, s40, s41
v_mfma_f32_16x16x32_bf16 v[72:75], v[124:127], a[192:195], v[72:75]
s_add_u32 s40, s40, 2359296
s_add_u32 s34, s22, s40
s_addc_u32 s35, s23, 0
v_mfma_f32_16x16x32_bf16 v[72:75], v[128:131], a[208:211], v[72:75]
s_waitcnt vmcnt(10) lgkmcnt(11)
s_add_u32 m0, s41, 137216
s_lshl_b32 s40, s26, 2
v_mfma_f32_16x16x32_bf16 v[36:39], a[228:231], v[132:135], v[36:39]
s_add_u32 s40, s40, s24
s_mul_i32 s40, s40, 331776
s_add_u32 s40, s40, 3116032
v_mfma_f32_16x16x32_bf16 v[36:39], a[244:247], v[136:139], v[36:39]
s_waitcnt vmcnt(8)
s_add_u32 s30, s22, s40
s_addc_u32 s31, s23, 0
v_mfma_f32_16x16x32_bf16 v[56:59], v[136:139], a[248:251], v[56:59]
s_mov_b32 s10, s30
s_mov_b32 s11, s31
s_and_b32 s8, s25, 7
v_mfma_f32_16x16x32_bf16 v[56:59], v[132:135], a[232:235], v[56:59]
s_waitcnt vmcnt(6)
s_add_u32 s9, s8, 2
s_and_b32 s9, s9, 7
v_mfma_f32_16x16x32_bf16 v[76:79], v[132:135], a[224:227], v[76:79]
s_add_u32 s8, s8, 1
ds_read_b128 v[116:119], v9 offset:14336
s_cmp_gt_u32 s8, 6
v_mfma_f32_16x16x32_bf16 v[76:79], v[136:139], a[240:243], v[76:79]
s_waitcnt lgkmcnt(5)
ds_read_b128 v[120:123], v157 offset:14336
s_cselect_b32 s8, 63, s8
v_mfma_f32_16x16x32_bf16 v[40:43], a[228:231], v[92:95], v[40:43]
s_add_u32 s9, s9, 11
s_cmp_gt_u32 s9, 15
s_cselect_b32 s9, 63, s9
v_mfma_f32_16x16x32_bf16 v[40:43], a[244:247], v[96:99], v[40:43]
v_cmp_ne_u32 vcc, v152, v154
s_cbranch_vccnz L_rdy_s_23
L_rdy_b_24:
v_mfma_f32_16x16x32_bf16 v[60:63], v[96:99], a[248:251], v[60:63]
global_load_lds_dwordx4 v7, s[34:35] offset:0 sc1
v_add_u32 v4, 126720, v4
v_mfma_f32_16x16x32_bf16 v[60:63], v[92:95], a[232:235], v[60:63]
global_load_lds_dwordx4 v7, s[34:35] offset:1024 sc1
v_lshl_add_u32 v242, v1, 2, s43
v_mfma_f32_16x16x32_bf16 v[80:83], v[92:95], a[224:227], v[80:83]
global_load_lds_dwordx4 v7, s[34:35] offset:2048 sc1
ds_read_b128 v[124:127], v9 offset:34816
v_mfma_f32_16x16x32_bf16 v[80:83], v[96:99], a[240:243], v[80:83]
s_add_u32 m0, m0, 0xc00
ds_read_b128 v[128:131], v157 offset:34816
s_add_u32 s34, s34, 0xc00
v_mfma_f32_16x16x32_bf16 v[16:19], v[96:99], v[96:99], v[16:19]
s_addc_u32 s35, s35, 0
global_load_lds_dwordx4 v7, s[34:35] offset:0 sc1
v_mul_u32_u24 v241, 18432, v5
v_mfma_f32_16x16x32_bf16 v[16:19], v[92:95], v[92:95], v[16:19]
s_waitcnt lgkmcnt(6)
v_lshl_add_u32 v241, v6, 4, v241
v_mfma_f32_16x16x32_bf16 v[44:47], a[228:231], v[100:103], v[44:47]
v_add_u32 v15, s44, v7
v_mfma_f32_16x16x32_bf16 v[44:47], a[244:247], v[104:107], v[44:47]
v_add_u32 v241, s42, v241
v_mfma_f32_16x16x32_bf16 v[64:67], v[104:107], a[248:251], v[64:67]
global_load_lds_dwordx4 v7, s[34:35] offset:1024 sc1
ds_read_b128 v[132:135], v9 offset:53248
v_mfma_f32_16x16x32_bf16 v[64:67], v[100:103], a[232:235], v[64:67]
ds_read_b128 v[136:139], v157 offset:53248
v_mov_b32 v232, 0xffff
v_mfma_f32_16x16x32_bf16 v[84:87], v[100:103], a[224:227], v[84:87]
v_cndmask_b32 v230, -1, v232, s[56:57]
v_mfma_f32_16x16x32_bf16 v[84:87], v[104:107], a[240:243], v[84:87]
s_waitcnt lgkmcnt(6)
v_cndmask_b32 v231, -1, v232, s[60:61]
v_mfma_f32_16x16x32_bf16 v[48:51], a[228:231], v[108:111], v[48:51]
global_load_lds_dwordx4 v7, s[34:35] offset:2048 sc1
s_add_u32 s34, s34, s45
v_mfma_f32_16x16x32_bf16 v[48:51], a[244:247], v[112:115], v[48:51]
s_addc_u32 s35, s35, 0
s_lshl_b32 s41, s24, 10
s_add_u32 m0, s41, 161792
v_mfma_f32_16x16x32_bf16 v[68:71], v[112:115], a[248:251], v[68:71]
v_cndmask_b32 v231, v231, 0, s[58:59]
v_mfma_f32_16x16x32_bf16 v[68:71], v[108:111], a[232:235], v[68:71]
v_mfma_f32_16x16x32_bf16 v[88:91], v[108:111], a[224:227], v[88:91]
global_load_dwordx4 a[0:3], v7, s[30:31] offset:-3072 sc1
ds_read_b128 v[92:95], v10 offset:16384
v_mfma_f32_16x16x32_bf16 v[88:91], v[112:115], a[240:243], v[88:91]
ds_read_b128 v[96:99], v158 offset:16384
v_mfma_f32_16x16x32_bf16 v[20:23], v[112:115], v[112:115], v[20:23]
v_mfma_f32_16x16x32_bf16 v[20:23], v[108:111], v[108:111], v[20:23]
s_waitcnt lgkmcnt(6)
v_mfma_f32_16x16x32_bf16 v[32:35], a[228:231], v[116:119], v[32:35]
global_load_dwordx4 a[4:7], v7, s[30:31] offset:-2048 sc1
v_mfma_f32_16x16x32_bf16 v[32:35], a[244:247], v[120:123], v[32:35]
v_mfma_f32_16x16x32_bf16 v[52:55], v[120:123], a[248:251], v[52:55]
ds_read_b128 v[100:103], v10 offset:34816
v_mfma_f32_16x16x32_bf16 v[52:55], v[116:119], a[232:235], v[52:55]
ds_read_b128 v[104:107], v158 offset:34816
v_mfma_f32_16x16x32_bf16 v[72:75], v[116:119], a[224:227], v[72:75]
global_load_dwordx4 a[8:11], v7, s[30:31] offset:-1024 sc1
v_mfma_f32_16x16x32_bf16 v[72:75], v[120:123], a[240:243], v[72:75]
s_waitcnt vmcnt(13) lgkmcnt(6)
v_mfma_f32_16x16x32_bf16 v[36:39], v[196:199], v[124:127], v[36:39]
v_mfma_f32_16x16x32_bf16 v[36:39], v[212:215], v[128:131], v[36:39]
s_waitcnt vmcnt(11)
v_mfma_f32_16x16x32_bf16 v[56:59], v[128:131], v[216:219], v[56:59]
global_load_dwordx4 a[12:15], v7, s[30:31] offset:0 sc1
v_mfma_f32_16x16x32_bf16 v[56:59], v[124:127], v[200:203], v[56:59]
s_waitcnt vmcnt(10)
v_mfma_f32_16x16x32_bf16 v[76:79], v[124:127], v[192:195], v[76:79]
ds_read_b128 v[108:111], v9 offset:16384
v_mfma_f32_16x16x32_bf16 v[76:79], v[128:131], v[208:211], v[76:79]
s_waitcnt lgkmcnt(5)
ds_read_b128 v[112:115], v157 offset:16384
v_cvt_pk_bf16_f32 v140, v36, v37
v_cvt_pk_bf16_f32 v141, v38, v39
v_mfma_f32_16x16x32_bf16 v[40:43], v[196:199], v[132:135], v[40:43]
global_load_dwordx4 a[16:19], v7, s[30:31] offset:1024 sc1
ds_write_b64 v11, v[140:141] offset:12672
v_mfma_f32_16x16x32_bf16 v[40:43], v[212:215], v[136:139], v[40:43]
v_cvt_pk_bf16_f32 v142, v56, v57
v_cvt_pk_bf16_f32 v143, v58, v59
v_mfma_f32_16x16x32_bf16 v[60:63], v[136:139], v[216:219], v[60:63]
ds_write_b64 v165, v[142:143] offset:24192
v_mfma_f32_16x16x32_bf16 v[60:63], v[132:135], v[200:203], v[60:63]
v_cvt_pk_bf16_f32 v144, v76, v77
v_cvt_pk_bf16_f32 v145, v78, v79
v_mfma_f32_16x16x32_bf16 v[80:83], v[132:135], v[192:195], v[80:83]
global_load_dwordx4 a[20:23], v7, s[30:31] offset:2048 sc1
s_add_u32 s30, s30, 0x1800
v_mfma_f32_16x16x32_bf16 v[80:83], v[136:139], v[208:211], v[80:83]
s_addc_u32 s31, s31, 0
ds_write_b64 v166, v[144:145] offset:64
v_mfma_f32_16x16x32_bf16 v[16:19], v[136:139], v[136:139], v[16:19]
ds_write_b128 v163, v[76:79] offset:32
v_mfma_f32_16x16x32_bf16 v[16:19], v[132:135], v[132:135], v[16:19]
s_waitcnt lgkmcnt(8)
v_cvt_pk_bf16_f32 v146, v40, v41
v_cvt_pk_bf16_f32 v147, v42, v43
v_mfma_f32_16x16x32_bf16 v[44:47], v[196:199], v[92:95], v[44:47]
global_load_dwordx4 a[24:27], v7, s[30:31] offset:-3072 sc1
ds_write_b64 v11, v[146:147] offset:13824
v_mfma_f32_16x16x32_bf16 v[44:47], v[212:215], v[96:99], v[44:47]
v_cvt_pk_bf16_f32 v148, v60, v61
v_cvt_pk_bf16_f32 v149, v62, v63
v_mfma_f32_16x16x32_bf16 v[64:67], v[96:99], v[216:219], v[64:67]
ds_write_b64 v165, v[148:149] offset:25344
v_mfma_f32_16x16x32_bf16 v[64:67], v[92:95], v[200:203], v[64:67]
v_cvt_pk_bf16_f32 v150, v80, v81
v_cvt_pk_bf16_f32 v151, v82, v83
v_mfma_f32_16x16x32_bf16 v[84:87], v[92:95], v[192:195], v[84:87]
global_load_dwordx4 a[28:31], v7, s[30:31] offset:-2048 sc1
ds_write_b64 v166, v[150:151] offset:128
v_mfma_f32_16x16x32_bf16 v[84:87], v[96:99], v[208:211], v[84:87]
s_waitcnt lgkmcnt(9)
ds_write_b128 v163, v[80:83] offset:64
v_mfma_f32_16x16x32_bf16 v[48:51], v[196:199], v[100:103], v[48:51]
v_cndmask_b32 v16, v16, v17, s[50:51]
v_cndmask_b32 v16, v16, v18, s[52:53]
v_cndmask_b32 v16, v16, v19, s[54:55]
v_mfma_f32_16x16x32_bf16 v[48:51], v[212:215], v[104:107], v[48:51]
ds_write_b32 v162, v16 offset:64
v_mfma_f32_16x16x32_bf16 v[68:71], v[104:107], v[216:219], v[68:71]
global_load_dwordx4 a[32:35], v7, s[30:31] offset:-1024 sc1
v_cvt_pk_bf16_f32 v140, v44, v45
v_cvt_pk_bf16_f32 v141, v46, v47
v_mfma_f32_16x16x32_bf16 v[68:71], v[100:103], v[200:203], v[68:71]
ds_write_b64 v11, v[140:141] offset:14976
v_mfma_f32_16x16x32_bf16 v[88:91], v[100:103], v[192:195], v[88:91]
v_cvt_pk_bf16_f32 v142, v64, v65
v_cvt_pk_bf16_f32 v143, v66, v67
v_mfma_f32_16x16x32_bf16 v[88:91], v[104:107], v[208:211], v[88:91]
ds_write_b64 v165, v[142:143] offset:26496
v_mfma_f32_16x16x32_bf16 v[20:23], v[104:107], v[104:107], v[20:23]
global_load_dwordx4 a[36:39], v7, s[30:31] offset:0 sc1
v_cvt_pk_bf16_f32 v144, v84, v85
v_cvt_pk_bf16_f32 v145, v86, v87
v_mfma_f32_16x16x32_bf16 v[20:23], v[100:103], v[100:103], v[20:23]
s_waitcnt lgkmcnt(11)
ds_write_b64 v166, v[144:145] offset:192
v_mfma_f32_16x16x32_bf16 v[32:35], v[196:199], v[108:111], v[32:35]
ds_write_b128 v163, v[84:87] offset:96
v_mfma_f32_16x16x32_bf16 v[32:35], v[212:215], v[112:115], v[32:35]
v_cvt_pk_bf16_f32 v146, v48, v49
v_cvt_pk_bf16_f32 v147, v50, v51
v_mfma_f32_16x16x32_bf16 v[52:55], v[112:115], v[216:219], v[52:55]
ds_write_b64 v11, v[146:147] offset:16128
v_mfma_f32_16x16x32_bf16 v[52:55], v[108:111], v[200:203], v[52:55]
v_cvt_pk_bf16_f32 v148, v68, v69
v_cvt_pk_bf16_f32 v149, v70, v71
v_mfma_f32_16x16x32_bf16 v[72:75], v[108:111], v[192:195], v[72:75]
ds_write_b64 v165, v[148:149] offset:27648
v_mfma_f32_16x16x32_bf16 v[72:75], v[112:115], v[208:211], v[72:75]
v_cvt_pk_bf16_f32 v150, v88, v89
v_cvt_pk_bf16_f32 v151, v90, v91
ds_write_b64 v166, v[150:151] offset:256
ds_write_b128 v163, v[88:91] offset:128
v_cndmask_b32 v20, v20, v21, s[50:51]
v_cndmask_b32 v20, v20, v22, s[52:53]
v_cndmask_b32 v20, v20, v23, s[54:55]
ds_write_b32 v162, v20 offset:128
v_cvt_pk_bf16_f32 v140, v32, v33
v_cvt_pk_bf16_f32 v141, v34, v35
ds_write_b64 v11, v[140:141] offset:11520
v_cvt_pk_bf16_f32 v142, v52, v53
v_cvt_pk_bf16_f32 v143, v54, v55
ds_write_b64 v165, v[142:143] offset:23040
v_cvt_pk_bf16_f32 v144, v72, v73
v_cvt_pk_bf16_f32 v145, v74, v75
ds_write_b64 v166, v[144:145] offset:0
ds_write_b128 v163, v[72:75] offset:0
L_q_att:
v_mov_b32 v25, 0
v_mov_b32 v37, 0
v_mov_b32 v47, 0
v_mov_b32 v57, 0
s_mov_b32 s40, 0x3ae38e39
ds_read_b128 v[28:31], v13 offset:12672
ds_read_b128 v[32:35], v13 offset:12688
ds_read_b128 v[38:41], v13 offset:12096
ds_read_b128 v[42:45], v13 offset:12112
ds_read_b128 v[48:51], v13 offset:11520
ds_read_b128 v[52:55], v13 offset:11536
ds_read_b128 v[60:63], v13 offset:24192
ds_read_b128 v[64:67], v13 offset:24208
ds_read_b128 v[70:73], v13 offset:23616
ds_read_b128 v[74:77], v13 offset:23632
ds_read_b128 v[80:83], v13 offset:23040
ds_read_b128 v[84:87], v13 offset:23056
s_waitcnt lgkmcnt(12)
s_barrier
ds_read2_b32 v[236:237], v2 offset0:0 offset1:80
ds_read2_b32 v[238:239], v4 offset0:0 offset1:80
ds_read_b128 v[16:19], v13 offset:1152
ds_read_b128 v[20:23], v13 offset:1168
ds_read_b32 v24, v14 offset:32
ds_read_b32 v36, v14 offset:1312
ds_read_b32 v46, v14 offset:1296
ds_read_b32 v56, v14 offset:1280
s_cmp_ge_u32 s24, 2
s_cbranch_scc1 L_q_wo_skip
global_load_lds_dwordx4 v15, s[34:35] sc1
L_q_wo_skip:
s_lshl_b32 m0, s24, 12
s_nop 0
global_load_lds_dwordx4 v7, s[34:35] offset:0 sc1
global_load_lds_dwordx4 v7, s[34:35] offset:1024 sc1
global_load_lds_dwordx4 v7, s[34:35] offset:2048 sc1
s_waitcnt lgkmcnt(6)
v_pk_mul_f32 v[236:237], v[236:237], s[40:41] op_sel_hi:[1,0]
v_pk_mul_f32 v[238:239], v[238:239], s[40:41] op_sel_hi:[1,0]
v_fma_f32 v236, -v236, v236, v237
v_max_f32 v236, 0, v236
v_add_f32 v236, 0x3727c5ac, v236
v_rsq_f32 v236, v236
v_fma_f32 v238, -v238, v238, v239
v_max_f32 v238, 0, v238
v_add_f32 v238, 0x3727c5ac, v238
v_rsq_f32 v238, v238
ds_write_b32 v2, v236 offset:640
ds_write_b32 v4, v238 offset:640
ds_read_b128 v[104:107], v3 offset:32
ds_read_b128 v[108:111], v3 offset:16
ds_read_b128 v[112:115], v3 offset:0
ds_read_b64 v[68:69], v243 offset:64
ds_read_b64 v[78:79], v243 offset:32
ds_read_b64 v[88:89], v243 offset:0
global_load_lds_dwordx4 v7, s[34:35] offset:3072 sc1
s_waitcnt lgkmcnt(8)
v_mfma_f32_4x4x4_16b_bf16 v[92:95], v[28:29], v[16:17], 0
v_mfma_f32_4x4x4_16b_bf16 v[96:99], v[38:39], v[16:17], 0
v_mfma_f32_4x4x4_16b_bf16 v[100:103], v[48:49], v[16:17], 0
v_mfma_f32_4x4x4_16b_bf16 v[92:95], v[30:31], v[18:19], v[92:95]
v_mfma_f32_4x4x4_16b_bf16 v[96:99], v[40:41], v[18:19], v[96:99]
v_mfma_f32_4x4x4_16b_bf16 v[100:103], v[50:51], v[18:19], v[100:103]
v_mfma_f32_4x4x4_16b_bf16 v[92:95], v[32:33], v[20:21], v[92:95]
v_mfma_f32_4x4x4_16b_bf16 v[96:99], v[42:43], v[20:21], v[96:99]
v_mfma_f32_4x4x4_16b_bf16 v[100:103], v[52:53], v[20:21], v[100:103]
v_mfma_f32_4x4x4_16b_bf16 v[92:95], v[34:35], v[22:23], v[92:95]
v_mfma_f32_4x4x4_16b_bf16 v[96:99], v[44:45], v[22:23], v[96:99]
v_mfma_f32_4x4x4_16b_bf16 v[100:103], v[54:55], v[22:23], v[100:103]
v_mfma_f32_4x4x4_16b_bf16 v[92:95], v[36:37], v[24:25], v[92:95]
v_mfma_f32_4x4x4_16b_bf16 v[96:99], v[46:47], v[24:25], v[96:99]
v_mfma_f32_4x4x4_16b_bf16 v[100:103], v[56:57], v[24:25], v[100:103]
s_add_u32 m0, m0, 0x4000
s_add_u32 s34, s34, 0x4000
s_addc_u32 s35, s35, 0
global_load_lds_dwordx4 v7, s[34:35] offset:0 sc1
global_load_lds_dwordx4 v7, s[34:35] offset:1024 sc1
s_waitcnt lgkmcnt(3)
v_mul_f32 v236, 0x3eae1a93, v236
v_cndmask_b32 v105, v105, v113, s[56:57]
v_cndmask_b32 v106, v106, v114, s[58:59]
v_cndmask_b32 v107, v107, v115, s[60:61]
v_cndmask_b32 v93, v93, v101, s[56:57]
v_cndmask_b32 v94, v94, v102, s[58:59]
v_cndmask_b32 v95, v95, v103, s[60:61]
v_pk_mul_f32 v[92:93], v[92:93], v[104:105]
v_pk_mul_f32 v[94:95], v[94:95], v[106:107]
v_pk_mul_f32 v[96:97], v[96:97], v[108:109]
v_pk_mul_f32 v[98:99], v[98:99], v[110:111]
v_pk_mul_f32 v[92:93], v[92:93], v[236:237] op_sel_hi:[1,0]
v_pk_mul_f32 v[94:95], v[94:95], v[236:237] op_sel_hi:[1,0]
v_pk_mul_f32 v[96:97], v[96:97], v[236:237] op_sel_hi:[1,0]
v_pk_mul_f32 v[98:99], v[98:99], v[236:237] op_sel_hi:[1,0]
s_cmp_lg_u32 s25, 0
s_cbranch_scc1 L_q_nomask
s_mov_b32 exec_lo, 0x11
s_mov_b32 exec_hi, 0x11
v_mov_b32 v93, 0xceabfb8f
s_mov_b32 exec_lo, 0x33
s_mov_b32 exec_hi, 0x33
v_mov_b32 v94, 0xceabfb8f
s_mov_b32 exec_lo, 0x77
s_mov_b32 exec_hi, 0x77
v_mov_b32 v95, 0xceabfb8f
s_mov_b32 exec_lo, 0xf
s_mov_b32 exec_hi, 0xf
v_mov_b32 v96, 0xceabfb8f
v_mov_b32 v97, 0xceabfb8f
v_mov_b32 v98, 0xceabfb8f
v_mov_b32 v99, 0xceabfb8f
s_mov_b64 exec, -1
L_q_nomask:
v_max3_f32 v237, v92, v93, v94
v_max3_f32 v238, v95, v96, v97
v_max3_f32 v237, v237, v98, v99
v_max_f32 v238, v237, v238
v_pk_add_f32 v[92:93], v[92:93], v[238:239] op_sel_hi:[1,0] neg_lo:[0,1] neg_hi:[0,1]
v_pk_add_f32 v[94:95], v[94:95], v[238:239] op_sel_hi:[1,0] neg_lo:[0,1] neg_hi:[0,1]
v_pk_add_f32 v[96:97], v[96:97], v[238:239] op_sel_hi:[1,0] neg_lo:[0,1] neg_hi:[0,1]
v_pk_add_f32 v[98:99], v[98:99], v[238:239] op_sel_hi:[1,0] neg_lo:[0,1] neg_hi:[0,1]
v_exp_f32 v92, v92
v_exp_f32 v93, v93
v_exp_f32 v94, v94
v_exp_f32 v95, v95
v_exp_f32 v96, v96
v_exp_f32 v97, v97
v_exp_f32 v98, v98
v_exp_f32 v99, v99
v_pk_add_f32 v[236:237], v[92:93], v[94:95]
v_pk_add_f32 v[238:239], v[96:97], v[98:99]
v_pk_add_f32 v[236:237], v[236:237], v[238:239]
v_add_f32 v236, v236, v237
v_rcp_f32 v236, v236
v_pk_mul_f32 v[92:93], v[92:93], v[104:105]
v_pk_mul_f32 v[94:95], v[94:95], v[106:107]
v_pk_mul_f32 v[96:97], v[96:97], v[108:109]
v_pk_mul_f32 v[98:99], v[98:99], v[110:111]
v_pk_mul_f32 v[92:93], v[92:93], v[236:237] op_sel_hi:[1,0]
v_pk_mul_f32 v[94:95], v[94:95], v[236:237] op_sel_hi:[1,0]
v_pk_mul_f32 v[96:97], v[96:97], v[236:237] op_sel_hi:[1,0]
v_pk_mul_f32 v[98:99], v[98:99], v[236:237] op_sel_hi:[1,0]
v_cvt_pk_bf16_f32 v118, v96, v97
v_cvt_pk_bf16_f32 v119, v98, v99
v_cvt_pk_bf16_f32 v120, v92, v93
v_cvt_pk_bf16_f32 v121, v94, v95
v_and_b32 v116, v230, v120
v_and_b32 v117, v231, v121
v_xor_b32 v120, v116, v120
v_xor_b32 v121, v117, v121
s_waitcnt lgkmcnt(0)
v_mfma_f32_4x4x4_16b_bf16 v[124:127], v[70:71], v[118:119], 0
v_mfma_f32_4x4x4_16b_bf16 v[128:131], v[72:73], v[118:119], 0
v_mfma_f32_4x4x4_16b_bf16 v[132:135], v[74:75], v[118:119], 0
v_mfma_f32_4x4x4_16b_bf16 v[136:139], v[76:77], v[118:119], 0
v_mfma_f32_4x4x4_16b_bf16 v[140:143], v[78:79], v[118:119], 0
v_mfma_f32_4x4x4_16b_bf16 v[124:127], v[60:61], v[116:117], v[124:127]
v_mfma_f32_4x4x4_16b_bf16 v[128:131], v[62:63], v[116:117], v[128:131]
v_mfma_f32_4x4x4_16b_bf16 v[132:135], v[64:65], v[116:117], v[132:135]
v_mfma_f32_4x4x4_16b_bf16 v[136:139], v[66:67], v[116:117], v[136:139]
v_mfma_f32_4x4x4_16b_bf16 v[140:143], v[68:69], v[116:117], v[140:143]
v_mfma_f32_4x4x4_16b_bf16 v[124:127], v[80:81], v[120:121], v[124:127]
v_mfma_f32_4x4x4_16b_bf16 v[128:131], v[82:83], v[120:121], v[128:131]
v_mfma_f32_4x4x4_16b_bf16 v[132:135], v[84:85], v[120:121], v[132:135]
v_mfma_f32_4x4x4_16b_bf16 v[136:139], v[86:87], v[120:121], v[136:139]
v_mfma_f32_4x4x4_16b_bf16 v[140:143], v[88:89], v[120:121], v[140:143]
s_nop 0
v_cvt_pk_bf16_f32 v16, v124, v125
v_cvt_pk_bf16_f32 v17, v126, v127
v_cvt_pk_bf16_f32 v18, v128, v129
v_cvt_pk_bf16_f32 v19, v130, v131
v_cvt_pk_bf16_f32 v20, v132, v133
v_cvt_pk_bf16_f32 v21, v134, v135
v_cvt_pk_bf16_f32 v22, v136, v137
v_cvt_pk_bf16_f32 v23, v138, v139
v_cvt_pk_bf16_f32 v24, v140, v141
global_store_dwordx4 v241, v[16:19], s[48:49] sc1
global_store_dwordx4 v241, v[20:23], s[48:49] offset:256 sc1
global_store_dword v242, v24, s[48:49] sc1
global_load_lds_dwordx4 v7, s[34:35] offset:2048 sc1
global_load_lds_dwordx4 v7, s[34:35] offset:3072 sc1
s_add_u32 m0, m0, 0x4000
s_add_u32 s34, s34, 0x4000
s_addc_u32 s35, s35, 0
global_load_lds_dwordx4 v7, s[34:35] offset:0 sc1
global_load_lds_dwordx4 v7, s[34:35] offset:1024 sc1
global_load_lds_dwordx4 v7, s[34:35] offset:2048 sc1
s_lshl_b32 s40, s25, 8
s_add_u32 s40, s40, 0
s_add_u32 s70, s68, s40
s_addc_u32 s71, s69, 0
s_mov_b32 s28, 1
v_add_u32 v9, 137216, v7
v_and_b32 v10, 0x37f, v7
v_add_u32 v11, 137216, v10
s_mul_i32 s36, s27, 18432
s_add_u32 s37, s36, 4096
s_add_u32 s32, s48, s37
s_addc_u32 s33, s49, 0
s_lshl_b32 s37, s25, 13
s_lshl_b32 s42, s24, 6
s_add_u32 s37, s37, s42
s_add_u32 s37, s37, 4853760
v_lshlrev_b32 v8, 10, v5
v_lshl_add_u32 v8, v6, 2, v8
v_add_u32 v8, s37, v8
s_lshl_b32 s37, s26, 11
s_add_u32 s37, s37, s36
s_add_u32 s37, s37, 2359296
v_add_u32 v12, s37, v7
s_lshl_b32 s37, s26, 8
s_add_u32 s37, s37, s36
s_add_u32 s37, s37, 2375680
v_lshlrev_b32 v13, 4, v6
v_and_b32 v14, 1, v5
v_lshl_add_u32 v13, v14, 3, v13
v_add_u32 v13, s37, v13
s_lshl_b32 s37, s27, 10
s_lshl_b32 s42, s26, 7
s_add_u32 s37, s37, s42
s_add_u32 s37, s37, 4718592
v_lshl_add_u32 v14, v6, 3, s37
v_mov_b32 v2, 0xffff0000
v_lshlrev_b32 v16, 16, v244
v_and_b32 v17, v2, v244
v_lshlrev_b32 v18, 16, v245
v_and_b32 v19, v2, v245
v_lshlrev_b32 v20, 16, v246
v_and_b32 v21, v2, v246
v_lshlrev_b32 v22, 16, v247
v_and_b32 v23, v2, v247
v_lshlrev_b32 v24, 16, v248
v_and_b32 v25, v2, v248
v_lshlrev_b32 v26, 16, v249
v_and_b32 v27, v2, v249
v_lshlrev_b32 v28, 16, v250
v_and_b32 v29, v2, v250
v_lshlrev_b32 v30, 16, v251
v_and_b32 v31, v2, v251
v_lshlrev_b32 v32, 16, v252
v_and_b32 v33, v2, v252
v_lshlrev_b32 v34, 16, v253
v_and_b32 v35, v2, v253
v_mov_b32 v2, 0x3f803f80
v_mov_b32 v36, 0
v_mov_b32 v37, 0
s_waitcnt vmcnt(5)
s_waitcnt lgkmcnt(0)
s_barrier
s_cmp_lg_u32 s24, 0
s_cbranch_scc1 L_sy_o_25
s_atomic_add s28, s[70:71], 0 glc
s_setprio 3
L_sy_o_25:
global_load_lds_dwordx4 v7, s[34:35] offset:3072 sc1
s_add_u32 m0, m0, 0x4000
s_add_u32 s34, s34, 0x4000
s_addc_u32 s35, s35, 0
global_load_lds_dwordx4 v7, s[34:35] offset:0 sc1
global_load_lds_dwordx4 v7, s[34:35] offset:1024 sc1
global_load_lds_dwordx4 v7, s[34:35] offset:2048 sc1
global_load_lds_dwordx4 v7, s[34:35] offset:3072 sc1
global_load_dwordx4 a[40:43], v7, s[30:31] offset:1024 sc1
ds_read_b128 a[120:123], v9 offset:0
ds_read_b128 a[124:127], v9 offset:1024
ds_read_b128 a[128:131], v9 offset:2048
ds_read_b128 a[132:135], v9 offset:3072
ds_read_b128 a[136:139], v11 offset:4096
ds_read_b128 a[140:143], v9 offset:5120
ds_read_b128 a[144:147], v9 offset:6144
ds_read_b128 a[148:151], v9 offset:7168
ds_read_b128 a[152:155], v9 offset:8192
ds_read_b128 a[156:159], v11 offset:9216
s_cmp_lg_u32 s24, 0
s_cbranch_scc1 L_sy_d_26
s_mov_b32 s41, 0
s_setprio 0
s_waitcnt lgkmcnt(0)
s_add_u32 s28, s28, 1
L_sy_p_27:
s_cmp_eq_u32 s28, 8
s_cbranch_scc1 L_sy_d_26
s_mov_b32 s28, 0
s_atomic_add s28, s[70:71], 0 glc
s_add_u32 s41, s41, 1
s_cmp_gt_u32 s41, 2097152
s_waitcnt lgkmcnt(0)
s_cbranch_scc0 L_sy_p_27
L_sy_d_26:
s_waitcnt vmcnt(1)
s_barrier
global_load_dwordx4 v[48:51], v7, s[32:33] offset:-4096 sc1
global_load_dwordx4 v[52:55], v7, s[32:33] offset:-3072 sc1
global_load_dwordx4 v[56:59], v7, s[32:33] offset:-2048 sc1
global_load_dwordx4 v[60:63], v7, s[32:33] offset:-1024 sc1
global_load_dwordx4 v[64:67], v7, s[32:33] offset:0 sc1
global_load_dwordx4 v[68:71], v7, s[32:33] offset:1024 sc1
s_waitcnt vmcnt(5) lgkmcnt(9)
v_mfma_f32_16x16x32_bf16 v[16:19], a[120:123], v[48:51], v[16:19]
global_load_dwordx4 v[72:75], v7, s[32:33] offset:2048 sc1
ds_read_b128 a[160:163], v9 offset:10240
s_waitcnt vmcnt(5) lgkmcnt(5)
v_mfma_f32_16x16x32_bf16 v[16:19], a[140:143], v[52:55], v[16:19]
ds_read_b128 a[180:183], v9 offset:15360
s_waitcnt lgkmcnt(5)
v_mfma_f32_16x16x32_bf16 v[20:23], a[144:147], v[52:55], v[20:23]
global_load_dwordx4 v[76:79], v7, s[32:33] offset:3072 sc1
ds_read_b128 a[184:187], v9 offset:16384
v_mfma_f32_16x16x32_bf16 v[20:23], a[124:127], v[48:51], v[20:23]
ds_read_b128 a[164:167], v9 offset:11264
v_mfma_f32_16x16x32_bf16 v[24:27], a[128:131], v[48:51], v[24:27]
ds_read_b128 a[168:171], v9 offset:12288
s_waitcnt lgkmcnt(7)
v_mfma_f32_16x16x32_bf16 v[24:27], a[148:151], v[52:55], v[24:27]
s_add_u32 s32, s32, 0x2000
s_addc_u32 s33, s33, 0
global_load_dwordx4 v[80:83], v7, s[32:33] offset:-4096 sc1
ds_read_b128 a[188:191], v9 offset:17408
s_waitcnt lgkmcnt(7)
v_mfma_f32_16x16x32_bf16 v[28:31], a[152:155], v[52:55], v[28:31]
ds_read_b128 a[192:195], v9 offset:18432
v_mfma_f32_16x16x32_bf16 v[28:31], a[132:135], v[48:51], v[28:31]
global_load_dwordx4 v[84:87], v7, s[32:33] offset:-3072 sc1
ds_read_b128 a[172:175], v9 offset:13312
v_mfma_f32_16x16x32_bf16 v[32:35], a[136:139], v[48:51], v[32:35]
ds_read_b128 a[176:179], v11 offset:14336
s_waitcnt lgkmcnt(9)
v_mfma_f32_16x16x32_bf16 v[32:35], a[156:159], v[52:55], v[32:35]
ds_read_b128 a[196:199], v11 offset:19456
s_waitcnt vmcnt(7) lgkmcnt(9)
v_mfma_f32_16x16x32_bf16 v[16:19], a[160:163], v[56:59], v[16:19]
global_load_dwordx4 v[88:91], v7, s[32:33] offset:-2048 sc1
ds_read_b128 a[200:203], v9 offset:20480
s_waitcnt vmcnt(7) lgkmcnt(9)
v_mfma_f32_16x16x32_bf16 v[16:19], a[180:183], v[60:63], v[16:19]
ds_read_b128 a[220:223], v7 offset:1024
s_waitcnt lgkmcnt(9)
v_mfma_f32_16x16x32_bf16 v[20:23], a[184:187], v[60:63], v[20:23]
global_load_dwordx4 v[92:95], v7, s[32:33] offset:-1024 sc1
ds_read_b128 a[224:227], v7 offset:2048
s_waitcnt lgkmcnt(9)
v_mfma_f32_16x16x32_bf16 v[20:23], a[164:167], v[56:59], v[20:23]
ds_read_b128 a[204:207], v9 offset:21504
s_waitcnt lgkmcnt(9)
v_mfma_f32_16x16x32_bf16 v[24:27], a[168:171], v[56:59], v[24:27]
ds_read_b128 a[208:211], v9 offset:22528
s_waitcnt lgkmcnt(9)
v_mfma_f32_16x16x32_bf16 v[24:27], a[188:191], v[60:63], v[24:27]
global_load_dwordx4 v[96:99], v7, s[32:33] offset:0 sc1
ds_read_b128 a[228:231], v7 offset:3072
s_waitcnt lgkmcnt(9)
v_mfma_f32_16x16x32_bf16 v[28:31], a[192:195], v[60:63], v[28:31]
ds_read_b128 a[232:235], v7 offset:4096
s_waitcnt lgkmcnt(9)
v_mfma_f32_16x16x32_bf16 v[28:31], a[172:175], v[56:59], v[28:31]
global_load_dwordx4 v[100:103], v7, s[32:33] offset:1024 sc1
ds_read_b128 a[212:215], v9 offset:23552
s_waitcnt lgkmcnt(9)
v_mfma_f32_16x16x32_bf16 v[32:35], a[176:179], v[56:59], v[32:35]
ds_read_b128 a[216:219], v10 offset:0
s_waitcnt lgkmcnt(9)
v_mfma_f32_16x16x32_bf16 v[32:35], a[196:199], v[60:63], v[32:35]
ds_read_b128 a[236:239], v10 offset:5120
s_waitcnt vmcnt(9) lgkmcnt(9)
v_mfma_f32_16x16x32_bf16 v[16:19], a[200:203], v[64:67], v[16:19]
global_load_dwordx4 v[104:107], v7, s[32:33] offset:2048 sc1
ds_read_b128 v[120:123], v7 offset:6144
s_waitcnt vmcnt(9) lgkmcnt(9)
v_mfma_f32_16x16x32_bf16 v[16:19], a[220:223], v[68:71], v[16:19]
ds_read_b128 v[140:143], v7 offset:11264
s_waitcnt lgkmcnt(9)
v_mfma_f32_16x16x32_bf16 v[20:23], a[224:227], v[68:71], v[20:23]
global_load_dwordx4 v[108:111], v7, s[32:33] offset:3072 sc1
ds_read_b128 v[144:147], v7 offset:12288
s_waitcnt lgkmcnt(9)
v_mfma_f32_16x16x32_bf16 v[20:23], a[204:207], v[64:67], v[20:23]
ds_read_b128 v[124:127], v7 offset:7168
s_waitcnt lgkmcnt(9)
v_mfma_f32_16x16x32_bf16 v[24:27], a[208:211], v[64:67], v[24:27]
ds_read_b128 v[128:131], v7 offset:8192
s_waitcnt lgkmcnt(9)
v_mfma_f32_16x16x32_bf16 v[24:27], a[228:231], v[68:71], v[24:27]
global_load_dword v112, v8, s[48:49] offset:-4096 sc1
ds_read_b128 v[148:151], v7 offset:13312
s_waitcnt lgkmcnt(9)
v_mfma_f32_16x16x32_bf16 v[28:31], a[232:235], v[68:71], v[28:31]
ds_read_b128 v[152:155], v7 offset:14336
s_waitcnt lgkmcnt(9)
v_mfma_f32_16x16x32_bf16 v[28:31], a[212:215], v[64:67], v[28:31]
global_load_dword v113, v8, s[48:49] offset:-3840 sc1
ds_read_b128 v[132:135], v7 offset:9216
s_waitcnt lgkmcnt(9)
v_mfma_f32_16x16x32_bf16 v[32:35], a[216:219], v[64:67], v[32:35]
ds_read_b128 v[136:139], v10 offset:10240
s_waitcnt lgkmcnt(9)
v_mfma_f32_16x16x32_bf16 v[32:35], a[236:239], v[68:71], v[32:35]
ds_read_b128 v[156:159], v10 offset:15360
s_waitcnt vmcnt(11) lgkmcnt(9)
v_mfma_f32_16x16x32_bf16 v[16:19], v[120:123], v[72:75], v[16:19]
global_load_dword v114, v8, s[48:49] offset:-3584 sc1
ds_read_b128 v[160:163], v7 offset:16384
s_waitcnt vmcnt(11) lgkmcnt(9)
v_mfma_f32_16x16x32_bf16 v[16:19], v[140:143], v[76:79], v[16:19]
ds_read_b128 v[180:183], v7 offset:21504
s_waitcnt lgkmcnt(9)
v_mfma_f32_16x16x32_bf16 v[20:23], v[144:147], v[76:79], v[20:23]
global_load_dword v115, v8, s[48:49] offset:-3328 sc1
ds_read_b128 v[184:187], v7 offset:22528
s_waitcnt lgkmcnt(9)
v_mfma_f32_16x16x32_bf16 v[20:23], v[124:127], v[72:75], v[20:23]
ds_read_b128 v[164:167], v7 offset:17408
s_waitcnt lgkmcnt(9)
v_mfma_f32_16x16x32_bf16 v[24:27], v[128:131], v[72:75], v[24:27]
ds_read_b128 v[168:171], v7 offset:18432
s_waitcnt lgkmcnt(9)
v_mfma_f32_16x16x32_bf16 v[24:27], v[148:151], v[76:79], v[24:27]
global_load_dword v116, v8, s[48:49] offset:0 sc1
ds_read_b128 v[188:191], v7 offset:23552
s_waitcnt lgkmcnt(9)
v_mfma_f32_16x16x32_bf16 v[28:31], v[152:155], v[76:79], v[28:31]
ds_read_b128 v[192:195], v7 offset:24576
s_waitcnt lgkmcnt(9)
v_mfma_f32_16x16x32_bf16 v[28:31], v[132:135], v[72:75], v[28:31]
global_load_dword v117, v8, s[48:49] offset:256 sc1
ds_read_b128 v[172:175], v7 offset:19456
s_waitcnt lgkmcnt(9)
v_mfma_f32_16x16x32_bf16 v[32:35], v[136:139], v[72:75], v[32:35]
ds_read_b128 v[176:179], v10 offset:20480
s_waitcnt lgkmcnt(9)
v_mfma_f32_16x16x32_bf16 v[32:35], v[156:159], v[76:79], v[32:35]
ds_read_b128 v[196:199], v10 offset:25600
s_waitcnt vmcnt(13) lgkmcnt(9)
v_mfma_f32_16x16x32_bf16 v[16:19], v[160:163], v[80:83], v[16:19]
global_load_dword v118, v8, s[48:49] offset:512 sc1
ds_read_b128 v[200:203], v7 offset:26624
s_waitcnt vmcnt(13) lgkmcnt(9)
v_mfma_f32_16x16x32_bf16 v[16:19], v[180:183], v[84:87], v[16:19]
ds_read_b128 v[220:223], v7 offset:31744
s_waitcnt lgkmcnt(9)
v_mfma_f32_16x16x32_bf16 v[20:23], v[184:187], v[84:87], v[20:23]
global_load_dword v119, v8, s[48:49] offset:768 sc1
ds_read_b128 v[224:227], v7 offset:32768
s_waitcnt lgkmcnt(9)
v_mfma_f32_16x16x32_bf16 v[20:23], v[164:167], v[80:83], v[20:23]
ds_read_b128 v[204:207], v7 offset:27648
s_waitcnt lgkmcnt(9)
v_mfma_f32_16x16x32_bf16 v[24:27], v[168:171], v[80:83], v[24:27]
ds_read_b128 v[208:211], v7 offset:28672
s_waitcnt lgkmcnt(9)
v_mfma_f32_16x16x32_bf16 v[24:27], v[188:191], v[84:87], v[24:27]
global_load_dwordx4 a[44:47], v7, s[30:31] offset:2048 sc1
ds_read_b128 v[228:231], v7 offset:33792
s_waitcnt lgkmcnt(9)
v_mfma_f32_16x16x32_bf16 v[28:31], v[192:195], v[84:87], v[28:31]
ds_read_b128 v[232:235], v7 offset:34816
s_waitcnt lgkmcnt(9)
v_mfma_f32_16x16x32_bf16 v[28:31], v[172:175], v[80:83], v[28:31]
ds_read_b128 v[212:215], v7 offset:29696
s_waitcnt lgkmcnt(9)
v_mfma_f32_16x16x32_bf16 v[32:35], v[176:179], v[80:83], v[32:35]
ds_read_b128 v[216:219], v10 offset:30720
s_waitcnt lgkmcnt(9)
v_mfma_f32_16x16x32_bf16 v[32:35], v[196:199], v[84:87], v[32:35]
ds_read_b128 v[236:239], v10 offset:35840
s_waitcnt vmcnt(14) lgkmcnt(9)
v_mfma_f32_16x16x32_bf16 v[16:19], v[200:203], v[88:91], v[16:19]
s_add_u32 s30, s30, 0x1800
s_addc_u32 s31, s31, 0
global_load_dwordx4 a[48:51], v7, s[30:31] offset:-3072 sc1
ds_read_b128 a[120:123], v7 offset:36864
s_waitcnt vmcnt(14) lgkmcnt(9)
v_mfma_f32_16x16x32_bf16 v[16:19], v[220:223], v[92:95], v[16:19]
ds_read_b128 a[140:143], v7 offset:41984
s_waitcnt lgkmcnt(9)
v_mfma_f32_16x16x32_bf16 v[20:23], v[224:227], v[92:95], v[20:23]
ds_read_b128 a[144:147], v7 offset:43008
s_waitcnt lgkmcnt(9)
v_mfma_f32_16x16x32_bf16 v[20:23], v[204:207], v[88:91], v[20:23]
ds_read_b128 a[124:127], v7 offset:37888
s_waitcnt lgkmcnt(9)
v_mfma_f32_16x16x32_bf16 v[24:27], v[208:211], v[88:91], v[24:27]
ds_read_b128 a[128:131], v7 offset:38912
s_waitcnt lgkmcnt(9)
v_mfma_f32_16x16x32_bf16 v[24:27], v[228:231], v[92:95], v[24:27]
global_load_dwordx4 a[52:55], v7, s[30:31] offset:-2048 sc1
ds_read_b128 a[148:151], v7 offset:44032
s_waitcnt lgkmcnt(9)
v_mfma_f32_16x16x32_bf16 v[28:31], v[232:235], v[92:95], v[28:31]
ds_read_b128 a[152:155], v7 offset:45056
s_waitcnt lgkmcnt(9)
v_mfma_f32_16x16x32_bf16 v[28:31], v[212:215], v[88:91], v[28:31]
ds_read_b128 a[132:135], v7 offset:39936
s_waitcnt lgkmcnt(9)
v_mfma_f32_16x16x32_bf16 v[32:35], v[216:219], v[88:91], v[32:35]
ds_read_b128 a[136:139], v10 offset:40960
s_waitcnt lgkmcnt(9)
v_mfma_f32_16x16x32_bf16 v[32:35], v[236:239], v[92:95], v[32:35]
ds_read_b128 a[156:159], v10 offset:46080
s_waitcnt vmcnt(14) lgkmcnt(9)
v_mfma_f32_16x16x32_bf16 v[16:19], a[120:123], v[96:99], v[16:19]
global_load_dwordx4 a[56:59], v7, s[30:31] offset:-1024 sc1
ds_read_b128 a[160:163], v7 offset:47104
s_waitcnt vmcnt(14) lgkmcnt(9)
v_mfma_f32_16x16x32_bf16 v[16:19], a[140:143], v[100:103], v[16:19]
ds_read_b128 a[180:183], v7 offset:52224
s_waitcnt lgkmcnt(9)
v_mfma_f32_16x16x32_bf16 v[20:23], a[144:147], v[100:103], v[20:23]
ds_read_b128 a[184:187], v7 offset:53248
s_waitcnt lgkmcnt(9)
v_mfma_f32_16x16x32_bf16 v[20:23], a[124:127], v[96:99], v[20:23]
ds_read_b128 a[164:167], v7 offset:48128
s_waitcnt lgkmcnt(9)
v_mfma_f32_16x16x32_bf16 v[24:27], a[128:131], v[96:99], v[24:27]
ds_read_b128 a[168:171], v7 offset:49152
s_waitcnt lgkmcnt(9)
v_mfma_f32_16x16x32_bf16 v[24:27], a[148:151], v[100:103], v[24:27]
global_load_dwordx4 a[60:63], v7, s[30:31] offset:0 sc1
ds_read_b128 a[188:191], v7 offset:54272
s_waitcnt lgkmcnt(9)
v_mfma_f32_16x16x32_bf16 v[28:31], a[152:155], v[100:103], v[28:31]
ds_read_b128 a[192:195], v7 offset:55296
s_waitcnt lgkmcnt(9)
v_mfma_f32_16x16x32_bf16 v[28:31], a[132:135], v[96:99], v[28:31]
ds_read_b128 a[172:175], v7 offset:50176
s_waitcnt lgkmcnt(9)
v_mfma_f32_16x16x32_bf16 v[32:35], a[136:139], v[96:99], v[32:35]
ds_read_b128 a[176:179], v10 offset:51200
s_waitcnt lgkmcnt(9)
v_mfma_f32_16x16x32_bf16 v[32:35], a[156:159], v[100:103], v[32:35]
ds_read_b128 a[196:199], v10 offset:56320
s_waitcnt vmcnt(14) lgkmcnt(9)
v_mfma_f32_16x16x32_bf16 v[16:19], a[160:163], v[104:107], v[16:19]
global_load_dwordx4 a[64:67], v7, s[30:31] offset:1024 sc1
ds_read_b128 a[200:203], v7 offset:57344
s_waitcnt vmcnt(14) lgkmcnt(9)
v_mfma_f32_16x16x32_bf16 v[16:19], a[180:183], v[108:111], v[16:19]
ds_read_b128 a[220:223], v7 offset:62464
s_waitcnt lgkmcnt(9)
v_mfma_f32_16x16x32_bf16 v[20:23], a[184:187], v[108:111], v[20:23]
ds_read_b128 a[224:227], v7 offset:63488
s_waitcnt lgkmcnt(9)
v_mfma_f32_16x16x32_bf16 v[20:23], a[164:167], v[104:107], v[20:23]
ds_read_b128 a[204:207], v7 offset:58368
s_waitcnt lgkmcnt(9)
v_mfma_f32_16x16x32_bf16 v[24:27], a[168:171], v[104:107], v[24:27]
ds_read_b128 a[208:211], v7 offset:59392
s_waitcnt lgkmcnt(9)
v_mfma_f32_16x16x32_bf16 v[24:27], a[188:191], v[108:111], v[24:27]
ds_read_b128 a[228:231], v7 offset:64512
s_waitcnt lgkmcnt(9)
v_mfma_f32_16x16x32_bf16 v[28:31], a[192:195], v[108:111], v[28:31]
ds_read_b128 a[232:235], v9 offset:24576
s_waitcnt lgkmcnt(9)
v_mfma_f32_16x16x32_bf16 v[28:31], a[172:175], v[104:107], v[28:31]
ds_read_b128 a[212:215], v7 offset:60416
s_waitcnt lgkmcnt(9)
v_mfma_f32_16x16x32_bf16 v[32:35], a[176:179], v[104:107], v[32:35]
ds_read_b128 a[216:219], v10 offset:61440
s_waitcnt lgkmcnt(9)
v_mfma_f32_16x16x32_bf16 v[32:35], a[196:199], v[108:111], v[32:35]
ds_read_b128 a[236:239], v11 offset:25600
s_waitcnt vmcnt(10) lgkmcnt(9)
v_mfma_f32_16x16x32_bf16 v[16:19], a[200:203], v[112:115], v[16:19]
s_waitcnt vmcnt(6) lgkmcnt(8)
v_mfma_f32_16x16x32_bf16 v[16:19], a[220:223], v[116:119], v[16:19]
s_waitcnt lgkmcnt(7)
v_mfma_f32_16x16x32_bf16 v[20:23], a[224:227], v[116:119], v[20:23]
s_waitcnt lgkmcnt(6)
v_mfma_f32_16x16x32_bf16 v[20:23], a[204:207], v[112:115], v[20:23]
s_waitcnt lgkmcnt(5)
v_mfma_f32_16x16x32_bf16 v[24:27], a[208:211], v[112:115], v[24:27]
s_waitcnt lgkmcnt(4)
v_mfma_f32_16x16x32_bf16 v[24:27], a[228:231], v[116:119], v[24:27]
s_waitcnt lgkmcnt(3)
v_mfma_f32_16x16x32_bf16 v[28:31], a[232:235], v[116:119], v[28:31]
s_waitcnt lgkmcnt(2)
v_mfma_f32_16x16x32_bf16 v[28:31], a[212:215], v[112:115], v[28:31]
s_waitcnt lgkmcnt(1)
v_mfma_f32_16x16x32_bf16 v[32:35], a[216:219], v[112:115], v[32:35]
s_waitcnt lgkmcnt(0)
v_mfma_f32_16x16x32_bf16 v[32:35], a[236:239], v[116:119], v[32:35]
v_cvt_pk_bf16_f32 v244, v16, v17
v_cvt_pk_bf16_f32 v245, v18, v19
v_cvt_pk_bf16_f32 v246, v20, v21
v_cvt_pk_bf16_f32 v247, v22, v23
global_store_dwordx4 v12, v[244:247], s[48:49] sc1
v_cvt_pk_bf16_f32 v248, v24, v25
v_cvt_pk_bf16_f32 v249, v26, v27
v_cvt_pk_bf16_f32 v250, v28, v29
v_cvt_pk_bf16_f32 v251, v30, v31
global_store_dwordx4 v12, v[248:251], s[48:49] offset:1024 sc1
v_cvt_pk_bf16_f32 v252, v32, v33
v_cvt_pk_bf16_f32 v253, v34, v35
s_mov_b32 exec_hi, 0
global_store_dwordx2 v13, v[252:253], s[48:49] sc1
v_dot2c_f32_bf16 v36, v252, v2
v_dot2c_f32_bf16 v37, v252, v252
v_dot2c_f32_bf16 v36, v253, v2
v_dot2c_f32_bf16 v37, v253, v253
s_mov_b32 exec_hi, -1
v_dot2c_f32_bf16 v36, v244, v2
v_dot2c_f32_bf16 v37, v244, v244
v_dot2c_f32_bf16 v36, v245, v2
v_dot2c_f32_bf16 v37, v245, v245
v_dot2c_f32_bf16 v36, v246, v2
v_dot2c_f32_bf16 v37, v246, v246
v_dot2c_f32_bf16 v36, v247, v2
v_dot2c_f32_bf16 v37, v247, v247
v_dot2c_f32_bf16 v36, v248, v2
v_dot2c_f32_bf16 v37, v248, v248
v_dot2c_f32_bf16 v36, v249, v2
v_dot2c_f32_bf16 v37, v249, v249
v_dot2c_f32_bf16 v36, v250, v2
v_dot2c_f32_bf16 v37, v250, v250
v_dot2c_f32_bf16 v36, v251, v2
v_dot2c_f32_bf16 v37, v251, v251
s_nop 2
v_mov_b32 v38, v36
v_mov_b32 v39, v37
s_nop 0
v_permlane16_swap_b32 v36, v38
v_permlane16_swap_b32 v37, v39
v_add_f32 v36, v36, v38
v_add_f32 v37, v37, v39
v_mov_b32 v38, v36
v_mov_b32 v39, v37
s_nop 0
v_permlane32_swap_b32 v36, v38
v_permlane32_swap_b32 v37, v39
v_add_f32 v36, v36, v38
v_add_f32 v37, v37, v39
s_mov_b64 exec, 0xffff
global_store_dwordx2 v14, v[36:37], s[48:49] sc1
s_mov_b64 exec, -1
global_load_dwordx4 a[68:71], v7, s[30:31] offset:2048 sc1
s_cmp_eq_u32 s8, 1
s_cselect_b32 s6, 2, 1
s_cmp_eq_u32 s8, 0
s_cselect_b32 s6, 0, s6
s_mul_i32 s6, s6, 18432
s_add_u32 s30, s10, s6
s_addc_u32 s31, s11, 0
global_load_dwordx4 a[72:75], v7, s[30:31] offset:-3072 sc1
global_load_dwordx4 a[76:79], v7, s[30:31] offset:-2048 sc1
global_load_dwordx4 a[80:83], v7, s[30:31] offset:-1024 sc1
global_load_dwordx4 a[84:87], v7, s[30:31] offset:0 sc1
s_lshl_b32 s40, s25, 8
s_add_u32 s40, s40, 8192
s_add_u32 s70, s68, s40
s_addc_u32 s71, s69, 0
s_mov_b32 s28, 1
v_add_u32 v8, 36864, v7
v_add_u32 v9, 73728, v7
v_add_u32 v10, 106496, v7
s_lshr_b32 s46, s24, 1
s_lshl_b32 s46, s46, 12
s_and_b32 s47, s24, 1
s_lshl_b32 s47, s47, 3
s_add_u32 s46, s46, s47
v_add_u32 v11, s46, v9
v_add_u32 v12, s46, v10
s_mul_i32 s46, s26, 2304
s_lshl_b32 s47, s24, 6
s_add_u32 s46, s46, s47
s_add_u32 s46, s46, 13729792
v_lshl_add_u32 v13, v5, 4, s46
s_lshl_b32 s46, s27, 10
s_add_u32 s46, s46, 4718592
s_add_u32 s34, s48, s46
s_addc_u32 s35, s49, 0
s_lshl_b32 s37, s24, 10
s_add_u32 s37, s37, 147456
v_lshlrev_b32 v14, 10, v5
v_lshl_add_u32 v14, v6, 3, v14
v_add_u32 v14, 147456, v14
s_mov_b32 s56, 0x3f3504f3
s_mul_i32 s46, s25, 589824
s_lshl_b32 s47, s24, 11
s_add_u32 s46, s46, s47
s_add_u32 s46, s46, 5111808
s_add_u32 s58, s48, s46
s_addc_u32 s59, s49, 0
s_lshl_b32 s46, s25, 12
s_lshl_b32 s47, s24, 7
s_add_u32 s46, s46, s47
s_add_u32 s46, s46, 32768
s_add_u32 s72, s68, s46
s_addc_u32 s73, s69, 0
s_mul_i32 s46, s27, 18432
s_add_u32 s46, s46, 2359296
s_add_u32 s32, s48, s46
s_addc_u32 s33, s49, 0
s_mul_i32 s36, s24, 18432
s_mov_b32 m0, s37
s_mov_b32 s54, 1
v_lshrrev_b32 v102, 2, v6
v_lshl_add_u32 v102, v102, 2, v5
v_and_b32 v103, 3, v6
v_lshl_add_u32 v102, v102, 2, v103
v_lshlrev_b32 v102, 4, v102
s_cmp_eq_u32 s8, 0
s_cselect_b32 s7, 1, 0
s_cmp_eq_u32 s8, -1
s_cselect_b32 s7, -1, s7
s_sub_u32 s14, s7, 0
s_lshl_b32 s14, s14, 13
s_lshl_b32 s7, s7, 8
s_add_u32 s12, s22, s7
s_addc_u32 s13, s23, 0
global_load_dwordx4 v[64:67], v13, s[12:13] sc1
s_cmp_eq_u32 s8, 1
s_cselect_b32 s7, 2, 1
s_cmp_eq_u32 s8, 0
s_cselect_b32 s7, 0, s7
s_sub_u32 s15, s7, 1
s_lshl_b32 s15, s15, 13
s_lshl_b32 s7, s7, 8
s_add_u32 s12, s22, s7
s_addc_u32 s13, s23, 0
global_load_dwordx4 v[68:71], v13, s[12:13] sc1
s_waitcnt vmcnt(7)
s_waitcnt lgkmcnt(0)
s_barrier
s_cmp_lg_u32 s24, 0
s_cbranch_scc1 L_sy_o_28
s_atomic_add s28, s[70:71], 0 glc
s_setprio 3
L_sy_o_28:
global_load_dwordx4 a[88:91], v7, s[30:31] offset:1024 sc1
global_load_dwordx4 a[92:95], v7, s[30:31] offset:2048 sc1
s_add_u32 s30, s30, 0x1800
s_addc_u32 s31, s31, 0
global_load_dwordx4 a[96:99], v7, s[30:31] offset:-3072 sc1
global_load_dwordx4 a[100:103], v7, s[30:31] offset:-2048 sc1
global_load_dwordx4 a[104:107], v7, s[30:31] offset:-1024 sc1
global_load_dwordx4 a[108:111], v7, s[30:31] offset:0 sc1
global_load_dwordx4 a[112:115], v7, s[30:31] offset:1024 sc1
global_load_dwordx4 a[116:119], v7, s[30:31] offset:2048 sc1
s_add_u32 s30, s30, 0x1800
s_addc_u32 s31, s31, 0
s_cmp_lg_u32 s24, 0
s_cbranch_scc1 L_sy_d_29
s_mov_b32 s41, 0
s_setprio 0
s_waitcnt lgkmcnt(0)
s_add_u32 s28, s28, 1
L_sy_p_30:
s_cmp_eq_u32 s28, 8
s_cbranch_scc1 L_sy_d_29
s_mov_b32 s28, 0
s_atomic_add s28, s[70:71], 0 glc
s_add_u32 s41, s41, 1
s_cmp_gt_u32 s41, 2097152
s_waitcnt lgkmcnt(0)
s_cbranch_scc0 L_sy_p_30
L_sy_d_29:
s_barrier
global_load_lds_dwordx4 v7, s[34:35] sc1
s_mov_b32 m0, s36
s_nop 0
global_load_lds_dwordx4 v7, s[32:33] offset:0 sc1
global_load_lds_dwordx4 v7, s[32:33] offset:1024 sc1
global_load_lds_dwordx4 v7, s[32:33] offset:2048 sc1
global_load_lds_dwordx4 v7, s[32:33] offset:3072 sc1
s_add_u32 m0, m0, 0x1000
s_add_u32 s32, s32, 0x1000
s_addc_u32 s33, s33, 0
global_load_lds_dwordx4 v7, s[32:33] offset:0 sc1
global_load_lds_dwordx4 v7, s[32:33] offset:1024 sc1
global_load_lds_dwordx4 v7, s[32:33] offset:2048 sc1
global_load_lds_dwordx4 v7, s[32:33] offset:3072 sc1
s_add_u32 m0, m0, 0x1000
s_add_u32 s32, s32, 0x1000
s_addc_u32 s33, s33, 0
global_load_lds_dwordx4 v7, s[32:33] offset:0 sc1
global_load_lds_dwordx4 v7, s[32:33] offset:1024 sc1
global_load_lds_dwordx4 v7, s[32:33] offset:2048 sc1
global_load_lds_dwordx4 v7, s[32:33] offset:3072 sc1
s_add_u32 m0, m0, 0x1000
s_add_u32 s32, s32, 0x1000
s_addc_u32 s33, s33, 0
global_load_lds_dwordx4 v7, s[32:33] offset:0 sc1
global_load_lds_dwordx4 v7, s[32:33] offset:1024 sc1
global_load_lds_dwordx4 v7, s[32:33] offset:2048 sc1
s_waitcnt vmcnt(9)
s_barrier
ds_read_b128 a[120:123], v7 offset:0
ds_read_b128 a[136:139], v7 offset:1024
ds_read_b128 a[152:155], v7 offset:2048
ds_read_b128 a[156:159], v7 offset:20480
ds_read_b128 a[140:143], v7 offset:19456
ds_read_b128 a[124:127], v7 offset:18432
ds_read_b128 a[128:131], v8 offset:0
ds_read_b128 a[144:147], v8 offset:1024
ds_read_b128 a[160:163], v8 offset:2048
ds_read_b128 a[164:167], v8 offset:20480
ds_read_b128 a[148:151], v8 offset:19456
ds_read_b128 a[132:135], v8 offset:18432
s_waitcnt lgkmcnt(11)
v_mfma_f32_16x16x32_bf16 v[16:19], a[0:3], a[120:123], 0
s_waitcnt lgkmcnt(10)
global_load_lds_dwordx4 v7, s[32:33] offset:3072 sc1
ds_read_b128 a[168:171], v7 offset:3072
v_mfma_f32_16x16x32_bf16 v[16:19], a[4:7], a[136:139], v[16:19]
s_waitcnt lgkmcnt(10)
ds_read_b128 a[184:187], v7 offset:4096
v_mfma_f32_16x16x32_bf16 v[16:19], a[8:11], a[152:155], v[16:19]
s_waitcnt lgkmcnt(10)
s_add_u32 m0, m0, 0x1000
s_add_u32 s32, s32, 0x1000
s_addc_u32 s33, s33, 0
global_load_lds_dwordx4 v7, s[32:33] offset:0 sc1
ds_read_b128 a[200:203], v7 offset:5120
v_mfma_f32_16x16x32_bf16 v[20:23], a[8:11], a[156:159], 0
s_waitcnt lgkmcnt(10)
ds_read_b128 a[204:207], v7 offset:23552
v_mfma_f32_16x16x32_bf16 v[20:23], a[4:7], a[140:143], v[20:23]
s_waitcnt lgkmcnt(10)
global_load_lds_dwordx4 v7, s[32:33] offset:1024 sc1
ds_read_b128 a[188:191], v7 offset:22528
v_mfma_f32_16x16x32_bf16 v[20:23], a[0:3], a[124:127], v[20:23]
s_waitcnt lgkmcnt(10)
ds_read_b128 a[172:175], v7 offset:21504
v_mfma_f32_16x16x32_bf16 v[24:27], a[0:3], a[128:131], 0
s_waitcnt lgkmcnt(10)
ds_read_b128 a[176:179], v8 offset:3072
v_mfma_f32_16x16x32_bf16 v[24:27], a[4:7], a[144:147], v[24:27]
s_waitcnt lgkmcnt(10)
ds_read_b128 a[192:195], v8 offset:4096
v_mfma_f32_16x16x32_bf16 v[24:27], a[8:11], a[160:163], v[24:27]
s_waitcnt lgkmcnt(10)
ds_read_b128 a[208:211], v8 offset:5120
v_mfma_f32_16x16x32_bf16 v[28:31], a[8:11], a[164:167], 0
s_waitcnt lgkmcnt(10)
ds_read_b128 a[212:215], v8 offset:23552
v_mfma_f32_16x16x32_bf16 v[28:31], a[4:7], a[148:151], v[28:31]
s_waitcnt lgkmcnt(10)
ds_read_b128 a[196:199], v8 offset:22528
v_mfma_f32_16x16x32_bf16 v[28:31], a[0:3], a[132:135], v[28:31]
s_waitcnt lgkmcnt(10)
global_load_dwordx4 a[0:3], v7, s[30:31] offset:-3072 sc1
ds_read_b128 a[180:183], v8 offset:21504
v_mfma_f32_16x16x32_bf16 v[16:19], a[12:15], a[168:171], v[16:19]
s_waitcnt lgkmcnt(10)
s_waitcnt vmcnt(7)
s_barrier
ds_read_b128 a[216:219], v7 offset:6144
v_mfma_f32_16x16x32_bf16 v[16:19], a[16:19], a[184:187], v[16:19]
s_waitcnt lgkmcnt(10)
ds_read_b128 a[232:235], v7 offset:7168
v_mfma_f32_16x16x32_bf16 v[16:19], a[20:23], a[200:203], v[16:19]
s_waitcnt lgkmcnt(10)
global_load_dwordx4 a[4:7], v7, s[30:31] offset:-2048 sc1
ds_read_b128 a[248:251], v7 offset:8192
v_mfma_f32_16x16x32_bf16 v[20:23], a[20:23], a[204:207], v[20:23]
s_waitcnt lgkmcnt(10)
ds_read_b128 a[252:255], v7 offset:26624
v_mfma_f32_16x16x32_bf16 v[20:23], a[16:19], a[188:191], v[20:23]
s_waitcnt lgkmcnt(10)
ds_read_b128 a[236:239], v7 offset:25600
v_mfma_f32_16x16x32_bf16 v[20:23], a[12:15], a[172:175], v[20:23]
s_waitcnt lgkmcnt(10)
global_load_dwordx4 a[8:11], v7, s[30:31] offset:-1024 sc1
ds_read_b128 a[220:223], v7 offset:24576
v_mfma_f32_16x16x32_bf16 v[24:27], a[12:15], a[176:179], v[24:27]
s_waitcnt lgkmcnt(10)
ds_read_b128 a[224:227], v8 offset:6144
v_mfma_f32_16x16x32_bf16 v[24:27], a[16:19], a[192:195], v[24:27]
s_waitcnt lgkmcnt(10)
ds_read_b128 a[240:243], v8 offset:7168
v_mfma_f32_16x16x32_bf16 v[24:27], a[20:23], a[208:211], v[24:27]
s_waitcnt lgkmcnt(10)
ds_read_b128 v[104:107], v8 offset:8192
v_mfma_f32_16x16x32_bf16 v[28:31], a[20:23], a[212:215], v[28:31]
s_waitcnt lgkmcnt(10)
ds_read_b128 v[108:111], v8 offset:26624
v_mfma_f32_16x16x32_bf16 v[28:31], a[16:19], a[196:199], v[28:31]
s_waitcnt lgkmcnt(10)
ds_read_b128 a[244:247], v8 offset:25600
v_mfma_f32_16x16x32_bf16 v[28:31], a[12:15], a[180:183], v[28:31]
s_waitcnt lgkmcnt(10)
global_load_dwordx4 a[12:15], v7, s[30:31] offset:0 sc1
ds_read_b128 a[228:231], v8 offset:24576
v_mfma_f32_16x16x32_bf16 v[16:19], a[24:27], a[216:219], v[16:19]
s_waitcnt lgkmcnt(10)
ds_read_b128 v[112:115], v7 offset:9216
v_mfma_f32_16x16x32_bf16 v[16:19], a[28:31], a[232:235], v[16:19]
s_waitcnt lgkmcnt(10)
ds_read_b128 v[128:131], v7 offset:10240
v_mfma_f32_16x16x32_bf16 v[16:19], a[32:35], a[248:251], v[16:19]
s_waitcnt lgkmcnt(10)
global_load_dwordx4 a[16:19], v7, s[30:31] offset:1024 sc1
ds_read_b128 v[144:147], v7 offset:11264
v_mfma_f32_16x16x32_bf16 v[20:23], a[32:35], a[252:255], v[20:23]
s_waitcnt lgkmcnt(10)
ds_read_b128 v[148:151], v7 offset:29696
v_mfma_f32_16x16x32_bf16 v[20:23], a[28:31], a[236:239], v[20:23]
s_waitcnt lgkmcnt(10)
ds_read_b128 v[132:135], v7 offset:28672
v_mfma_f32_16x16x32_bf16 v[20:23], a[24:27], a[220:223], v[20:23]
s_waitcnt lgkmcnt(10)
global_load_dwordx4 a[20:23], v7, s[30:31] offset:2048 sc1
ds_read_b128 v[116:119], v7 offset:27648
v_mfma_f32_16x16x32_bf16 v[24:27], a[24:27], a[224:227], v[24:27]
s_waitcnt lgkmcnt(10)
ds_read_b128 v[120:123], v8 offset:9216
ds_read2_b64 v[48:51], v14 offset0:0 offset1:16
v_mfma_f32_16x16x32_bf16 v[24:27], a[28:31], a[240:243], v[24:27]
s_waitcnt lgkmcnt(11)
s_cmp_eq_u32 s8, 2
ds_read_b128 v[136:139], v8 offset:10240
ds_read2_b64 v[52:55], v14 offset0:32 offset1:48
v_mfma_f32_16x16x32_bf16 v[24:27], a[32:35], v[104:107], v[24:27]
s_waitcnt lgkmcnt(12)
ds_read_b128 v[152:155], v8 offset:11264
ds_read2_b64 v[56:59], v14 offset0:64 offset1:80
v_mfma_f32_16x16x32_bf16 v[28:31], a[32:35], v[108:111], v[28:31]
s_waitcnt lgkmcnt(13)
s_cselect_b32 s6, 3, 2
ds_read_b128 v[156:159], v8 offset:29696
ds_read2_b64 v[60:63], v14 offset0:96 offset1:112
v_mfma_f32_16x16x32_bf16 v[28:31], a[28:31], a[244:247], v[28:31]
s_waitcnt lgkmcnt(14)
ds_read_b128 v[140:143], v8 offset:28672
v_mfma_f32_16x16x32_bf16 v[28:31], a[24:27], a[228:231], v[28:31]
s_waitcnt lgkmcnt(14)
s_cmp_eq_u32 s8, 1
ds_read_b128 v[124:127], v8 offset:27648
v_mfma_f32_16x16x32_bf16 v[16:19], a[36:39], v[112:115], v[16:19]
s_waitcnt lgkmcnt(14)
s_waitcnt vmcnt(6)
s_barrier
ds_read_b128 v[160:163], v7 offset:12288
v_mfma_f32_16x16x32_bf16 v[16:19], a[40:43], v[128:131], v[16:19]
s_waitcnt lgkmcnt(14)
s_cselect_b32 s6, 1, s6
ds_read_b128 v[176:179], v7 offset:13312
v_mfma_f32_16x16x32_bf16 v[16:19], a[44:47], v[144:147], v[16:19]
s_waitcnt lgkmcnt(14)
ds_read_b128 v[192:195], v7 offset:14336
v_mfma_f32_16x16x32_bf16 v[20:23], a[44:47], v[148:151], v[20:23]
s_waitcnt lgkmcnt(14)
s_mul_i32 s6, s6, 18432
ds_read_b128 v[196:199], v7 offset:32768
v_mfma_f32_16x16x32_bf16 v[20:23], a[40:43], v[132:135], v[20:23]
s_waitcnt lgkmcnt(14)
ds_read_b128 v[180:183], v7 offset:31744
v_mfma_f32_16x16x32_bf16 v[20:23], a[36:39], v[116:119], v[20:23]
s_waitcnt lgkmcnt(14)
s_add_u32 s30, s10, s6
ds_read_b128 v[164:167], v7 offset:30720
v_mfma_f32_16x16x32_bf16 v[24:27], a[36:39], v[120:123], v[24:27]
s_waitcnt lgkmcnt(8)
ds_read_b128 v[168:171], v8 offset:12288
v_add_f32 v48, v48, v56
v_add_f32 v49, v49, v57
v_mfma_f32_16x16x32_bf16 v[24:27], a[40:43], v[136:139], v[24:27]
s_addc_u32 s31, s11, 0
global_load_dwordx4 a[24:27], v7, s[30:31] offset:-3072 sc1
ds_read_b128 v[184:187], v8 offset:13312
v_add_f32 v50, v50, v58
v_add_f32 v51, v51, v59
v_mfma_f32_16x16x32_bf16 v[24:27], a[44:47], v[152:155], v[24:27]
ds_read_b128 v[200:203], v8 offset:14336
v_add_f32 v52, v52, v60
v_add_f32 v53, v53, v61
v_mfma_f32_16x16x32_bf16 v[28:31], a[44:47], v[156:159], v[28:31]
s_waitcnt lgkmcnt(10)
ds_read_b128 v[204:207], v8 offset:32768
v_add_f32 v54, v54, v62
v_add_f32 v55, v55, v63
v_mfma_f32_16x16x32_bf16 v[28:31], a[40:43], v[140:143], v[28:31]
s_waitcnt lgkmcnt(10)
global_load_dwordx4 a[28:31], v7, s[30:31] offset:-2048 sc1
ds_read_b128 v[188:191], v8 offset:31744
v_add_f32 v48, v48, v52
v_add_f32 v49, v49, v53
v_mfma_f32_16x16x32_bf16 v[28:31], a[36:39], v[124:127], v[28:31]
s_waitcnt lgkmcnt(10)
ds_read_b128 v[172:175], v8 offset:30720
v_add_f32 v50, v50, v54
v_add_f32 v51, v51, v55
v_mfma_f32_16x16x32_bf16 v[16:19], a[48:51], v[160:163], v[16:19]
s_waitcnt lgkmcnt(10)
ds_read_b128 v[208:211], v7 offset:15360
v_add_f32 v48, v48, v50
v_add_f32 v49, v49, v51
v_mfma_f32_16x16x32_bf16 v[16:19], a[52:55], v[176:179], v[16:19]
s_waitcnt lgkmcnt(10)
global_load_dwordx4 a[32:35], v7, s[30:31] offset:-1024 sc1
ds_read_b128 v[224:227], v7 offset:16384
v_mul_f32 v48, 0x3ae38e39, v48
v_mul_f32 v49, 0x3ae38e39, v49
v_mfma_f32_16x16x32_bf16 v[16:19], a[56:59], v[192:195], v[16:19]
s_waitcnt lgkmcnt(10)
ds_read_b128 v[240:243], v7 offset:17408
v_fma_f32 v49, -v48, v48, v49
v_max_f32 v49, 0, v49
v_mfma_f32_16x16x32_bf16 v[20:23], a[56:59], v[196:199], v[20:23]
s_waitcnt lgkmcnt(10)
ds_read_b128 v[244:247], v7 offset:35840
v_add_f32 v49, 0x3727c5ac, v49
v_rsq_f32 v49, v49
v_mfma_f32_16x16x32_bf16 v[20:23], a[52:55], v[180:183], v[20:23]
s_waitcnt lgkmcnt(10)
global_load_dwordx4 a[36:39], v7, s[30:31] offset:0 sc1
ds_read_b128 v[228:231], v7 offset:34816
v_mul_f32 v72, 0x3fb8aa3b, v49
v_mul_f32 v73, 0x3fb8aa3b, v49
v_mfma_f32_16x16x32_bf16 v[20:23], a[48:51], v[164:167], v[20:23]
s_waitcnt lgkmcnt(10)
ds_read_b128 v[212:215], v7 offset:33792
s_nop 0
v_permlane16_swap_b32 v72, v73
v_mfma_f32_16x16x32_bf16 v[24:27], a[48:51], v[168:171], v[24:27]
s_waitcnt lgkmcnt(10)
ds_read_b128 v[216:219], v8 offset:15360
v_mov_b32 v74, v72
v_mov_b32 v75, v73
v_mfma_f32_16x16x32_bf16 v[24:27], a[52:55], v[184:187], v[24:27]
s_waitcnt lgkmcnt(10)
global_load_dwordx4 a[40:43], v7, s[30:31] offset:1024 sc1
ds_read_b128 v[232:235], v8 offset:16384
s_nop 0
v_permlane32_swap_b32 v72, v74
v_mfma_f32_16x16x32_bf16 v[24:27], a[56:59], v[200:203], v[24:27]
s_waitcnt lgkmcnt(10)
ds_read_b128 v[248:251], v8 offset:17408
v_permlane32_swap_b32 v73, v75
v_mfma_f32_16x16x32_bf16 v[28:31], a[56:59], v[204:207], v[28:31]
s_waitcnt lgkmcnt(10)
ds_read_b128 v[252:255], v8 offset:35840
v_mfma_f32_16x16x32_bf16 v[28:31], a[52:55], v[188:191], v[28:31]
s_waitcnt lgkmcnt(10)
global_load_dwordx4 a[44:47], v7, s[30:31] offset:2048 sc1
ds_read_b128 v[236:239], v8 offset:34816
v_mfma_f32_16x16x32_bf16 v[28:31], a[48:51], v[172:175], v[28:31]
s_waitcnt lgkmcnt(10)
ds_read_b128 v[220:223], v8 offset:33792
v_mfma_f32_16x16x32_bf16 v[16:19], a[60:63], v[208:211], v[16:19]
s_waitcnt lgkmcnt(10)
s_add_u32 s30, s30, 0x1800
v_mfma_f32_16x16x32_bf16 v[16:19], a[64:67], v[224:227], v[16:19]
s_waitcnt lgkmcnt(9)
v_mfma_f32_16x16x32_bf16 v[16:19], a[68:71], v[240:243], v[16:19]
s_waitcnt lgkmcnt(8)
s_addc_u32 s31, s31, 0
global_load_dwordx4 a[48:51], v7, s[30:31] offset:-3072 sc1
v_mfma_f32_16x16x32_bf16 v[20:23], a[68:71], v[244:247], v[20:23]
s_waitcnt lgkmcnt(7)
v_mfma_f32_16x16x32_bf16 v[20:23], a[64:67], v[228:231], v[20:23]
s_waitcnt lgkmcnt(6)
v_mfma_f32_16x16x32_bf16 v[20:23], a[60:63], v[212:215], v[20:23]
s_waitcnt lgkmcnt(5)
global_load_dwordx4 a[52:55], v7, s[30:31] offset:-2048 sc1
v_mfma_f32_16x16x32_bf16 v[24:27], a[60:63], v[216:219], v[24:27]
s_waitcnt lgkmcnt(4)
v_fma_f32 v16, v16, v72, v64
v_fma_f32 v17, v17, v72, v65
v_mfma_f32_16x16x32_bf16 v[24:27], a[64:67], v[232:235], v[24:27]
s_waitcnt lgkmcnt(3)
v_exp_f32 v76, v16
v_mfma_f32_16x16x32_bf16 v[24:27], a[68:71], v[248:251], v[24:27]
s_waitcnt lgkmcnt(2)
global_load_dwordx4 a[56:59], v7, s[30:31] offset:-1024 sc1
v_exp_f32 v77, v17
v_mfma_f32_16x16x32_bf16 v[28:31], a[68:71], v[252:255], v[28:31]
s_waitcnt lgkmcnt(1)
v_fma_f32 v76, v76, s56, s56
v_fma_f32 v77, v77, s56, s56
v_mfma_f32_16x16x32_bf16 v[28:31], a[64:67], v[236:239], v[28:31]
s_waitcnt lgkmcnt(0)
v_fma_f32 v76, -v76, v76, -0.5
v_fma_f32 v77, -v77, v77, -0.5
v_mfma_f32_16x16x32_bf16 v[28:31], a[60:63], v[220:223], v[28:31]
global_load_dwordx4 a[60:63], v7, s[30:31] offset:0 sc1
v_rcp_f32 v76, v76
v_mfma_f32_16x16x32_bf16 v[32:35], a[72:75], a[120:123], 0
v_rcp_f32 v77, v77
v_mfma_f32_16x16x32_bf16 v[32:35], a[76:79], a[136:139], v[32:35]
v_fmac_f32 v16, v16, v76
v_fmac_f32 v17, v17, v77
v_mfma_f32_16x16x32_bf16 v[32:35], a[80:83], a[152:155], v[32:35]
global_load_dwordx4 a[64:67], v7, s[30:31] offset:1024 sc1
v_fma_f32 v18, v18, v72, v66
v_fma_f32 v19, v19, v72, v67
v_mfma_f32_16x16x32_bf16 v[36:39], a[80:83], a[156:159], 0
v_exp_f32 v76, v18
v_mfma_f32_16x16x32_bf16 v[36:39], a[76:79], a[140:143], v[36:39]
v_exp_f32 v77, v19
v_mfma_f32_16x16x32_bf16 v[36:39], a[72:75], a[124:127], v[36:39]
global_load_dwordx4 a[68:71], v7, s[30:31] offset:2048 sc1
v_fma_f32 v76, v76, s56, s56
v_fma_f32 v77, v77, s56, s56
v_mfma_f32_16x16x32_bf16 v[40:43], a[72:75], a[128:131], 0
s_add_u32 s30, s30, 0x1800
v_fma_f32 v76, -v76, v76, -0.5
v_fma_f32 v77, -v77, v77, -0.5
v_mfma_f32_16x16x32_bf16 v[40:43], a[76:79], a[144:147], v[40:43]
s_addc_u32 s31, s31, 0
v_rcp_f32 v76, v76
v_mfma_f32_16x16x32_bf16 v[40:43], a[80:83], a[160:163], v[40:43]
v_rcp_f32 v77, v77
v_mfma_f32_16x16x32_bf16 v[44:47], a[80:83], a[164:167], 0
v_fmac_f32 v18, v18, v76
v_fmac_f32 v19, v19, v77
v_mfma_f32_16x16x32_bf16 v[44:47], a[76:79], a[148:151], v[44:47]
v_cvt_pk_bf16_f32 v78, v16, v17
v_cvt_pk_bf16_f32 v79, v18, v19
v_add_u32 v82, s14, v11
v_mfma_f32_16x16x32_bf16 v[44:47], a[72:75], a[132:135], v[44:47]
global_load_dwordx4 a[72:75], v7, s[30:31] offset:-3072 sc1
ds_write_b64 v82, v[78:79] offset:0
v_mfma_f32_16x16x32_bf16 v[32:35], a[84:87], a[168:171], v[32:35]
v_fma_f32 v20, v20, v73, v64
v_fma_f32 v21, v21, v73, v65
v_mfma_f32_16x16x32_bf16 v[32:35], a[88:91], a[184:187], v[32:35]
v_exp_f32 v76, v20
v_mfma_f32_16x16x32_bf16 v[32:35], a[92:95], a[200:203], v[32:35]
global_load_dwordx4 a[76:79], v7, s[30:31] offset:-2048 sc1
v_exp_f32 v77, v21
v_mfma_f32_16x16x32_bf16 v[36:39], a[92:95], a[204:207], v[36:39]
v_fma_f32 v76, v76, s56, s56
v_fma_f32 v77, v77, s56, s56
v_mfma_f32_16x16x32_bf16 v[36:39], a[88:91], a[188:191], v[36:39]
v_fma_f32 v76, -v76, v76, -0.5
v_fma_f32 v77, -v77, v77, -0.5
v_mfma_f32_16x16x32_bf16 v[36:39], a[84:87], a[172:175], v[36:39]
global_load_dwordx4 a[80:83], v7, s[30:31] offset:-1024 sc1
v_rcp_f32 v76, v76
v_mfma_f32_16x16x32_bf16 v[40:43], a[84:87], a[176:179], v[40:43]
v_rcp_f32 v77, v77
v_mfma_f32_16x16x32_bf16 v[40:43], a[88:91], a[192:195], v[40:43]
v_fmac_f32 v20, v20, v76
v_fmac_f32 v21, v21, v77
v_mfma_f32_16x16x32_bf16 v[40:43], a[92:95], a[208:211], v[40:43]
v_fma_f32 v22, v22, v73, v66
v_fma_f32 v23, v23, v73, v67
v_mfma_f32_16x16x32_bf16 v[44:47], a[92:95], a[212:215], v[44:47]
v_exp_f32 v76, v22
v_mfma_f32_16x16x32_bf16 v[44:47], a[88:91], a[196:199], v[44:47]
v_exp_f32 v77, v23
v_mfma_f32_16x16x32_bf16 v[44:47], a[84:87], a[180:183], v[44:47]
global_load_dwordx4 a[84:87], v7, s[30:31] offset:0 sc1
v_fma_f32 v76, v76, s56, s56
v_fma_f32 v77, v77, s56, s56
v_mfma_f32_16x16x32_bf16 v[32:35], a[96:99], a[216:219], v[32:35]
v_fma_f32 v76, -v76, v76, -0.5
v_fma_f32 v77, -v77, v77, -0.5
v_mfma_f32_16x16x32_bf16 v[32:35], a[100:103], a[232:235], v[32:35]
v_rcp_f32 v76, v76
v_mfma_f32_16x16x32_bf16 v[32:35], a[104:107], a[248:251], v[32:35]
global_load_dwordx4 a[88:91], v7, s[30:31] offset:1024 sc1
v_rcp_f32 v77, v77
v_mfma_f32_16x16x32_bf16 v[36:39], a[104:107], a[252:255], v[36:39]
v_fmac_f32 v22, v22, v76
v_fmac_f32 v23, v23, v77
v_mfma_f32_16x16x32_bf16 v[36:39], a[100:103], a[236:239], v[36:39]
v_cvt_pk_bf16_f32 v80, v20, v21
v_cvt_pk_bf16_f32 v81, v22, v23
v_mfma_f32_16x16x32_bf16 v[36:39], a[96:99], a[220:223], v[36:39]
global_load_dwordx4 a[92:95], v7, s[30:31] offset:2048 sc1
ds_write_b64 v82, v[80:81] offset:1024
v_mfma_f32_16x16x32_bf16 v[40:43], a[96:99], a[224:227], v[40:43]
s_cmp_eq_u32 s8, 3
v_fma_f32 v24, v24, v74, v64
v_fma_f32 v25, v25, v74, v65
v_mfma_f32_16x16x32_bf16 v[40:43], a[100:103], a[240:243], v[40:43]
s_cselect_b32 s6, 4, 3
v_exp_f32 v76, v24
v_mfma_f32_16x16x32_bf16 v[40:43], a[104:107], v[104:107], v[40:43]
s_cmp_eq_u32 s8, 2
v_exp_f32 v77, v25
v_mfma_f32_16x16x32_bf16 v[44:47], a[104:107], v[108:111], v[44:47]
s_cselect_b32 s6, 2, s6
v_fma_f32 v76, v76, s56, s56
v_fma_f32 v77, v77, s56, s56
v_mfma_f32_16x16x32_bf16 v[44:47], a[100:103], a[244:247], v[44:47]
s_mul_i32 s6, s6, 18432
v_fma_f32 v76, -v76, v76, -0.5
v_fma_f32 v77, -v77, v77, -0.5
v_mfma_f32_16x16x32_bf16 v[44:47], a[96:99], a[228:231], v[44:47]
s_add_u32 s30, s10, s6
v_rcp_f32 v76, v76
v_mfma_f32_16x16x32_bf16 v[32:35], a[108:111], v[112:115], v[32:35]
s_addc_u32 s31, s11, 0
global_load_dwordx4 a[96:99], v7, s[30:31] offset:-3072 sc1
v_rcp_f32 v77, v77
v_mfma_f32_16x16x32_bf16 v[32:35], a[112:115], v[128:131], v[32:35]
s_cmp_eq_u32 s8, 2
v_fmac_f32 v24, v24, v76
v_fmac_f32 v25, v25, v77
v_mfma_f32_16x16x32_bf16 v[32:35], a[116:119], v[144:147], v[32:35]
s_cselect_b32 s7, 3, 2
v_fma_f32 v26, v26, v74, v66
v_fma_f32 v27, v27, v74, v67
v_mfma_f32_16x16x32_bf16 v[36:39], a[116:119], v[148:151], v[36:39]
s_cmp_eq_u32 s8, 1
global_load_dwordx4 a[100:103], v7, s[30:31] offset:-2048 sc1
v_exp_f32 v76, v26
v_mfma_f32_16x16x32_bf16 v[36:39], a[112:115], v[132:135], v[36:39]
s_cselect_b32 s7, 1, s7
v_exp_f32 v77, v27
v_mfma_f32_16x16x32_bf16 v[36:39], a[108:111], v[116:119], v[36:39]
s_sub_u32 s14, s7, 2
v_fma_f32 v76, v76, s56, s56
v_fma_f32 v77, v77, s56, s56
v_mfma_f32_16x16x32_bf16 v[40:43], a[108:111], v[120:123], v[40:43]
s_lshl_b32 s14, s14, 13
global_load_dwordx4 a[104:107], v7, s[30:31] offset:-1024 sc1
v_fma_f32 v76, -v76, v76, -0.5
v_fma_f32 v77, -v77, v77, -0.5
v_mfma_f32_16x16x32_bf16 v[40:43], a[112:115], v[136:139], v[40:43]
s_lshl_b32 s7, s7, 8
v_rcp_f32 v76, v76
v_mfma_f32_16x16x32_bf16 v[40:43], a[116:119], v[152:155], v[40:43]
s_add_u32 s12, s22, s7
v_rcp_f32 v77, v77
v_mfma_f32_16x16x32_bf16 v[44:47], a[116:119], v[156:159], v[44:47]
s_addc_u32 s13, s23, 0
v_fmac_f32 v26, v26, v76
v_fmac_f32 v27, v27, v77
v_mfma_f32_16x16x32_bf16 v[44:47], a[112:115], v[140:143], v[44:47]
v_cvt_pk_bf16_f32 v78, v24, v25
v_cvt_pk_bf16_f32 v79, v26, v27
v_mfma_f32_16x16x32_bf16 v[44:47], a[108:111], v[124:127], v[44:47]
s_waitcnt vmcnt(24)
global_load_dwordx4 a[108:111], v7, s[30:31] offset:0 sc1
ds_write_b64 v82, v[78:79] offset:2048
v_mfma_f32_16x16x32_bf16 v[32:35], a[0:3], v[160:163], v[32:35]
v_fma_f32 v28, v28, v75, v64
v_fma_f32 v29, v29, v75, v65
v_mfma_f32_16x16x32_bf16 v[32:35], a[4:7], v[176:179], v[32:35]
v_exp_f32 v76, v28
v_mfma_f32_16x16x32_bf16 v[32:35], a[8:11], v[192:195], v[32:35]
global_load_dwordx4 a[112:115], v7, s[30:31] offset:1024 sc1
v_exp_f32 v77, v29
v_mfma_f32_16x16x32_bf16 v[36:39], a[8:11], v[196:199], v[36:39]
v_fma_f32 v76, v76, s56, s56
v_fma_f32 v77, v77, s56, s56
v_mfma_f32_16x16x32_bf16 v[36:39], a[4:7], v[180:183], v[36:39]
v_fma_f32 v76, -v76, v76, -0.5
v_fma_f32 v77, -v77, v77, -0.5
v_mfma_f32_16x16x32_bf16 v[36:39], a[0:3], v[164:167], v[36:39]
global_load_dwordx4 a[116:119], v7, s[30:31] offset:2048 sc1
v_rcp_f32 v76, v76
v_mfma_f32_16x16x32_bf16 v[40:43], a[0:3], v[168:171], v[40:43]
s_add_u32 s30, s30, 0x1800
v_rcp_f32 v77, v77
v_mfma_f32_16x16x32_bf16 v[40:43], a[4:7], v[184:187], v[40:43]
s_addc_u32 s31, s31, 0
v_fmac_f32 v28, v28, v76
v_fmac_f32 v29, v29, v77
v_mfma_f32_16x16x32_bf16 v[40:43], a[8:11], v[200:203], v[40:43]
v_fma_f32 v30, v30, v75, v66
v_fma_f32 v31, v31, v75, v67
v_mfma_f32_16x16x32_bf16 v[44:47], a[8:11], v[204:207], v[44:47]
v_exp_f32 v76, v30
v_mfma_f32_16x16x32_bf16 v[44:47], a[4:7], v[188:191], v[44:47]
v_exp_f32 v77, v31
v_mfma_f32_16x16x32_bf16 v[44:47], a[0:3], v[172:175], v[44:47]
s_waitcnt vmcnt(24)
global_load_dwordx4 a[0:3], v7, s[30:31] offset:-3072 sc1
v_fma_f32 v76, v76, s56, s56
v_fma_f32 v77, v77, s56, s56
v_mfma_f32_16x16x32_bf16 v[32:35], a[12:15], v[208:211], v[32:35]
v_fma_f32 v76, -v76, v76, -0.5
v_fma_f32 v77, -v77, v77, -0.5
v_mfma_f32_16x16x32_bf16 v[32:35], a[16:19], v[224:227], v[32:35]
v_rcp_f32 v76, v76
v_mfma_f32_16x16x32_bf16 v[32:35], a[20:23], v[240:243], v[32:35]
global_load_dwordx4 a[4:7], v7, s[30:31] offset:-2048 sc1
v_rcp_f32 v77, v77
v_mfma_f32_16x16x32_bf16 v[36:39], a[20:23], v[244:247], v[36:39]
v_fmac_f32 v30, v30, v76
v_fmac_f32 v31, v31, v77
v_mfma_f32_16x16x32_bf16 v[36:39], a[16:19], v[228:231], v[36:39]
v_cvt_pk_bf16_f32 v80, v28, v29
v_cvt_pk_bf16_f32 v81, v30, v31
v_mfma_f32_16x16x32_bf16 v[36:39], a[12:15], v[212:215], v[36:39]
global_load_dwordx4 a[8:11], v7, s[30:31] offset:-1024 sc1
ds_write_b64 v82, v[80:81] offset:3072
v_mfma_f32_16x16x32_bf16 v[40:43], a[12:15], v[216:219], v[40:43]
v_fma_f32 v32, v32, v72, v68
v_fma_f32 v33, v33, v72, v69
v_mfma_f32_16x16x32_bf16 v[40:43], a[16:19], v[232:235], v[40:43]
v_exp_f32 v76, v32
v_mfma_f32_16x16x32_bf16 v[40:43], a[20:23], v[248:251], v[40:43]
v_exp_f32 v77, v33
v_mfma_f32_16x16x32_bf16 v[44:47], a[20:23], v[252:255], v[44:47]
v_fma_f32 v76, v76, s56, s56
v_fma_f32 v77, v77, s56, s56
v_mfma_f32_16x16x32_bf16 v[44:47], a[16:19], v[236:239], v[44:47]
v_fma_f32 v76, -v76, v76, -0.5
v_fma_f32 v77, -v77, v77, -0.5
v_mfma_f32_16x16x32_bf16 v[44:47], a[12:15], v[220:223], v[44:47]
s_waitcnt vmcnt(24)
global_load_dwordx4 a[12:15], v7, s[30:31] offset:0 sc1
v_rcp_f32 v76, v76
v_mfma_f32_16x16x32_bf16 v[16:19], a[24:27], a[120:123], 0
v_rcp_f32 v77, v77
v_mfma_f32_16x16x32_bf16 v[16:19], a[28:31], a[136:139], v[16:19]
v_fmac_f32 v32, v32, v76
v_fmac_f32 v33, v33, v77
v_mfma_f32_16x16x32_bf16 v[16:19], a[32:35], a[152:155], v[16:19]
global_load_dwordx4 a[16:19], v7, s[30:31] offset:1024 sc1
v_fma_f32 v34, v34, v72, v70
v_fma_f32 v35, v35, v72, v71
v_mfma_f32_16x16x32_bf16 v[20:23], a[32:35], a[156:159], 0
v_exp_f32 v76, v34
v_mfma_f32_16x16x32_bf16 v[20:23], a[28:31], a[140:143], v[20:23]
global_load_dwordx4 v[64:67], v13, s[12:13] sc1
v_exp_f32 v77, v35
v_mfma_f32_16x16x32_bf16 v[20:23], a[24:27], a[124:127], v[20:23]
global_load_dwordx4 a[20:23], v7, s[30:31] offset:2048 sc1
v_fma_f32 v76, v76, s56, s56
v_fma_f32 v77, v77, s56, s56
v_mfma_f32_16x16x32_bf16 v[24:27], a[24:27], a[128:131], 0
s_add_u32 s30, s30, 0x1800
v_fma_f32 v76, -v76, v76, -0.5
v_fma_f32 v77, -v77, v77, -0.5
v_mfma_f32_16x16x32_bf16 v[24:27], a[28:31], a[144:147], v[24:27]
s_addc_u32 s31, s31, 0
v_rcp_f32 v76, v76
v_mfma_f32_16x16x32_bf16 v[24:27], a[32:35], a[160:163], v[24:27]
v_rcp_f32 v77, v77
v_mfma_f32_16x16x32_bf16 v[28:31], a[32:35], a[164:167], 0
v_fmac_f32 v34, v34, v76
v_fmac_f32 v35, v35, v77
v_mfma_f32_16x16x32_bf16 v[28:31], a[28:31], a[148:151], v[28:31]
v_cvt_pk_bf16_f32 v78, v32, v33
v_cvt_pk_bf16_f32 v79, v34, v35
v_add_u32 v82, s15, v11
v_mfma_f32_16x16x32_bf16 v[28:31], a[24:27], a[132:135], v[28:31]
s_waitcnt vmcnt(25)
global_load_dwordx4 a[24:27], v7, s[30:31] offset:-3072 sc1
ds_write_b64 v82, v[78:79] offset:8192
v_mfma_f32_16x16x32_bf16 v[16:19], a[36:39], a[168:171], v[16:19]
v_fma_f32 v36, v36, v73, v68
v_fma_f32 v37, v37, v73, v69
v_mfma_f32_16x16x32_bf16 v[16:19], a[40:43], a[184:187], v[16:19]
v_exp_f32 v76, v36
v_mfma_f32_16x16x32_bf16 v[16:19], a[44:47], a[200:203], v[16:19]
global_load_dwordx4 a[28:31], v7, s[30:31] offset:-2048 sc1
v_exp_f32 v77, v37
v_mfma_f32_16x16x32_bf16 v[20:23], a[44:47], a[204:207], v[20:23]
v_fma_f32 v76, v76, s56, s56
v_fma_f32 v77, v77, s56, s56
v_mfma_f32_16x16x32_bf16 v[20:23], a[40:43], a[188:191], v[20:23]
v_fma_f32 v76, -v76, v76, -0.5
v_fma_f32 v77, -v77, v77, -0.5
v_mfma_f32_16x16x32_bf16 v[20:23], a[36:39], a[172:175], v[20:23]
global_load_dwordx4 a[32:35], v7, s[30:31] offset:-1024 sc1
v_rcp_f32 v76, v76
v_mfma_f32_16x16x32_bf16 v[24:27], a[36:39], a[176:179], v[24:27]
v_rcp_f32 v77, v77
v_mfma_f32_16x16x32_bf16 v[24:27], a[40:43], a[192:195], v[24:27]
v_fmac_f32 v36, v36, v76
v_fmac_f32 v37, v37, v77
v_mfma_f32_16x16x32_bf16 v[24:27], a[44:47], a[208:211], v[24:27]
v_fma_f32 v38, v38, v73, v70
v_fma_f32 v39, v39, v73, v71
v_mfma_f32_16x16x32_bf16 v[28:31], a[44:47], a[212:215], v[28:31]
v_exp_f32 v76, v38
v_mfma_f32_16x16x32_bf16 v[28:31], a[40:43], a[196:199], v[28:31]
v_exp_f32 v77, v39
v_mfma_f32_16x16x32_bf16 v[28:31], a[36:39], a[180:183], v[28:31]
s_waitcnt vmcnt(25)
global_load_dwordx4 a[36:39], v7, s[30:31] offset:0 sc1
v_fma_f32 v76, v76, s56, s56
v_fma_f32 v77, v77, s56, s56
v_mfma_f32_16x16x32_bf16 v[16:19], a[48:51], a[216:219], v[16:19]
v_fma_f32 v76, -v76, v76, -0.5
v_fma_f32 v77, -v77, v77, -0.5
v_mfma_f32_16x16x32_bf16 v[16:19], a[52:55], a[232:235], v[16:19]
v_rcp_f32 v76, v76
v_mfma_f32_16x16x32_bf16 v[16:19], a[56:59], a[248:251], v[16:19]
global_load_dwordx4 a[40:43], v7, s[30:31] offset:1024 sc1
v_rcp_f32 v77, v77
v_mfma_f32_16x16x32_bf16 v[20:23], a[56:59], a[252:255], v[20:23]
v_fmac_f32 v38, v38, v76
v_fmac_f32 v39, v39, v77
v_mfma_f32_16x16x32_bf16 v[20:23], a[52:55], a[236:239], v[20:23]
v_cvt_pk_bf16_f32 v80, v36, v37
v_cvt_pk_bf16_f32 v81, v38, v39
v_mfma_f32_16x16x32_bf16 v[20:23], a[48:51], a[220:223], v[20:23]
global_load_dwordx4 a[44:47], v7, s[30:31] offset:2048 sc1
ds_write_b64 v82, v[80:81] offset:9216
v_mfma_f32_16x16x32_bf16 v[24:27], a[48:51], a[224:227], v[24:27]
s_cmp_eq_u32 s8, 4
v_fma_f32 v40, v40, v74, v68
v_fma_f32 v41, v41, v74, v69
v_mfma_f32_16x16x32_bf16 v[24:27], a[52:55], a[240:243], v[24:27]
s_cselect_b32 s6, 5, 4
v_exp_f32 v76, v40
v_mfma_f32_16x16x32_bf16 v[24:27], a[56:59], v[104:107], v[24:27]
s_cmp_eq_u32 s8, 3
v_exp_f32 v77, v41
v_mfma_f32_16x16x32_bf16 v[28:31], a[56:59], v[108:111], v[28:31]
s_cselect_b32 s6, 3, s6
v_fma_f32 v76, v76, s56, s56
v_fma_f32 v77, v77, s56, s56
v_mfma_f32_16x16x32_bf16 v[28:31], a[52:55], a[244:247], v[28:31]
s_mul_i32 s6, s6, 18432
v_fma_f32 v76, -v76, v76, -0.5
v_fma_f32 v77, -v77, v77, -0.5
v_mfma_f32_16x16x32_bf16 v[28:31], a[48:51], a[228:231], v[28:31]
s_waitcnt vmcnt(25)
v_rcp_f32 v76, v76
v_mfma_f32_16x16x32_bf16 v[16:19], a[60:63], v[112:115], v[16:19]
s_add_u32 s30, s10, s6
v_rcp_f32 v77, v77
v_mfma_f32_16x16x32_bf16 v[16:19], a[64:67], v[128:131], v[16:19]
s_addc_u32 s31, s11, 0
global_load_dwordx4 a[48:51], v7, s[30:31] offset:-3072 sc1
v_fmac_f32 v40, v40, v76
v_fmac_f32 v41, v41, v77
v_mfma_f32_16x16x32_bf16 v[16:19], a[68:71], v[144:147], v[16:19]
s_cmp_eq_u32 s8, 3
v_fma_f32 v42, v42, v74, v70
v_fma_f32 v43, v43, v74, v71
v_mfma_f32_16x16x32_bf16 v[20:23], a[68:71], v[148:151], v[20:23]
s_cselect_b32 s7, 4, 3
v_exp_f32 v76, v42
v_mfma_f32_16x16x32_bf16 v[20:23], a[64:67], v[132:135], v[20:23]
s_cmp_eq_u32 s8, 2
global_load_dwordx4 a[52:55], v7, s[30:31] offset:-2048 sc1
v_exp_f32 v77, v43
v_mfma_f32_16x16x32_bf16 v[20:23], a[60:63], v[116:119], v[20:23]
s_cselect_b32 s7, 2, s7
v_fma_f32 v76, v76, s56, s56
v_fma_f32 v77, v77, s56, s56
v_mfma_f32_16x16x32_bf16 v[24:27], a[60:63], v[120:123], v[24:27]
s_sub_u32 s15, s7, 3
v_fma_f32 v76, -v76, v76, -0.5
v_fma_f32 v77, -v77, v77, -0.5
v_mfma_f32_16x16x32_bf16 v[24:27], a[64:67], v[136:139], v[24:27]
s_lshl_b32 s15, s15, 13
global_load_dwordx4 a[56:59], v7, s[30:31] offset:-1024 sc1
v_rcp_f32 v76, v76
v_mfma_f32_16x16x32_bf16 v[24:27], a[68:71], v[152:155], v[24:27]
s_lshl_b32 s7, s7, 8
v_rcp_f32 v77, v77
v_mfma_f32_16x16x32_bf16 v[28:31], a[68:71], v[156:159], v[28:31]
s_add_u32 s12, s22, s7
v_fmac_f32 v42, v42, v76
v_fmac_f32 v43, v43, v77
v_mfma_f32_16x16x32_bf16 v[28:31], a[64:67], v[140:143], v[28:31]
s_addc_u32 s13, s23, 0
v_cvt_pk_bf16_f32 v78, v40, v41
v_cvt_pk_bf16_f32 v79, v42, v43
v_mfma_f32_16x16x32_bf16 v[28:31], a[60:63], v[124:127], v[28:31]
s_waitcnt vmcnt(25)
global_load_dwordx4 a[60:63], v7, s[30:31] offset:0 sc1
ds_write_b64 v82, v[78:79] offset:10240
v_mfma_f32_16x16x32_bf16 v[16:19], a[72:75], v[160:163], v[16:19]
v_fma_f32 v44, v44, v75, v68
v_fma_f32 v45, v45, v75, v69
v_mfma_f32_16x16x32_bf16 v[16:19], a[76:79], v[176:179], v[16:19]
v_exp_f32 v76, v44
v_mfma_f32_16x16x32_bf16 v[16:19], a[80:83], v[192:195], v[16:19]
global_load_dwordx4 a[64:67], v7, s[30:31] offset:1024 sc1
v_exp_f32 v77, v45
v_mfma_f32_16x16x32_bf16 v[20:23], a[80:83], v[196:199], v[20:23]
v_fma_f32 v76, v76, s56, s56
v_fma_f32 v77, v77, s56, s56
v_mfma_f32_16x16x32_bf16 v[20:23], a[76:79], v[180:183], v[20:23]
v_fma_f32 v76, -v76, v76, -0.5
v_fma_f32 v77, -v77, v77, -0.5
v_mfma_f32_16x16x32_bf16 v[20:23], a[72:75], v[164:167], v[20:23]
global_load_dwordx4 a[68:71], v7, s[30:31] offset:2048 sc1
v_rcp_f32 v76, v76
v_mfma_f32_16x16x32_bf16 v[24:27], a[72:75], v[168:171], v[24:27]
s_add_u32 s30, s30, 0x1800
v_rcp_f32 v77, v77
v_mfma_f32_16x16x32_bf16 v[24:27], a[76:79], v[184:187], v[24:27]
s_addc_u32 s31, s31, 0
v_fmac_f32 v44, v44, v76
v_fmac_f32 v45, v45, v77
v_mfma_f32_16x16x32_bf16 v[24:27], a[80:83], v[200:203], v[24:27]
v_fma_f32 v46, v46, v75, v70
v_fma_f32 v47, v47, v75, v71
v_mfma_f32_16x16x32_bf16 v[28:31], a[80:83], v[204:207], v[28:31]
v_exp_f32 v76, v46
v_mfma_f32_16x16x32_bf16 v[28:31], a[76:79], v[188:191], v[28:31]
v_exp_f32 v77, v47
v_mfma_f32_16x16x32_bf16 v[28:31], a[72:75], v[172:175], v[28:31]
s_waitcnt vmcnt(25)
global_load_dwordx4 a[72:75], v7, s[30:31] offset:-3072 sc1
v_fma_f32 v76, v76, s56, s56
v_fma_f32 v77, v77, s56, s56
v_mfma_f32_16x16x32_bf16 v[16:19], a[84:87], v[208:211], v[16:19]
v_fma_f32 v76, -v76, v76, -0.5
v_fma_f32 v77, -v77, v77, -0.5
v_mfma_f32_16x16x32_bf16 v[16:19], a[88:91], v[224:227], v[16:19]
v_rcp_f32 v76, v76
v_mfma_f32_16x16x32_bf16 v[16:19], a[92:95], v[240:243], v[16:19]
global_load_dwordx4 a[76:79], v7, s[30:31] offset:-2048 sc1
v_rcp_f32 v77, v77
v_mfma_f32_16x16x32_bf16 v[20:23], a[92:95], v[244:247], v[20:23]
v_fmac_f32 v46, v46, v76
v_fmac_f32 v47, v47, v77
v_mfma_f32_16x16x32_bf16 v[20:23], a[88:91], v[228:231], v[20:23]
v_cvt_pk_bf16_f32 v80, v44, v45
v_cvt_pk_bf16_f32 v81, v46, v47
v_mfma_f32_16x16x32_bf16 v[20:23], a[84:87], v[212:215], v[20:23]
global_load_dwordx4 a[80:83], v7, s[30:31] offset:-1024 sc1
ds_write_b64 v82, v[80:81] offset:11264
v_mfma_f32_16x16x32_bf16 v[24:27], a[84:87], v[216:219], v[24:27]
s_waitcnt vmcnt(16)
v_fma_f32 v16, v16, v72, v64
v_fma_f32 v17, v17, v72, v65
v_mfma_f32_16x16x32_bf16 v[24:27], a[88:91], v[232:235], v[24:27]
v_exp_f32 v76, v16
v_mfma_f32_16x16x32_bf16 v[24:27], a[92:95], v[248:251], v[24:27]
v_exp_f32 v77, v17
v_mfma_f32_16x16x32_bf16 v[28:31], a[92:95], v[252:255], v[28:31]
v_fma_f32 v76, v76, s56, s56
v_fma_f32 v77, v77, s56, s56
v_mfma_f32_16x16x32_bf16 v[28:31], a[88:91], v[236:239], v[28:31]
v_fma_f32 v76, -v76, v76, -0.5
v_fma_f32 v77, -v77, v77, -0.5
v_mfma_f32_16x16x32_bf16 v[28:31], a[84:87], v[220:223], v[28:31]
global_load_dwordx4 a[84:87], v7, s[30:31] offset:0 sc1
v_rcp_f32 v76, v76
v_mfma_f32_16x16x32_bf16 v[32:35], a[96:99], a[120:123], 0
v_rcp_f32 v77, v77
v_mfma_f32_16x16x32_bf16 v[32:35], a[100:103], a[136:139], v[32:35]
v_fmac_f32 v16, v16, v76
v_fmac_f32 v17, v17, v77
v_mfma_f32_16x16x32_bf16 v[32:35], a[104:107], a[152:155], v[32:35]
global_load_dwordx4 a[88:91], v7, s[30:31] offset:1024 sc1
v_fma_f32 v18, v18, v72, v66
v_fma_f32 v19, v19, v72, v67
v_mfma_f32_16x16x32_bf16 v[36:39], a[104:107], a[156:159], 0
v_exp_f32 v76, v18
v_mfma_f32_16x16x32_bf16 v[36:39], a[100:103], a[140:143], v[36:39]
global_load_dwordx4 v[68:71], v13, s[12:13] sc1
v_exp_f32 v77, v19
v_mfma_f32_16x16x32_bf16 v[36:39], a[96:99], a[124:127], v[36:39]
global_load_dwordx4 a[92:95], v7, s[30:31] offset:2048 sc1
v_fma_f32 v76, v76, s56, s56
v_fma_f32 v77, v77, s56, s56
v_mfma_f32_16x16x32_bf16 v[40:43], a[96:99], a[128:131], 0
s_add_u32 s30, s30, 0x1800
v_fma_f32 v76, -v76, v76, -0.5
v_fma_f32 v77, -v77, v77, -0.5
v_mfma_f32_16x16x32_bf16 v[40:43], a[100:103], a[144:147], v[40:43]
s_addc_u32 s31, s31, 0
v_rcp_f32 v76, v76
v_mfma_f32_16x16x32_bf16 v[40:43], a[104:107], a[160:163], v[40:43]
v_rcp_f32 v77, v77
v_mfma_f32_16x16x32_bf16 v[44:47], a[104:107], a[164:167], 0
v_fmac_f32 v18, v18, v76
v_fmac_f32 v19, v19, v77
v_mfma_f32_16x16x32_bf16 v[44:47], a[100:103], a[148:151], v[44:47]
v_cvt_pk_bf16_f32 v78, v16, v17
v_cvt_pk_bf16_f32 v79, v18, v19
v_add_u32 v82, s14, v11
v_mfma_f32_16x16x32_bf16 v[44:47], a[96:99], a[132:135], v[44:47]
global_load_dwordx4 a[96:99], v7, s[30:31] offset:-3072 sc1
ds_write_b64 v82, v[78:79] offset:16384
v_mfma_f32_16x16x32_bf16 v[32:35], a[108:111], a[168:171], v[32:35]
v_fma_f32 v20, v20, v73, v64
v_fma_f32 v21, v21, v73, v65
v_mfma_f32_16x16x32_bf16 v[32:35], a[112:115], a[184:187], v[32:35]
v_exp_f32 v76, v20
v_mfma_f32_16x16x32_bf16 v[32:35], a[116:119], a[200:203], v[32:35]
global_load_dwordx4 a[100:103], v7, s[30:31] offset:-2048 sc1
v_exp_f32 v77, v21
v_mfma_f32_16x16x32_bf16 v[36:39], a[116:119], a[204:207], v[36:39]
v_fma_f32 v76, v76, s56, s56
v_fma_f32 v77, v77, s56, s56
v_mfma_f32_16x16x32_bf16 v[36:39], a[112:115], a[188:191], v[36:39]
v_fma_f32 v76, -v76, v76, -0.5
v_fma_f32 v77, -v77, v77, -0.5
v_mfma_f32_16x16x32_bf16 v[36:39], a[108:111], a[172:175], v[36:39]
global_load_dwordx4 a[104:107], v7, s[30:31] offset:-1024 sc1
v_rcp_f32 v76, v76
v_mfma_f32_16x16x32_bf16 v[40:43], a[108:111], a[176:179], v[40:43]
v_rcp_f32 v77, v77
v_mfma_f32_16x16x32_bf16 v[40:43], a[112:115], a[192:195], v[40:43]
v_fmac_f32 v20, v20, v76
v_fmac_f32 v21, v21, v77
v_mfma_f32_16x16x32_bf16 v[40:43], a[116:119], a[208:211], v[40:43]
v_fma_f32 v22, v22, v73, v66
v_fma_f32 v23, v23, v73, v67
v_mfma_f32_16x16x32_bf16 v[44:47], a[116:119], a[212:215], v[44:47]
v_exp_f32 v76, v22
v_mfma_f32_16x16x32_bf16 v[44:47], a[112:115], a[196:199], v[44:47]
v_exp_f32 v77, v23
v_mfma_f32_16x16x32_bf16 v[44:47], a[108:111], a[180:183], v[44:47]
global_load_dwordx4 a[108:111], v7, s[30:31] offset:0 sc1
v_fma_f32 v76, v76, s56, s56
v_fma_f32 v77, v77, s56, s56
v_mfma_f32_16x16x32_bf16 v[32:35], a[0:3], a[216:219], v[32:35]
v_fma_f32 v76, -v76, v76, -0.5
v_fma_f32 v77, -v77, v77, -0.5
v_mfma_f32_16x16x32_bf16 v[32:35], a[4:7], a[232:235], v[32:35]
v_rcp_f32 v76, v76
v_mfma_f32_16x16x32_bf16 v[32:35], a[8:11], a[248:251], v[32:35]
global_load_dwordx4 a[112:115], v7, s[30:31] offset:1024 sc1
v_rcp_f32 v77, v77
v_mfma_f32_16x16x32_bf16 v[36:39], a[8:11], a[252:255], v[36:39]
v_fmac_f32 v22, v22, v76
v_fmac_f32 v23, v23, v77
v_mfma_f32_16x16x32_bf16 v[36:39], a[4:7], a[236:239], v[36:39]
v_cvt_pk_bf16_f32 v80, v20, v21
v_cvt_pk_bf16_f32 v81, v22, v23
v_mfma_f32_16x16x32_bf16 v[36:39], a[0:3], a[220:223], v[36:39]
global_load_dwordx4 a[116:119], v7, s[30:31] offset:2048 sc1
ds_write_b64 v82, v[80:81] offset:17408
v_mfma_f32_16x16x32_bf16 v[40:43], a[0:3], a[224:227], v[40:43]
s_cmp_eq_u32 s8, 5
v_fma_f32 v24, v24, v74, v64
v_fma_f32 v25, v25, v74, v65
v_mfma_f32_16x16x32_bf16 v[40:43], a[4:7], a[240:243], v[40:43]
s_cselect_b32 s6, 6, 5
v_exp_f32 v76, v24
v_mfma_f32_16x16x32_bf16 v[40:43], a[8:11], v[104:107], v[40:43]
s_cmp_eq_u32 s8, 4
v_exp_f32 v77, v25
v_mfma_f32_16x16x32_bf16 v[44:47], a[8:11], v[108:111], v[44:47]
s_cselect_b32 s6, 4, s6
v_fma_f32 v76, v76, s56, s56
v_fma_f32 v77, v77, s56, s56
v_mfma_f32_16x16x32_bf16 v[44:47], a[4:7], a[244:247], v[44:47]
s_mul_i32 s6, s6, 18432
v_fma_f32 v76, -v76, v76, -0.5
v_fma_f32 v77, -v77, v77, -0.5
v_mfma_f32_16x16x32_bf16 v[44:47], a[0:3], a[228:231], v[44:47]
s_add_u32 s30, s10, s6
v_rcp_f32 v76, v76
v_mfma_f32_16x16x32_bf16 v[32:35], a[12:15], v[112:115], v[32:35]
s_addc_u32 s31, s11, 0
global_load_dwordx4 a[0:3], v7, s[30:31] offset:-3072 sc1
v_rcp_f32 v77, v77
v_mfma_f32_16x16x32_bf16 v[32:35], a[16:19], v[128:131], v[32:35]
s_waitcnt vmcnt(26)
v_fmac_f32 v24, v24, v76
v_fmac_f32 v25, v25, v77
v_mfma_f32_16x16x32_bf16 v[32:35], a[20:23], v[144:147], v[32:35]
s_cmp_eq_u32 s8, 4
v_fma_f32 v26, v26, v74, v66
v_fma_f32 v27, v27, v74, v67
v_mfma_f32_16x16x32_bf16 v[36:39], a[20:23], v[148:151], v[36:39]
s_cselect_b32 s7, 5, 4
global_load_dwordx4 a[4:7], v7, s[30:31] offset:-2048 sc1
v_exp_f32 v76, v26
v_mfma_f32_16x16x32_bf16 v[36:39], a[16:19], v[132:135], v[36:39]
s_cmp_eq_u32 s8, 3
v_exp_f32 v77, v27
v_mfma_f32_16x16x32_bf16 v[36:39], a[12:15], v[116:119], v[36:39]
s_cselect_b32 s7, 3, s7
v_fma_f32 v76, v76, s56, s56
v_fma_f32 v77, v77, s56, s56
v_mfma_f32_16x16x32_bf16 v[40:43], a[12:15], v[120:123], v[40:43]
s_sub_u32 s14, s7, 4
global_load_dwordx4 a[8:11], v7, s[30:31] offset:-1024 sc1
v_fma_f32 v76, -v76, v76, -0.5
v_fma_f32 v77, -v77, v77, -0.5
v_mfma_f32_16x16x32_bf16 v[40:43], a[16:19], v[136:139], v[40:43]
s_lshl_b32 s14, s14, 13
v_rcp_f32 v76, v76
v_mfma_f32_16x16x32_bf16 v[40:43], a[20:23], v[152:155], v[40:43]
s_lshl_b32 s7, s7, 8
v_rcp_f32 v77, v77
v_mfma_f32_16x16x32_bf16 v[44:47], a[20:23], v[156:159], v[44:47]
s_add_u32 s12, s22, s7
v_fmac_f32 v26, v26, v76
v_fmac_f32 v27, v27, v77
v_mfma_f32_16x16x32_bf16 v[44:47], a[16:19], v[140:143], v[44:47]
s_addc_u32 s13, s23, 0
v_cvt_pk_bf16_f32 v78, v24, v25
v_cvt_pk_bf16_f32 v79, v26, v27
v_mfma_f32_16x16x32_bf16 v[44:47], a[12:15], v[124:127], v[44:47]
s_waitcnt vmcnt(25)
global_load_dwordx4 a[12:15], v7, s[30:31] offset:0 sc1
ds_write_b64 v82, v[78:79] offset:18432
v_mfma_f32_16x16x32_bf16 v[32:35], a[24:27], v[160:163], v[32:35]
v_fma_f32 v28, v28, v75, v64
v_fma_f32 v29, v29, v75, v65
v_mfma_f32_16x16x32_bf16 v[32:35], a[28:31], v[176:179], v[32:35]
v_exp_f32 v76, v28
v_mfma_f32_16x16x32_bf16 v[32:35], a[32:35], v[192:195], v[32:35]
global_load_dwordx4 a[16:19], v7, s[30:31] offset:1024 sc1
v_exp_f32 v77, v29
v_mfma_f32_16x16x32_bf16 v[36:39], a[32:35], v[196:199], v[36:39]
v_fma_f32 v76, v76, s56, s56
v_fma_f32 v77, v77, s56, s56
v_mfma_f32_16x16x32_bf16 v[36:39], a[28:31], v[180:183], v[36:39]
v_fma_f32 v76, -v76, v76, -0.5
v_fma_f32 v77, -v77, v77, -0.5
v_mfma_f32_16x16x32_bf16 v[36:39], a[24:27], v[164:167], v[36:39]
global_load_dwordx4 a[20:23], v7, s[30:31] offset:2048 sc1
v_rcp_f32 v76, v76
v_mfma_f32_16x16x32_bf16 v[40:43], a[24:27], v[168:171], v[40:43]
s_add_u32 s30, s30, 0x1800
v_rcp_f32 v77, v77
v_mfma_f32_16x16x32_bf16 v[40:43], a[28:31], v[184:187], v[40:43]
s_addc_u32 s31, s31, 0
v_fmac_f32 v28, v28, v76
v_fmac_f32 v29, v29, v77
v_mfma_f32_16x16x32_bf16 v[40:43], a[32:35], v[200:203], v[40:43]
v_fma_f32 v30, v30, v75, v66
v_fma_f32 v31, v31, v75, v67
v_mfma_f32_16x16x32_bf16 v[44:47], a[32:35], v[204:207], v[44:47]
v_exp_f32 v76, v30
v_mfma_f32_16x16x32_bf16 v[44:47], a[28:31], v[188:191], v[44:47]
v_exp_f32 v77, v31
v_mfma_f32_16x16x32_bf16 v[44:47], a[24:27], v[172:175], v[44:47]
s_waitcnt vmcnt(25)
global_load_dwordx4 a[24:27], v7, s[30:31] offset:-3072 sc1
v_fma_f32 v76, v76, s56, s56
v_fma_f32 v77, v77, s56, s56
v_mfma_f32_16x16x32_bf16 v[32:35], a[36:39], v[208:211], v[32:35]
v_fma_f32 v76, -v76, v76, -0.5
v_fma_f32 v77, -v77, v77, -0.5
v_mfma_f32_16x16x32_bf16 v[32:35], a[40:43], v[224:227], v[32:35]
v_rcp_f32 v76, v76
v_mfma_f32_16x16x32_bf16 v[32:35], a[44:47], v[240:243], v[32:35]
global_load_dwordx4 a[28:31], v7, s[30:31] offset:-2048 sc1
v_rcp_f32 v77, v77
v_mfma_f32_16x16x32_bf16 v[36:39], a[44:47], v[244:247], v[36:39]
v_fmac_f32 v30, v30, v76
v_fmac_f32 v31, v31, v77
v_mfma_f32_16x16x32_bf16 v[36:39], a[40:43], v[228:231], v[36:39]
v_cvt_pk_bf16_f32 v80, v28, v29
v_cvt_pk_bf16_f32 v81, v30, v31
v_mfma_f32_16x16x32_bf16 v[36:39], a[36:39], v[212:215], v[36:39]
global_load_dwordx4 a[32:35], v7, s[30:31] offset:-1024 sc1
ds_write_b64 v82, v[80:81] offset:19456
v_mfma_f32_16x16x32_bf16 v[40:43], a[36:39], v[216:219], v[40:43]
s_waitcnt vmcnt(16)
v_fma_f32 v32, v32, v72, v68
v_fma_f32 v33, v33, v72, v69
v_mfma_f32_16x16x32_bf16 v[40:43], a[40:43], v[232:235], v[40:43]
v_exp_f32 v76, v32
v_mfma_f32_16x16x32_bf16 v[40:43], a[44:47], v[248:251], v[40:43]
v_exp_f32 v77, v33
v_mfma_f32_16x16x32_bf16 v[44:47], a[44:47], v[252:255], v[44:47]
v_fma_f32 v76, v76, s56, s56
v_fma_f32 v77, v77, s56, s56
v_mfma_f32_16x16x32_bf16 v[44:47], a[40:43], v[236:239], v[44:47]
v_fma_f32 v76, -v76, v76, -0.5
v_fma_f32 v77, -v77, v77, -0.5
v_mfma_f32_16x16x32_bf16 v[44:47], a[36:39], v[220:223], v[44:47]
global_load_dwordx4 a[36:39], v7, s[30:31] offset:0 sc1
v_rcp_f32 v76, v76
v_mfma_f32_16x16x32_bf16 v[16:19], a[48:51], a[120:123], 0
v_rcp_f32 v77, v77
v_mfma_f32_16x16x32_bf16 v[16:19], a[52:55], a[136:139], v[16:19]
v_fmac_f32 v32, v32, v76
v_fmac_f32 v33, v33, v77
v_mfma_f32_16x16x32_bf16 v[16:19], a[56:59], a[152:155], v[16:19]
global_load_dwordx4 a[40:43], v7, s[30:31] offset:1024 sc1
v_fma_f32 v34, v34, v72, v70
v_fma_f32 v35, v35, v72, v71
v_mfma_f32_16x16x32_bf16 v[20:23], a[56:59], a[156:159], 0
v_exp_f32 v76, v34
v_mfma_f32_16x16x32_bf16 v[20:23], a[52:55], a[140:143], v[20:23]
global_load_dwordx4 v[64:67], v13, s[12:13] sc1
v_exp_f32 v77, v35
v_mfma_f32_16x16x32_bf16 v[20:23], a[48:51], a[124:127], v[20:23]
global_load_dwordx4 a[44:47], v7, s[30:31] offset:2048 sc1
v_fma_f32 v76, v76, s56, s56
v_fma_f32 v77, v77, s56, s56
v_mfma_f32_16x16x32_bf16 v[24:27], a[48:51], a[128:131], 0
s_add_u32 s30, s30, 0x1800
v_fma_f32 v76, -v76, v76, -0.5
v_fma_f32 v77, -v77, v77, -0.5
v_mfma_f32_16x16x32_bf16 v[24:27], a[52:55], a[144:147], v[24:27]
s_addc_u32 s31, s31, 0
v_rcp_f32 v76, v76
v_mfma_f32_16x16x32_bf16 v[24:27], a[56:59], a[160:163], v[24:27]
v_rcp_f32 v77, v77
v_mfma_f32_16x16x32_bf16 v[28:31], a[56:59], a[164:167], 0
v_fmac_f32 v34, v34, v76
v_fmac_f32 v35, v35, v77
v_mfma_f32_16x16x32_bf16 v[28:31], a[52:55], a[148:151], v[28:31]
v_cvt_pk_bf16_f32 v78, v32, v33
v_cvt_pk_bf16_f32 v79, v34, v35
v_add_u32 v82, s15, v11
v_mfma_f32_16x16x32_bf16 v[28:31], a[48:51], a[132:135], v[28:31]
global_load_dwordx4 a[48:51], v7, s[30:31] offset:-3072 sc1
ds_write_b64 v82, v[78:79] offset:24576
v_mfma_f32_16x16x32_bf16 v[16:19], a[60:63], a[168:171], v[16:19]
v_fma_f32 v36, v36, v73, v68
v_fma_f32 v37, v37, v73, v69
v_mfma_f32_16x16x32_bf16 v[16:19], a[64:67], a[184:187], v[16:19]
v_exp_f32 v76, v36
v_mfma_f32_16x16x32_bf16 v[16:19], a[68:71], a[200:203], v[16:19]
global_load_dwordx4 a[52:55], v7, s[30:31] offset:-2048 sc1
v_exp_f32 v77, v37
v_mfma_f32_16x16x32_bf16 v[20:23], a[68:71], a[204:207], v[20:23]
v_fma_f32 v76, v76, s56, s56
v_fma_f32 v77, v77, s56, s56
v_mfma_f32_16x16x32_bf16 v[20:23], a[64:67], a[188:191], v[20:23]
v_fma_f32 v76, -v76, v76, -0.5
v_fma_f32 v77, -v77, v77, -0.5
v_mfma_f32_16x16x32_bf16 v[20:23], a[60:63], a[172:175], v[20:23]
global_load_dwordx4 a[56:59], v7, s[30:31] offset:-1024 sc1
v_rcp_f32 v76, v76
v_mfma_f32_16x16x32_bf16 v[24:27], a[60:63], a[176:179], v[24:27]
v_rcp_f32 v77, v77
v_mfma_f32_16x16x32_bf16 v[24:27], a[64:67], a[192:195], v[24:27]
v_fmac_f32 v36, v36, v76
v_fmac_f32 v37, v37, v77
v_mfma_f32_16x16x32_bf16 v[24:27], a[68:71], a[208:211], v[24:27]
v_fma_f32 v38, v38, v73, v70
v_fma_f32 v39, v39, v73, v71
v_mfma_f32_16x16x32_bf16 v[28:31], a[68:71], a[212:215], v[28:31]
v_exp_f32 v76, v38
v_mfma_f32_16x16x32_bf16 v[28:31], a[64:67], a[196:199], v[28:31]
v_exp_f32 v77, v39
v_mfma_f32_16x16x32_bf16 v[28:31], a[60:63], a[180:183], v[28:31]
global_load_dwordx4 a[60:63], v7, s[30:31] offset:0 sc1
v_fma_f32 v76, v76, s56, s56
v_fma_f32 v77, v77, s56, s56
v_mfma_f32_16x16x32_bf16 v[16:19], a[72:75], a[216:219], v[16:19]
v_fma_f32 v76, -v76, v76, -0.5
v_fma_f32 v77, -v77, v77, -0.5
v_mfma_f32_16x16x32_bf16 v[16:19], a[76:79], a[232:235], v[16:19]
v_rcp_f32 v76, v76
v_mfma_f32_16x16x32_bf16 v[16:19], a[80:83], a[248:251], v[16:19]
global_load_dwordx4 a[64:67], v7, s[30:31] offset:1024 sc1
v_rcp_f32 v77, v77
v_mfma_f32_16x16x32_bf16 v[20:23], a[80:83], a[252:255], v[20:23]
v_fmac_f32 v38, v38, v76
v_fmac_f32 v39, v39, v77
v_mfma_f32_16x16x32_bf16 v[20:23], a[76:79], a[236:239], v[20:23]
v_cvt_pk_bf16_f32 v80, v36, v37
v_cvt_pk_bf16_f32 v81, v38, v39
v_mfma_f32_16x16x32_bf16 v[20:23], a[72:75], a[220:223], v[20:23]
global_load_dwordx4 a[68:71], v7, s[30:31] offset:2048 sc1
ds_write_b64 v82, v[80:81] offset:25600
v_mfma_f32_16x16x32_bf16 v[24:27], a[72:75], a[224:227], v[24:27]
s_cmp_eq_u32 s8, 6
v_fma_f32 v40, v40, v74, v68
v_fma_f32 v41, v41, v74, v69
v_mfma_f32_16x16x32_bf16 v[24:27], a[76:79], a[240:243], v[24:27]
s_cselect_b32 s6, 7, 6
v_exp_f32 v76, v40
v_mfma_f32_16x16x32_bf16 v[24:27], a[80:83], v[104:107], v[24:27]
s_cmp_eq_u32 s8, 5
v_exp_f32 v77, v41
v_mfma_f32_16x16x32_bf16 v[28:31], a[80:83], v[108:111], v[28:31]
s_cselect_b32 s6, 5, s6
v_fma_f32 v76, v76, s56, s56
v_fma_f32 v77, v77, s56, s56
v_mfma_f32_16x16x32_bf16 v[28:31], a[76:79], a[244:247], v[28:31]
s_mul_i32 s6, s6, 18432
v_fma_f32 v76, -v76, v76, -0.5
v_fma_f32 v77, -v77, v77, -0.5
v_mfma_f32_16x16x32_bf16 v[28:31], a[72:75], a[228:231], v[28:31]
s_add_u32 s30, s10, s6
v_rcp_f32 v76, v76
v_mfma_f32_16x16x32_bf16 v[16:19], a[84:87], v[112:115], v[16:19]
s_addc_u32 s31, s11, 0
global_load_dwordx4 a[72:75], v7, s[30:31] offset:-3072 sc1
v_rcp_f32 v77, v77
v_mfma_f32_16x16x32_bf16 v[16:19], a[88:91], v[128:131], v[16:19]
s_waitcnt vmcnt(26)
v_fmac_f32 v40, v40, v76
v_fmac_f32 v41, v41, v77
v_mfma_f32_16x16x32_bf16 v[16:19], a[92:95], v[144:147], v[16:19]
s_cmp_eq_u32 s8, 5
v_fma_f32 v42, v42, v74, v70
v_fma_f32 v43, v43, v74, v71
v_mfma_f32_16x16x32_bf16 v[20:23], a[92:95], v[148:151], v[20:23]
s_cselect_b32 s7, 6, 5
global_load_dwordx4 a[76:79], v7, s[30:31] offset:-2048 sc1
v_exp_f32 v76, v42
v_mfma_f32_16x16x32_bf16 v[20:23], a[88:91], v[132:135], v[20:23]
s_cmp_eq_u32 s8, 4
v_exp_f32 v77, v43
v_mfma_f32_16x16x32_bf16 v[20:23], a[84:87], v[116:119], v[20:23]
s_cselect_b32 s7, 4, s7
v_fma_f32 v76, v76, s56, s56
v_fma_f32 v77, v77, s56, s56
v_mfma_f32_16x16x32_bf16 v[24:27], a[84:87], v[120:123], v[24:27]
s_sub_u32 s15, s7, 5
global_load_dwordx4 a[80:83], v7, s[30:31] offset:-1024 sc1
v_fma_f32 v76, -v76, v76, -0.5
v_fma_f32 v77, -v77, v77, -0.5
v_mfma_f32_16x16x32_bf16 v[24:27], a[88:91], v[136:139], v[24:27]
s_lshl_b32 s15, s15, 13
v_rcp_f32 v76, v76
v_mfma_f32_16x16x32_bf16 v[24:27], a[92:95], v[152:155], v[24:27]
s_lshl_b32 s7, s7, 8
v_rcp_f32 v77, v77
v_mfma_f32_16x16x32_bf16 v[28:31], a[92:95], v[156:159], v[28:31]
s_add_u32 s12, s22, s7
v_fmac_f32 v42, v42, v76
v_fmac_f32 v43, v43, v77
v_mfma_f32_16x16x32_bf16 v[28:31], a[88:91], v[140:143], v[28:31]
s_addc_u32 s13, s23, 0
v_cvt_pk_bf16_f32 v78, v40, v41
v_cvt_pk_bf16_f32 v79, v42, v43
v_mfma_f32_16x16x32_bf16 v[28:31], a[84:87], v[124:127], v[28:31]
s_waitcnt vmcnt(25)
global_load_dwordx4 a[84:87], v7, s[30:31] offset:0 sc1
ds_write_b64 v82, v[78:79] offset:26624
v_mfma_f32_16x16x32_bf16 v[16:19], a[96:99], v[160:163], v[16:19]
v_fma_f32 v44, v44, v75, v68
v_fma_f32 v45, v45, v75, v69
v_mfma_f32_16x16x32_bf16 v[16:19], a[100:103], v[176:179], v[16:19]
v_exp_f32 v76, v44
v_mfma_f32_16x16x32_bf16 v[16:19], a[104:107], v[192:195], v[16:19]
global_load_dwordx4 a[88:91], v7, s[30:31] offset:1024 sc1
v_exp_f32 v77, v45
v_mfma_f32_16x16x32_bf16 v[20:23], a[104:107], v[196:199], v[20:23]
v_fma_f32 v76, v76, s56, s56
v_fma_f32 v77, v77, s56, s56
v_mfma_f32_16x16x32_bf16 v[20:23], a[100:103], v[180:183], v[20:23]
v_fma_f32 v76, -v76, v76, -0.5
v_fma_f32 v77, -v77, v77, -0.5
v_mfma_f32_16x16x32_bf16 v[20:23], a[96:99], v[164:167], v[20:23]
global_load_dwordx4 a[92:95], v7, s[30:31] offset:2048 sc1
v_rcp_f32 v76, v76
v_mfma_f32_16x16x32_bf16 v[24:27], a[96:99], v[168:171], v[24:27]
s_add_u32 s30, s30, 0x1800
v_rcp_f32 v77, v77
v_mfma_f32_16x16x32_bf16 v[24:27], a[100:103], v[184:187], v[24:27]
s_addc_u32 s31, s31, 0
v_fmac_f32 v44, v44, v76
v_fmac_f32 v45, v45, v77
v_mfma_f32_16x16x32_bf16 v[24:27], a[104:107], v[200:203], v[24:27]
v_fma_f32 v46, v46, v75, v70
v_fma_f32 v47, v47, v75, v71
v_mfma_f32_16x16x32_bf16 v[28:31], a[104:107], v[204:207], v[28:31]
v_exp_f32 v76, v46
v_mfma_f32_16x16x32_bf16 v[28:31], a[100:103], v[188:191], v[28:31]
v_exp_f32 v77, v47
v_mfma_f32_16x16x32_bf16 v[28:31], a[96:99], v[172:175], v[28:31]
s_waitcnt vmcnt(25)
global_load_dwordx4 a[96:99], v7, s[30:31] offset:-3072 sc1
v_fma_f32 v76, v76, s56, s56
v_fma_f32 v77, v77, s56, s56
v_mfma_f32_16x16x32_bf16 v[16:19], a[108:111], v[208:211], v[16:19]
v_fma_f32 v76, -v76, v76, -0.5
v_fma_f32 v77, -v77, v77, -0.5
v_mfma_f32_16x16x32_bf16 v[16:19], a[112:115], v[224:227], v[16:19]
v_rcp_f32 v76, v76
v_mfma_f32_16x16x32_bf16 v[16:19], a[116:119], v[240:243], v[16:19]
global_load_dwordx4 a[100:103], v7, s[30:31] offset:-2048 sc1
v_rcp_f32 v77, v77
v_mfma_f32_16x16x32_bf16 v[20:23], a[116:119], v[244:247], v[20:23]
v_fmac_f32 v46, v46, v76
v_fmac_f32 v47, v47, v77
v_mfma_f32_16x16x32_bf16 v[20:23], a[112:115], v[228:231], v[20:23]
v_cvt_pk_bf16_f32 v80, v44, v45
v_cvt_pk_bf16_f32 v81, v46, v47
v_mfma_f32_16x16x32_bf16 v[20:23], a[108:111], v[212:215], v[20:23]
global_load_dwordx4 a[104:107], v7, s[30:31] offset:-1024 sc1
ds_write_b64 v82, v[80:81] offset:27648
v_mfma_f32_16x16x32_bf16 v[24:27], a[108:111], v[216:219], v[24:27]
s_waitcnt vmcnt(16)
v_fma_f32 v16, v16, v72, v64
v_fma_f32 v17, v17, v72, v65
v_mfma_f32_16x16x32_bf16 v[24:27], a[112:115], v[232:235], v[24:27]
v_exp_f32 v76, v16
v_mfma_f32_16x16x32_bf16 v[24:27], a[116:119], v[248:251], v[24:27]
v_exp_f32 v77, v17
v_mfma_f32_16x16x32_bf16 v[28:31], a[116:119], v[252:255], v[28:31]
v_fma_f32 v76, v76, s56, s56
v_fma_f32 v77, v77, s56, s56
v_mfma_f32_16x16x32_bf16 v[28:31], a[112:115], v[236:239], v[28:31]
v_fma_f32 v76, -v76, v76, -0.5
v_fma_f32 v77, -v77, v77, -0.5
v_mfma_f32_16x16x32_bf16 v[28:31], a[108:111], v[220:223], v[28:31]
global_load_dwordx4 a[108:111], v7, s[30:31] offset:0 sc1
v_rcp_f32 v76, v76
v_mfma_f32_16x16x32_bf16 v[32:35], a[0:3], a[120:123], 0
v_rcp_f32 v77, v77
v_mfma_f32_16x16x32_bf16 v[32:35], a[4:7], a[136:139], v[32:35]
v_fmac_f32 v16, v16, v76
v_fmac_f32 v17, v17, v77
v_mfma_f32_16x16x32_bf16 v[32:35], a[8:11], a[152:155], v[32:35]
global_load_dwordx4 a[112:115], v7, s[30:31] offset:1024 sc1
v_fma_f32 v18, v18, v72, v66
v_fma_f32 v19, v19, v72, v67
v_mfma_f32_16x16x32_bf16 v[36:39], a[8:11], a[156:159], 0
v_exp_f32 v76, v18
v_mfma_f32_16x16x32_bf16 v[36:39], a[4:7], a[140:143], v[36:39]
global_load_dwordx4 v[68:71], v13, s[12:13] sc1
v_exp_f32 v77, v19
v_mfma_f32_16x16x32_bf16 v[36:39], a[0:3], a[124:127], v[36:39]
global_load_dwordx4 a[116:119], v7, s[30:31] offset:2048 sc1
v_fma_f32 v76, v76, s56, s56
v_fma_f32 v77, v77, s56, s56
v_mfma_f32_16x16x32_bf16 v[40:43], a[0:3], a[128:131], 0
s_add_u32 s30, s30, 0x1800
v_fma_f32 v76, -v76, v76, -0.5
v_fma_f32 v77, -v77, v77, -0.5
v_mfma_f32_16x16x32_bf16 v[40:43], a[4:7], a[144:147], v[40:43]
s_addc_u32 s31, s31, 0
v_rcp_f32 v76, v76
v_mfma_f32_16x16x32_bf16 v[40:43], a[8:11], a[160:163], v[40:43]
v_rcp_f32 v77, v77
v_mfma_f32_16x16x32_bf16 v[44:47], a[8:11], a[164:167], 0
v_fmac_f32 v18, v18, v76
v_fmac_f32 v19, v19, v77
v_mfma_f32_16x16x32_bf16 v[44:47], a[4:7], a[148:151], v[44:47]
v_cvt_pk_bf16_f32 v78, v16, v17
v_cvt_pk_bf16_f32 v79, v18, v19
v_add_u32 v82, s14, v12
v_mfma_f32_16x16x32_bf16 v[44:47], a[0:3], a[132:135], v[44:47]
global_load_dwordx4 a[0:3], v7, s[30:31] offset:-3072 sc1
ds_write_b64 v82, v[78:79] offset:0
v_mfma_f32_16x16x32_bf16 v[32:35], a[12:15], a[168:171], v[32:35]
v_fma_f32 v20, v20, v73, v64
v_fma_f32 v21, v21, v73, v65
v_mfma_f32_16x16x32_bf16 v[32:35], a[16:19], a[184:187], v[32:35]
v_exp_f32 v76, v20
v_mfma_f32_16x16x32_bf16 v[32:35], a[20:23], a[200:203], v[32:35]
global_load_dwordx4 a[4:7], v7, s[30:31] offset:-2048 sc1
v_exp_f32 v77, v21
v_mfma_f32_16x16x32_bf16 v[36:39], a[20:23], a[204:207], v[36:39]
v_fma_f32 v76, v76, s56, s56
v_fma_f32 v77, v77, s56, s56
v_mfma_f32_16x16x32_bf16 v[36:39], a[16:19], a[188:191], v[36:39]
v_fma_f32 v76, -v76, v76, -0.5
v_fma_f32 v77, -v77, v77, -0.5
v_mfma_f32_16x16x32_bf16 v[36:39], a[12:15], a[172:175], v[36:39]
global_load_dwordx4 a[8:11], v7, s[30:31] offset:-1024 sc1
v_rcp_f32 v76, v76
v_mfma_f32_16x16x32_bf16 v[40:43], a[12:15], a[176:179], v[40:43]
v_rcp_f32 v77, v77
v_mfma_f32_16x16x32_bf16 v[40:43], a[16:19], a[192:195], v[40:43]
v_fmac_f32 v20, v20, v76
v_fmac_f32 v21, v21, v77
v_mfma_f32_16x16x32_bf16 v[40:43], a[20:23], a[208:211], v[40:43]
v_fma_f32 v22, v22, v73, v66
v_fma_f32 v23, v23, v73, v67
v_mfma_f32_16x16x32_bf16 v[44:47], a[20:23], a[212:215], v[44:47]
v_exp_f32 v76, v22
v_mfma_f32_16x16x32_bf16 v[44:47], a[16:19], a[196:199], v[44:47]
v_exp_f32 v77, v23
v_mfma_f32_16x16x32_bf16 v[44:47], a[12:15], a[180:183], v[44:47]
global_load_dwordx4 a[12:15], v7, s[30:31] offset:0 sc1
v_fma_f32 v76, v76, s56, s56
v_fma_f32 v77, v77, s56, s56
v_mfma_f32_16x16x32_bf16 v[32:35], a[24:27], a[216:219], v[32:35]
v_fma_f32 v76, -v76, v76, -0.5
v_fma_f32 v77, -v77, v77, -0.5
v_mfma_f32_16x16x32_bf16 v[32:35], a[28:31], a[232:235], v[32:35]
v_rcp_f32 v76, v76
v_mfma_f32_16x16x32_bf16 v[32:35], a[32:35], a[248:251], v[32:35]
global_load_dwordx4 a[16:19], v7, s[30:31] offset:1024 sc1
v_rcp_f32 v77, v77
v_mfma_f32_16x16x32_bf16 v[36:39], a[32:35], a[252:255], v[36:39]
v_fmac_f32 v22, v22, v76
v_fmac_f32 v23, v23, v77
v_mfma_f32_16x16x32_bf16 v[36:39], a[28:31], a[236:239], v[36:39]
v_cvt_pk_bf16_f32 v80, v20, v21
v_cvt_pk_bf16_f32 v81, v22, v23
v_mfma_f32_16x16x32_bf16 v[36:39], a[24:27], a[220:223], v[36:39]
global_load_dwordx4 a[20:23], v7, s[30:31] offset:2048 sc1
ds_write_b64 v82, v[80:81] offset:1024
v_mfma_f32_16x16x32_bf16 v[40:43], a[24:27], a[224:227], v[40:43]
s_cmp_eq_u32 s8, 7
v_fma_f32 v24, v24, v74, v64
v_fma_f32 v25, v25, v74, v65
v_mfma_f32_16x16x32_bf16 v[40:43], a[28:31], a[240:243], v[40:43]
s_cselect_b32 s6, 8, 7
v_exp_f32 v76, v24
v_mfma_f32_16x16x32_bf16 v[40:43], a[32:35], v[104:107], v[40:43]
s_cmp_eq_u32 s8, 6
v_exp_f32 v77, v25
v_mfma_f32_16x16x32_bf16 v[44:47], a[32:35], v[108:111], v[44:47]
s_cselect_b32 s6, 6, s6
v_fma_f32 v76, v76, s56, s56
v_fma_f32 v77, v77, s56, s56
v_mfma_f32_16x16x32_bf16 v[44:47], a[28:31], a[244:247], v[44:47]
s_mul_i32 s6, s6, 18432
v_fma_f32 v76, -v76, v76, -0.5
v_fma_f32 v77, -v77, v77, -0.5
v_mfma_f32_16x16x32_bf16 v[44:47], a[24:27], a[228:231], v[44:47]
s_add_u32 s30, s10, s6
v_rcp_f32 v76, v76
v_mfma_f32_16x16x32_bf16 v[32:35], a[36:39], v[112:115], v[32:35]
s_addc_u32 s31, s11, 0
global_load_dwordx4 a[24:27], v7, s[30:31] offset:-3072 sc1
v_rcp_f32 v77, v77
v_mfma_f32_16x16x32_bf16 v[32:35], a[40:43], v[128:131], v[32:35]
s_waitcnt vmcnt(26)
v_fmac_f32 v24, v24, v76
v_fmac_f32 v25, v25, v77
v_mfma_f32_16x16x32_bf16 v[32:35], a[44:47], v[144:147], v[32:35]
s_cmp_eq_u32 s8, 6
v_fma_f32 v26, v26, v74, v66
v_fma_f32 v27, v27, v74, v67
v_mfma_f32_16x16x32_bf16 v[36:39], a[44:47], v[148:151], v[36:39]
s_cselect_b32 s7, 7, 6
global_load_dwordx4 a[28:31], v7, s[30:31] offset:-2048 sc1
v_exp_f32 v76, v26
v_mfma_f32_16x16x32_bf16 v[36:39], a[40:43], v[132:135], v[36:39]
s_cmp_eq_u32 s8, 5
v_exp_f32 v77, v27
v_mfma_f32_16x16x32_bf16 v[36:39], a[36:39], v[116:119], v[36:39]
s_cselect_b32 s7, 5, s7
v_fma_f32 v76, v76, s56, s56
v_fma_f32 v77, v77, s56, s56
v_mfma_f32_16x16x32_bf16 v[40:43], a[36:39], v[120:123], v[40:43]
s_sub_u32 s14, s7, 6
global_load_dwordx4 a[32:35], v7, s[30:31] offset:-1024 sc1
v_fma_f32 v76, -v76, v76, -0.5
v_fma_f32 v77, -v77, v77, -0.5
v_mfma_f32_16x16x32_bf16 v[40:43], a[40:43], v[136:139], v[40:43]
s_lshl_b32 s14, s14, 13
v_rcp_f32 v76, v76
v_mfma_f32_16x16x32_bf16 v[40:43], a[44:47], v[152:155], v[40:43]
s_lshl_b32 s7, s7, 8
v_rcp_f32 v77, v77
v_mfma_f32_16x16x32_bf16 v[44:47], a[44:47], v[156:159], v[44:47]
s_add_u32 s12, s22, s7
v_fmac_f32 v26, v26, v76
v_fmac_f32 v27, v27, v77
v_mfma_f32_16x16x32_bf16 v[44:47], a[40:43], v[140:143], v[44:47]
s_addc_u32 s13, s23, 0
v_cvt_pk_bf16_f32 v78, v24, v25
v_cvt_pk_bf16_f32 v79, v26, v27
v_mfma_f32_16x16x32_bf16 v[44:47], a[36:39], v[124:127], v[44:47]
s_waitcnt vmcnt(25)
global_load_dwordx4 a[36:39], v7, s[30:31] offset:0 sc1
ds_write_b64 v82, v[78:79] offset:2048
v_mfma_f32_16x16x32_bf16 v[32:35], a[48:51], v[160:163], v[32:35]
v_fma_f32 v28, v28, v75, v64
v_fma_f32 v29, v29, v75, v65
v_mfma_f32_16x16x32_bf16 v[32:35], a[52:55], v[176:179], v[32:35]
v_exp_f32 v76, v28
v_mfma_f32_16x16x32_bf16 v[32:35], a[56:59], v[192:195], v[32:35]
global_load_dwordx4 a[40:43], v7, s[30:31] offset:1024 sc1
v_exp_f32 v77, v29
v_mfma_f32_16x16x32_bf16 v[36:39], a[56:59], v[196:199], v[36:39]
v_fma_f32 v76, v76, s56, s56
v_fma_f32 v77, v77, s56, s56
v_mfma_f32_16x16x32_bf16 v[36:39], a[52:55], v[180:183], v[36:39]
v_fma_f32 v76, -v76, v76, -0.5
v_fma_f32 v77, -v77, v77, -0.5
v_mfma_f32_16x16x32_bf16 v[36:39], a[48:51], v[164:167], v[36:39]
global_load_dwordx4 a[44:47], v7, s[30:31] offset:2048 sc1
v_rcp_f32 v76, v76
v_mfma_f32_16x16x32_bf16 v[40:43], a[48:51], v[168:171], v[40:43]
s_add_u32 s30, s30, 0x1800
v_rcp_f32 v77, v77
v_mfma_f32_16x16x32_bf16 v[40:43], a[52:55], v[184:187], v[40:43]
s_addc_u32 s31, s31, 0
v_fmac_f32 v28, v28, v76
v_fmac_f32 v29, v29, v77
v_mfma_f32_16x16x32_bf16 v[40:43], a[56:59], v[200:203], v[40:43]
v_fma_f32 v30, v30, v75, v66
v_fma_f32 v31, v31, v75, v67
v_mfma_f32_16x16x32_bf16 v[44:47], a[56:59], v[204:207], v[44:47]
v_exp_f32 v76, v30
v_mfma_f32_16x16x32_bf16 v[44:47], a[52:55], v[188:191], v[44:47]
v_exp_f32 v77, v31
v_mfma_f32_16x16x32_bf16 v[44:47], a[48:51], v[172:175], v[44:47]
s_waitcnt vmcnt(25)
global_load_dwordx4 a[48:51], v7, s[30:31] offset:-3072 sc1
v_fma_f32 v76, v76, s56, s56
v_fma_f32 v77, v77, s56, s56
v_mfma_f32_16x16x32_bf16 v[32:35], a[60:63], v[208:211], v[32:35]
v_fma_f32 v76, -v76, v76, -0.5
v_fma_f32 v77, -v77, v77, -0.5
v_mfma_f32_16x16x32_bf16 v[32:35], a[64:67], v[224:227], v[32:35]
v_rcp_f32 v76, v76
v_mfma_f32_16x16x32_bf16 v[32:35], a[68:71], v[240:243], v[32:35]
global_load_dwordx4 a[52:55], v7, s[30:31] offset:-2048 sc1
v_rcp_f32 v77, v77
v_mfma_f32_16x16x32_bf16 v[36:39], a[68:71], v[244:247], v[36:39]
v_fmac_f32 v30, v30, v76
v_fmac_f32 v31, v31, v77
v_mfma_f32_16x16x32_bf16 v[36:39], a[64:67], v[228:231], v[36:39]
v_cvt_pk_bf16_f32 v80, v28, v29
v_cvt_pk_bf16_f32 v81, v30, v31
v_mfma_f32_16x16x32_bf16 v[36:39], a[60:63], v[212:215], v[36:39]
global_load_dwordx4 a[56:59], v7, s[30:31] offset:-1024 sc1
ds_write_b64 v82, v[80:81] offset:3072
v_mfma_f32_16x16x32_bf16 v[40:43], a[60:63], v[216:219], v[40:43]
s_waitcnt vmcnt(16)
v_fma_f32 v32, v32, v72, v68
v_fma_f32 v33, v33, v72, v69
v_mfma_f32_16x16x32_bf16 v[40:43], a[64:67], v[232:235], v[40:43]
v_exp_f32 v76, v32
v_mfma_f32_16x16x32_bf16 v[40:43], a[68:71], v[248:251], v[40:43]
v_exp_f32 v77, v33
v_mfma_f32_16x16x32_bf16 v[44:47], a[68:71], v[252:255], v[44:47]
v_fma_f32 v76, v76, s56, s56
v_fma_f32 v77, v77, s56, s56
v_mfma_f32_16x16x32_bf16 v[44:47], a[64:67], v[236:239], v[44:47]
v_fma_f32 v76, -v76, v76, -0.5
v_fma_f32 v77, -v77, v77, -0.5
v_mfma_f32_16x16x32_bf16 v[44:47], a[60:63], v[220:223], v[44:47]
global_load_dwordx4 a[60:63], v7, s[30:31] offset:0 sc1
v_rcp_f32 v76, v76
v_mfma_f32_16x16x32_bf16 v[16:19], a[72:75], a[120:123], 0
v_rcp_f32 v77, v77
v_mfma_f32_16x16x32_bf16 v[16:19], a[76:79], a[136:139], v[16:19]
v_fmac_f32 v32, v32, v76
v_fmac_f32 v33, v33, v77
v_mfma_f32_16x16x32_bf16 v[16:19], a[80:83], a[152:155], v[16:19]
global_load_dwordx4 a[64:67], v7, s[30:31] offset:1024 sc1
v_fma_f32 v34, v34, v72, v70
v_fma_f32 v35, v35, v72, v71
v_mfma_f32_16x16x32_bf16 v[20:23], a[80:83], a[156:159], 0
v_exp_f32 v76, v34
v_mfma_f32_16x16x32_bf16 v[20:23], a[76:79], a[140:143], v[20:23]
global_load_dwordx4 v[64:67], v13, s[12:13] sc1
v_exp_f32 v77, v35
v_mfma_f32_16x16x32_bf16 v[20:23], a[72:75], a[124:127], v[20:23]
global_load_dwordx4 a[68:71], v7, s[30:31] offset:2048 sc1
v_fma_f32 v76, v76, s56, s56
v_fma_f32 v77, v77, s56, s56
v_mfma_f32_16x16x32_bf16 v[24:27], a[72:75], a[128:131], 0
s_add_u32 s30, s30, 0x1800
v_fma_f32 v76, -v76, v76, -0.5
v_fma_f32 v77, -v77, v77, -0.5
v_mfma_f32_16x16x32_bf16 v[24:27], a[76:79], a[144:147], v[24:27]
s_addc_u32 s31, s31, 0
v_rcp_f32 v76, v76
v_mfma_f32_16x16x32_bf16 v[24:27], a[80:83], a[160:163], v[24:27]
v_rcp_f32 v77, v77
v_mfma_f32_16x16x32_bf16 v[28:31], a[80:83], a[164:167], 0
v_fmac_f32 v34, v34, v76
v_fmac_f32 v35, v35, v77
v_mfma_f32_16x16x32_bf16 v[28:31], a[76:79], a[148:151], v[28:31]
v_cvt_pk_bf16_f32 v78, v32, v33
v_cvt_pk_bf16_f32 v79, v34, v35
v_add_u32 v82, s15, v12
v_mfma_f32_16x16x32_bf16 v[28:31], a[72:75], a[132:135], v[28:31]
global_load_dwordx4 a[72:75], v7, s[30:31] offset:-3072 sc1
ds_write_b64 v82, v[78:79] offset:8192
v_mfma_f32_16x16x32_bf16 v[16:19], a[84:87], a[168:171], v[16:19]
v_fma_f32 v36, v36, v73, v68
v_fma_f32 v37, v37, v73, v69
v_mfma_f32_16x16x32_bf16 v[16:19], a[88:91], a[184:187], v[16:19]
v_exp_f32 v76, v36
v_mfma_f32_16x16x32_bf16 v[16:19], a[92:95], a[200:203], v[16:19]
global_load_dwordx4 a[76:79], v7, s[30:31] offset:-2048 sc1
v_exp_f32 v77, v37
v_mfma_f32_16x16x32_bf16 v[20:23], a[92:95], a[204:207], v[20:23]
v_fma_f32 v76, v76, s56, s56
v_fma_f32 v77, v77, s56, s56
v_mfma_f32_16x16x32_bf16 v[20:23], a[88:91], a[188:191], v[20:23]
v_fma_f32 v76, -v76, v76, -0.5
v_fma_f32 v77, -v77, v77, -0.5
v_mfma_f32_16x16x32_bf16 v[20:23], a[84:87], a[172:175], v[20:23]
global_load_dwordx4 a[80:83], v7, s[30:31] offset:-1024 sc1
v_rcp_f32 v76, v76
v_mfma_f32_16x16x32_bf16 v[24:27], a[84:87], a[176:179], v[24:27]
v_rcp_f32 v77, v77
v_mfma_f32_16x16x32_bf16 v[24:27], a[88:91], a[192:195], v[24:27]
v_fmac_f32 v36, v36, v76
v_fmac_f32 v37, v37, v77
v_mfma_f32_16x16x32_bf16 v[24:27], a[92:95], a[208:211], v[24:27]
v_fma_f32 v38, v38, v73, v70
v_fma_f32 v39, v39, v73, v71
v_mfma_f32_16x16x32_bf16 v[28:31], a[92:95], a[212:215], v[28:31]
v_exp_f32 v76, v38
v_mfma_f32_16x16x32_bf16 v[28:31], a[88:91], a[196:199], v[28:31]
v_exp_f32 v77, v39
v_mfma_f32_16x16x32_bf16 v[28:31], a[84:87], a[180:183], v[28:31]
global_load_dwordx4 a[84:87], v7, s[30:31] offset:0 sc1
v_fma_f32 v76, v76, s56, s56
v_fma_f32 v77, v77, s56, s56
v_mfma_f32_16x16x32_bf16 v[16:19], a[96:99], a[216:219], v[16:19]
v_fma_f32 v76, -v76, v76, -0.5
v_fma_f32 v77, -v77, v77, -0.5
v_mfma_f32_16x16x32_bf16 v[16:19], a[100:103], a[232:235], v[16:19]
v_rcp_f32 v76, v76
v_mfma_f32_16x16x32_bf16 v[16:19], a[104:107], a[248:251], v[16:19]
global_load_dwordx4 a[88:91], v7, s[30:31] offset:1024 sc1
v_rcp_f32 v77, v77
v_mfma_f32_16x16x32_bf16 v[20:23], a[104:107], a[252:255], v[20:23]
v_fmac_f32 v38, v38, v76
v_fmac_f32 v39, v39, v77
v_mfma_f32_16x16x32_bf16 v[20:23], a[100:103], a[236:239], v[20:23]
v_cvt_pk_bf16_f32 v80, v36, v37
v_cvt_pk_bf16_f32 v81, v38, v39
v_mfma_f32_16x16x32_bf16 v[20:23], a[96:99], a[220:223], v[20:23]
global_load_dwordx4 a[92:95], v7, s[30:31] offset:2048 sc1
ds_write_b64 v82, v[80:81] offset:9216
v_mfma_f32_16x16x32_bf16 v[24:27], a[96:99], a[224:227], v[24:27]
s_cmp_eq_u32 s8, 8
v_fma_f32 v40, v40, v74, v68
v_fma_f32 v41, v41, v74, v69
v_mfma_f32_16x16x32_bf16 v[24:27], a[100:103], a[240:243], v[24:27]
s_cselect_b32 s6, 9, 8
v_exp_f32 v76, v40
v_mfma_f32_16x16x32_bf16 v[24:27], a[104:107], v[104:107], v[24:27]
s_cmp_eq_u32 s8, 7
v_exp_f32 v77, v41
v_mfma_f32_16x16x32_bf16 v[28:31], a[104:107], v[108:111], v[28:31]
s_cselect_b32 s6, 7, s6
v_fma_f32 v76, v76, s56, s56
v_fma_f32 v77, v77, s56, s56
v_mfma_f32_16x16x32_bf16 v[28:31], a[100:103], a[244:247], v[28:31]
s_mul_i32 s6, s6, 18432
v_fma_f32 v76, -v76, v76, -0.5
v_fma_f32 v77, -v77, v77, -0.5
v_mfma_f32_16x16x32_bf16 v[28:31], a[96:99], a[228:231], v[28:31]
s_add_u32 s30, s10, s6
v_rcp_f32 v76, v76
v_mfma_f32_16x16x32_bf16 v[16:19], a[108:111], v[112:115], v[16:19]
s_addc_u32 s31, s11, 0
global_load_dwordx4 a[96:99], v7, s[30:31] offset:-3072 sc1
v_rcp_f32 v77, v77
v_mfma_f32_16x16x32_bf16 v[16:19], a[112:115], v[128:131], v[16:19]
s_waitcnt vmcnt(26)
v_fmac_f32 v40, v40, v76
v_fmac_f32 v41, v41, v77
v_mfma_f32_16x16x32_bf16 v[16:19], a[116:119], v[144:147], v[16:19]
s_cmp_eq_u32 s8, 7
v_fma_f32 v42, v42, v74, v70
v_fma_f32 v43, v43, v74, v71
v_mfma_f32_16x16x32_bf16 v[20:23], a[116:119], v[148:151], v[20:23]
s_cselect_b32 s7, 8, 7
global_load_dwordx4 a[100:103], v7, s[30:31] offset:-2048 sc1
v_exp_f32 v76, v42
v_mfma_f32_16x16x32_bf16 v[20:23], a[112:115], v[132:135], v[20:23]
s_cmp_eq_u32 s8, 6
v_exp_f32 v77, v43
v_mfma_f32_16x16x32_bf16 v[20:23], a[108:111], v[116:119], v[20:23]
s_cselect_b32 s7, 6, s7
v_fma_f32 v76, v76, s56, s56
v_fma_f32 v77, v77, s56, s56
v_mfma_f32_16x16x32_bf16 v[24:27], a[108:111], v[120:123], v[24:27]
s_sub_u32 s15, s7, 7
global_load_dwordx4 a[104:107], v7, s[30:31] offset:-1024 sc1
v_fma_f32 v76, -v76, v76, -0.5
v_fma_f32 v77, -v77, v77, -0.5
v_mfma_f32_16x16x32_bf16 v[24:27], a[112:115], v[136:139], v[24:27]
s_lshl_b32 s15, s15, 13
v_rcp_f32 v76, v76
v_mfma_f32_16x16x32_bf16 v[24:27], a[116:119], v[152:155], v[24:27]
s_lshl_b32 s7, s7, 8
v_rcp_f32 v77, v77
v_mfma_f32_16x16x32_bf16 v[28:31], a[116:119], v[156:159], v[28:31]
s_add_u32 s12, s22, s7
v_fmac_f32 v42, v42, v76
v_fmac_f32 v43, v43, v77
v_mfma_f32_16x16x32_bf16 v[28:31], a[112:115], v[140:143], v[28:31]
s_addc_u32 s13, s23, 0
v_cvt_pk_bf16_f32 v78, v40, v41
v_cvt_pk_bf16_f32 v79, v42, v43
v_mfma_f32_16x16x32_bf16 v[28:31], a[108:111], v[124:127], v[28:31]
s_waitcnt vmcnt(25)
global_load_dwordx4 a[108:111], v7, s[30:31] offset:0 sc1
ds_write_b64 v82, v[78:79] offset:10240
v_mfma_f32_16x16x32_bf16 v[16:19], a[0:3], v[160:163], v[16:19]
v_fma_f32 v44, v44, v75, v68
v_fma_f32 v45, v45, v75, v69
v_mfma_f32_16x16x32_bf16 v[16:19], a[4:7], v[176:179], v[16:19]
v_exp_f32 v76, v44
v_mfma_f32_16x16x32_bf16 v[16:19], a[8:11], v[192:195], v[16:19]
global_load_dwordx4 a[112:115], v7, s[30:31] offset:1024 sc1
v_exp_f32 v77, v45
v_mfma_f32_16x16x32_bf16 v[20:23], a[8:11], v[196:199], v[20:23]
v_fma_f32 v76, v76, s56, s56
v_fma_f32 v77, v77, s56, s56
v_mfma_f32_16x16x32_bf16 v[20:23], a[4:7], v[180:183], v[20:23]
v_fma_f32 v76, -v76, v76, -0.5
v_fma_f32 v77, -v77, v77, -0.5
v_mfma_f32_16x16x32_bf16 v[20:23], a[0:3], v[164:167], v[20:23]
global_load_dwordx4 a[116:119], v7, s[30:31] offset:2048 sc1
v_rcp_f32 v76, v76
v_mfma_f32_16x16x32_bf16 v[24:27], a[0:3], v[168:171], v[24:27]
s_add_u32 s30, s30, 0x1800
v_rcp_f32 v77, v77
v_mfma_f32_16x16x32_bf16 v[24:27], a[4:7], v[184:187], v[24:27]
s_addc_u32 s31, s31, 0
v_fmac_f32 v44, v44, v76
v_fmac_f32 v45, v45, v77
v_mfma_f32_16x16x32_bf16 v[24:27], a[8:11], v[200:203], v[24:27]
v_fma_f32 v46, v46, v75, v70
v_fma_f32 v47, v47, v75, v71
v_mfma_f32_16x16x32_bf16 v[28:31], a[8:11], v[204:207], v[28:31]
v_exp_f32 v76, v46
v_mfma_f32_16x16x32_bf16 v[28:31], a[4:7], v[188:191], v[28:31]
v_exp_f32 v77, v47
v_mfma_f32_16x16x32_bf16 v[28:31], a[0:3], v[172:175], v[28:31]
s_waitcnt vmcnt(25)
global_load_dwordx4 a[0:3], v7, s[30:31] offset:-3072 sc1
v_fma_f32 v76, v76, s56, s56
v_fma_f32 v77, v77, s56, s56
v_mfma_f32_16x16x32_bf16 v[16:19], a[12:15], v[208:211], v[16:19]
v_fma_f32 v76, -v76, v76, -0.5
v_fma_f32 v77, -v77, v77, -0.5
v_mfma_f32_16x16x32_bf16 v[16:19], a[16:19], v[224:227], v[16:19]
v_rcp_f32 v76, v76
v_mfma_f32_16x16x32_bf16 v[16:19], a[20:23], v[240:243], v[16:19]
global_load_dwordx4 a[4:7], v7, s[30:31] offset:-2048 sc1
v_rcp_f32 v77, v77
v_mfma_f32_16x16x32_bf16 v[20:23], a[20:23], v[244:247], v[20:23]
v_fmac_f32 v46, v46, v76
v_fmac_f32 v47, v47, v77
v_mfma_f32_16x16x32_bf16 v[20:23], a[16:19], v[228:231], v[20:23]
v_cvt_pk_bf16_f32 v80, v44, v45
v_cvt_pk_bf16_f32 v81, v46, v47
v_mfma_f32_16x16x32_bf16 v[20:23], a[12:15], v[212:215], v[20:23]
global_load_dwordx4 a[8:11], v7, s[30:31] offset:-1024 sc1
ds_write_b64 v82, v[80:81] offset:11264
v_mfma_f32_16x16x32_bf16 v[24:27], a[12:15], v[216:219], v[24:27]
s_waitcnt vmcnt(16)
v_fma_f32 v16, v16, v72, v64
v_fma_f32 v17, v17, v72, v65
v_mfma_f32_16x16x32_bf16 v[24:27], a[16:19], v[232:235], v[24:27]
v_exp_f32 v76, v16
v_mfma_f32_16x16x32_bf16 v[24:27], a[20:23], v[248:251], v[24:27]
v_exp_f32 v77, v17
v_mfma_f32_16x16x32_bf16 v[28:31], a[20:23], v[252:255], v[28:31]
v_fma_f32 v76, v76, s56, s56
v_fma_f32 v77, v77, s56, s56
v_mfma_f32_16x16x32_bf16 v[28:31], a[16:19], v[236:239], v[28:31]
v_fma_f32 v76, -v76, v76, -0.5
v_fma_f32 v77, -v77, v77, -0.5
v_mfma_f32_16x16x32_bf16 v[28:31], a[12:15], v[220:223], v[28:31]
global_load_dwordx4 a[12:15], v7, s[30:31] offset:0 sc1
v_rcp_f32 v76, v76
v_mfma_f32_16x16x32_bf16 v[32:35], a[24:27], a[120:123], 0
v_rcp_f32 v77, v77
v_mfma_f32_16x16x32_bf16 v[32:35], a[28:31], a[136:139], v[32:35]
v_fmac_f32 v16, v16, v76
v_fmac_f32 v17, v17, v77
v_mfma_f32_16x16x32_bf16 v[32:35], a[32:35], a[152:155], v[32:35]
global_load_dwordx4 a[16:19], v7, s[30:31] offset:1024 sc1
v_fma_f32 v18, v18, v72, v66
v_fma_f32 v19, v19, v72, v67
v_mfma_f32_16x16x32_bf16 v[36:39], a[32:35], a[156:159], 0
v_exp_f32 v76, v18
v_mfma_f32_16x16x32_bf16 v[36:39], a[28:31], a[140:143], v[36:39]
global_load_dwordx4 v[68:71], v13, s[12:13] sc1
v_exp_f32 v77, v19
v_mfma_f32_16x16x32_bf16 v[36:39], a[24:27], a[124:127], v[36:39]
global_load_dwordx4 a[20:23], v7, s[30:31] offset:2048 sc1
v_fma_f32 v76, v76, s56, s56
v_fma_f32 v77, v77, s56, s56
v_mfma_f32_16x16x32_bf16 v[40:43], a[24:27], a[128:131], 0
s_add_u32 s30, s30, 0x1800
v_fma_f32 v76, -v76, v76, -0.5
v_fma_f32 v77, -v77, v77, -0.5
v_mfma_f32_16x16x32_bf16 v[40:43], a[28:31], a[144:147], v[40:43]
s_addc_u32 s31, s31, 0
v_rcp_f32 v76, v76
v_mfma_f32_16x16x32_bf16 v[40:43], a[32:35], a[160:163], v[40:43]
v_rcp_f32 v77, v77
v_mfma_f32_16x16x32_bf16 v[44:47], a[32:35], a[164:167], 0
v_fmac_f32 v18, v18, v76
v_fmac_f32 v19, v19, v77
v_mfma_f32_16x16x32_bf16 v[44:47], a[28:31], a[148:151], v[44:47]
v_cvt_pk_bf16_f32 v78, v16, v17
v_cvt_pk_bf16_f32 v79, v18, v19
v_add_u32 v82, s14, v12
v_mfma_f32_16x16x32_bf16 v[44:47], a[24:27], a[132:135], v[44:47]
global_load_dwordx4 a[24:27], v7, s[30:31] offset:-3072 sc1
ds_write_b64 v82, v[78:79] offset:16384
v_mfma_f32_16x16x32_bf16 v[32:35], a[36:39], a[168:171], v[32:35]
v_fma_f32 v20, v20, v73, v64
v_fma_f32 v21, v21, v73, v65
v_mfma_f32_16x16x32_bf16 v[32:35], a[40:43], a[184:187], v[32:35]
v_exp_f32 v76, v20
v_mfma_f32_16x16x32_bf16 v[32:35], a[44:47], a[200:203], v[32:35]
global_load_dwordx4 a[28:31], v7, s[30:31] offset:-2048 sc1
v_exp_f32 v77, v21
v_mfma_f32_16x16x32_bf16 v[36:39], a[44:47], a[204:207], v[36:39]
v_fma_f32 v76, v76, s56, s56
v_fma_f32 v77, v77, s56, s56
v_mfma_f32_16x16x32_bf16 v[36:39], a[40:43], a[188:191], v[36:39]
v_fma_f32 v76, -v76, v76, -0.5
v_fma_f32 v77, -v77, v77, -0.5
v_mfma_f32_16x16x32_bf16 v[36:39], a[36:39], a[172:175], v[36:39]
global_load_dwordx4 a[32:35], v7, s[30:31] offset:-1024 sc1
v_rcp_f32 v76, v76
v_mfma_f32_16x16x32_bf16 v[40:43], a[36:39], a[176:179], v[40:43]
v_rcp_f32 v77, v77
v_mfma_f32_16x16x32_bf16 v[40:43], a[40:43], a[192:195], v[40:43]
v_fmac_f32 v20, v20, v76
v_fmac_f32 v21, v21, v77
v_mfma_f32_16x16x32_bf16 v[40:43], a[44:47], a[208:211], v[40:43]
v_fma_f32 v22, v22, v73, v66
v_fma_f32 v23, v23, v73, v67
v_mfma_f32_16x16x32_bf16 v[44:47], a[44:47], a[212:215], v[44:47]
v_exp_f32 v76, v22
v_mfma_f32_16x16x32_bf16 v[44:47], a[40:43], a[196:199], v[44:47]
v_exp_f32 v77, v23
v_mfma_f32_16x16x32_bf16 v[44:47], a[36:39], a[180:183], v[44:47]
global_load_dwordx4 a[36:39], v7, s[30:31] offset:0 sc1
v_fma_f32 v76, v76, s56, s56
v_fma_f32 v77, v77, s56, s56
v_mfma_f32_16x16x32_bf16 v[32:35], a[48:51], a[216:219], v[32:35]
v_fma_f32 v76, -v76, v76, -0.5
v_fma_f32 v77, -v77, v77, -0.5
v_mfma_f32_16x16x32_bf16 v[32:35], a[52:55], a[232:235], v[32:35]
v_rcp_f32 v76, v76
v_mfma_f32_16x16x32_bf16 v[32:35], a[56:59], a[248:251], v[32:35]
global_load_dwordx4 a[40:43], v7, s[30:31] offset:1024 sc1
v_rcp_f32 v77, v77
v_mfma_f32_16x16x32_bf16 v[36:39], a[56:59], a[252:255], v[36:39]
v_fmac_f32 v22, v22, v76
v_fmac_f32 v23, v23, v77
v_mfma_f32_16x16x32_bf16 v[36:39], a[52:55], a[236:239], v[36:39]
v_cvt_pk_bf16_f32 v80, v20, v21
v_cvt_pk_bf16_f32 v81, v22, v23
v_mfma_f32_16x16x32_bf16 v[36:39], a[48:51], a[220:223], v[36:39]
global_load_dwordx4 a[44:47], v7, s[30:31] offset:2048 sc1
ds_write_b64 v82, v[80:81] offset:17408
v_mfma_f32_16x16x32_bf16 v[40:43], a[48:51], a[224:227], v[40:43]
s_add_u32 s30, s30, 0x1800
v_fma_f32 v24, v24, v74, v64
v_fma_f32 v25, v25, v74, v65
v_mfma_f32_16x16x32_bf16 v[40:43], a[52:55], a[240:243], v[40:43]
s_addc_u32 s31, s31, 0
v_exp_f32 v76, v24
v_mfma_f32_16x16x32_bf16 v[40:43], a[56:59], v[104:107], v[40:43]
s_cmp_eq_u32 s8, 8
v_exp_f32 v77, v25
v_mfma_f32_16x16x32_bf16 v[44:47], a[56:59], v[108:111], v[44:47]
s_cselect_b32 s7, 9, 8
v_fma_f32 v76, v76, s56, s56
v_fma_f32 v77, v77, s56, s56
v_mfma_f32_16x16x32_bf16 v[44:47], a[52:55], a[244:247], v[44:47]
s_cmp_eq_u32 s8, 7
v_fma_f32 v76, -v76, v76, -0.5
v_fma_f32 v77, -v77, v77, -0.5
v_mfma_f32_16x16x32_bf16 v[44:47], a[48:51], a[228:231], v[44:47]
s_cselect_b32 s7, 7, s7
global_load_dwordx4 a[48:51], v7, s[30:31] offset:-3072 sc1
v_rcp_f32 v76, v76
v_mfma_f32_16x16x32_bf16 v[32:35], a[60:63], v[112:115], v[32:35]
s_sub_u32 s14, s7, 8
v_rcp_f32 v77, v77
v_mfma_f32_16x16x32_bf16 v[32:35], a[64:67], v[128:131], v[32:35]
s_waitcnt vmcnt(26)
v_fmac_f32 v24, v24, v76
v_fmac_f32 v25, v25, v77
v_mfma_f32_16x16x32_bf16 v[32:35], a[68:71], v[144:147], v[32:35]
s_lshl_b32 s14, s14, 13
global_load_dwordx4 a[52:55], v7, s[30:31] offset:-2048 sc1
v_fma_f32 v26, v26, v74, v66
v_fma_f32 v27, v27, v74, v67
v_mfma_f32_16x16x32_bf16 v[36:39], a[68:71], v[148:151], v[36:39]
s_lshl_b32 s7, s7, 8
v_exp_f32 v76, v26
v_mfma_f32_16x16x32_bf16 v[36:39], a[64:67], v[132:135], v[36:39]
s_add_u32 s12, s22, s7
v_exp_f32 v77, v27
v_mfma_f32_16x16x32_bf16 v[36:39], a[60:63], v[116:119], v[36:39]
s_addc_u32 s13, s23, 0
global_load_dwordx4 a[56:59], v7, s[30:31] offset:-1024 sc1
v_fma_f32 v76, v76, s56, s56
v_fma_f32 v77, v77, s56, s56
v_mfma_f32_16x16x32_bf16 v[40:43], a[60:63], v[120:123], v[40:43]
v_fma_f32 v76, -v76, v76, -0.5
v_fma_f32 v77, -v77, v77, -0.5
v_mfma_f32_16x16x32_bf16 v[40:43], a[64:67], v[136:139], v[40:43]
v_rcp_f32 v76, v76
v_mfma_f32_16x16x32_bf16 v[40:43], a[68:71], v[152:155], v[40:43]
v_rcp_f32 v77, v77
v_mfma_f32_16x16x32_bf16 v[44:47], a[68:71], v[156:159], v[44:47]
v_fmac_f32 v26, v26, v76
v_fmac_f32 v27, v27, v77
v_mfma_f32_16x16x32_bf16 v[44:47], a[64:67], v[140:143], v[44:47]
v_cvt_pk_bf16_f32 v78, v24, v25
v_cvt_pk_bf16_f32 v79, v26, v27
v_mfma_f32_16x16x32_bf16 v[44:47], a[60:63], v[124:127], v[44:47]
s_waitcnt vmcnt(25)
global_load_dwordx4 a[60:63], v7, s[30:31] offset:0 sc1
ds_write_b64 v82, v[78:79] offset:18432
v_mfma_f32_16x16x32_bf16 v[32:35], a[72:75], v[160:163], v[32:35]
v_fma_f32 v28, v28, v75, v64
v_fma_f32 v29, v29, v75, v65
v_mfma_f32_16x16x32_bf16 v[32:35], a[76:79], v[176:179], v[32:35]
v_exp_f32 v76, v28
v_mfma_f32_16x16x32_bf16 v[32:35], a[80:83], v[192:195], v[32:35]
global_load_dwordx4 a[64:67], v7, s[30:31] offset:1024 sc1
v_exp_f32 v77, v29
v_mfma_f32_16x16x32_bf16 v[36:39], a[80:83], v[196:199], v[36:39]
v_fma_f32 v76, v76, s56, s56
v_fma_f32 v77, v77, s56, s56
v_mfma_f32_16x16x32_bf16 v[36:39], a[76:79], v[180:183], v[36:39]
v_fma_f32 v76, -v76, v76, -0.5
v_fma_f32 v77, -v77, v77, -0.5
v_mfma_f32_16x16x32_bf16 v[36:39], a[72:75], v[164:167], v[36:39]
global_load_dwordx4 a[68:71], v7, s[30:31] offset:2048 sc1
v_rcp_f32 v76, v76
v_mfma_f32_16x16x32_bf16 v[40:43], a[72:75], v[168:171], v[40:43]
s_add_u32 s30, s30, 0x1800
v_rcp_f32 v77, v77
v_mfma_f32_16x16x32_bf16 v[40:43], a[76:79], v[184:187], v[40:43]
s_addc_u32 s31, s31, 0
v_fmac_f32 v28, v28, v76
v_fmac_f32 v29, v29, v77
v_mfma_f32_16x16x32_bf16 v[40:43], a[80:83], v[200:203], v[40:43]
v_fma_f32 v30, v30, v75, v66
v_fma_f32 v31, v31, v75, v67
v_mfma_f32_16x16x32_bf16 v[44:47], a[80:83], v[204:207], v[44:47]
v_exp_f32 v76, v30
v_mfma_f32_16x16x32_bf16 v[44:47], a[76:79], v[188:191], v[44:47]
v_exp_f32 v77, v31
v_mfma_f32_16x16x32_bf16 v[44:47], a[72:75], v[172:175], v[44:47]
s_waitcnt vmcnt(25)
global_load_dwordx4 a[72:75], v7, s[30:31] offset:-3072 sc1
v_fma_f32 v76, v76, s56, s56
v_fma_f32 v77, v77, s56, s56
v_mfma_f32_16x16x32_bf16 v[32:35], a[84:87], v[208:211], v[32:35]
v_fma_f32 v76, -v76, v76, -0.5
v_fma_f32 v77, -v77, v77, -0.5
v_mfma_f32_16x16x32_bf16 v[32:35], a[88:91], v[224:227], v[32:35]
v_rcp_f32 v76, v76
v_mfma_f32_16x16x32_bf16 v[32:35], a[92:95], v[240:243], v[32:35]
global_load_dwordx4 a[76:79], v7, s[30:31] offset:-2048 sc1
v_rcp_f32 v77, v77
v_mfma_f32_16x16x32_bf16 v[36:39], a[92:95], v[244:247], v[36:39]
v_fmac_f32 v30, v30, v76
v_fmac_f32 v31, v31, v77
v_mfma_f32_16x16x32_bf16 v[36:39], a[88:91], v[228:231], v[36:39]
v_cvt_pk_bf16_f32 v80, v28, v29
v_cvt_pk_bf16_f32 v81, v30, v31
v_mfma_f32_16x16x32_bf16 v[36:39], a[84:87], v[212:215], v[36:39]
global_load_dwordx4 a[80:83], v7, s[30:31] offset:-1024 sc1
ds_write_b64 v82, v[80:81] offset:19456
v_mfma_f32_16x16x32_bf16 v[40:43], a[84:87], v[216:219], v[40:43]
s_waitcnt vmcnt(16)
v_fma_f32 v32, v32, v72, v68
v_fma_f32 v33, v33, v72, v69
v_mfma_f32_16x16x32_bf16 v[40:43], a[88:91], v[232:235], v[40:43]
v_exp_f32 v76, v32
v_mfma_f32_16x16x32_bf16 v[40:43], a[92:95], v[248:251], v[40:43]
v_exp_f32 v77, v33
v_mfma_f32_16x16x32_bf16 v[44:47], a[92:95], v[252:255], v[44:47]
v_fma_f32 v76, v76, s56, s56
v_fma_f32 v77, v77, s56, s56
v_mfma_f32_16x16x32_bf16 v[44:47], a[88:91], v[236:239], v[44:47]
v_fma_f32 v76, -v76, v76, -0.5
v_fma_f32 v77, -v77, v77, -0.5
v_mfma_f32_16x16x32_bf16 v[44:47], a[84:87], v[220:223], v[44:47]
global_load_dwordx4 a[84:87], v7, s[30:31] offset:0 sc1
v_rcp_f32 v76, v76
v_mfma_f32_16x16x32_bf16 v[16:19], a[96:99], a[120:123], 0
v_rcp_f32 v77, v77
v_mfma_f32_16x16x32_bf16 v[16:19], a[100:103], a[136:139], v[16:19]
v_fmac_f32 v32, v32, v76
v_fmac_f32 v33, v33, v77
v_mfma_f32_16x16x32_bf16 v[16:19], a[104:107], a[152:155], v[16:19]
global_load_dwordx4 a[88:91], v7, s[30:31] offset:1024 sc1
v_fma_f32 v34, v34, v72, v70
v_fma_f32 v35, v35, v72, v71
v_mfma_f32_16x16x32_bf16 v[20:23], a[104:107], a[156:159], 0
v_exp_f32 v76, v34
v_mfma_f32_16x16x32_bf16 v[20:23], a[100:103], a[140:143], v[20:23]
global_load_dwordx4 v[64:67], v13, s[12:13] sc1
v_exp_f32 v77, v35
v_mfma_f32_16x16x32_bf16 v[20:23], a[96:99], a[124:127], v[20:23]
global_load_dwordx4 a[92:95], v7, s[30:31] offset:2048 sc1
v_fma_f32 v76, v76, s56, s56
v_fma_f32 v77, v77, s56, s56
v_mfma_f32_16x16x32_bf16 v[24:27], a[96:99], a[128:131], 0
s_add_u32 s30, s30, 0x1800
v_fma_f32 v76, -v76, v76, -0.5
v_fma_f32 v77, -v77, v77, -0.5
v_mfma_f32_16x16x32_bf16 v[24:27], a[100:103], a[144:147], v[24:27]
s_addc_u32 s31, s31, 0
v_rcp_f32 v76, v76
v_mfma_f32_16x16x32_bf16 v[24:27], a[104:107], a[160:163], v[24:27]
v_rcp_f32 v77, v77
v_mfma_f32_16x16x32_bf16 v[28:31], a[104:107], a[164:167], 0
v_fmac_f32 v34, v34, v76
v_fmac_f32 v35, v35, v77
v_mfma_f32_16x16x32_bf16 v[28:31], a[100:103], a[148:151], v[28:31]
v_cvt_pk_bf16_f32 v78, v32, v33
v_cvt_pk_bf16_f32 v79, v34, v35
v_add_u32 v82, s15, v12
v_mfma_f32_16x16x32_bf16 v[28:31], a[96:99], a[132:135], v[28:31]
global_load_dwordx4 a[96:99], v7, s[30:31] offset:-3072 sc1
ds_write_b64 v82, v[78:79] offset:24576
v_mfma_f32_16x16x32_bf16 v[16:19], a[108:111], a[168:171], v[16:19]
v_fma_f32 v36, v36, v73, v68
v_fma_f32 v37, v37, v73, v69
v_mfma_f32_16x16x32_bf16 v[16:19], a[112:115], a[184:187], v[16:19]
v_exp_f32 v76, v36
v_mfma_f32_16x16x32_bf16 v[16:19], a[116:119], a[200:203], v[16:19]
global_load_dwordx4 a[100:103], v7, s[30:31] offset:-2048 sc1
v_exp_f32 v77, v37
v_mfma_f32_16x16x32_bf16 v[20:23], a[116:119], a[204:207], v[20:23]
v_fma_f32 v76, v76, s56, s56
v_fma_f32 v77, v77, s56, s56
v_mfma_f32_16x16x32_bf16 v[20:23], a[112:115], a[188:191], v[20:23]
v_fma_f32 v76, -v76, v76, -0.5
v_fma_f32 v77, -v77, v77, -0.5
v_mfma_f32_16x16x32_bf16 v[20:23], a[108:111], a[172:175], v[20:23]
global_load_dwordx4 a[104:107], v7, s[30:31] offset:-1024 sc1
v_rcp_f32 v76, v76
v_mfma_f32_16x16x32_bf16 v[24:27], a[108:111], a[176:179], v[24:27]
v_rcp_f32 v77, v77
v_mfma_f32_16x16x32_bf16 v[24:27], a[112:115], a[192:195], v[24:27]
v_fmac_f32 v36, v36, v76
v_fmac_f32 v37, v37, v77
v_mfma_f32_16x16x32_bf16 v[24:27], a[116:119], a[208:211], v[24:27]
v_fma_f32 v38, v38, v73, v70
v_fma_f32 v39, v39, v73, v71
v_mfma_f32_16x16x32_bf16 v[28:31], a[116:119], a[212:215], v[28:31]
v_exp_f32 v76, v38
v_mfma_f32_16x16x32_bf16 v[28:31], a[112:115], a[196:199], v[28:31]
v_exp_f32 v77, v39
v_mfma_f32_16x16x32_bf16 v[28:31], a[108:111], a[180:183], v[28:31]
global_load_dwordx4 a[108:111], v7, s[30:31] offset:0 sc1
v_fma_f32 v76, v76, s56, s56
v_fma_f32 v77, v77, s56, s56
v_mfma_f32_16x16x32_bf16 v[16:19], a[0:3], a[216:219], v[16:19]
v_fma_f32 v76, -v76, v76, -0.5
v_fma_f32 v77, -v77, v77, -0.5
v_mfma_f32_16x16x32_bf16 v[16:19], a[4:7], a[232:235], v[16:19]
v_rcp_f32 v76, v76
v_mfma_f32_16x16x32_bf16 v[16:19], a[8:11], a[248:251], v[16:19]
global_load_dwordx4 a[112:115], v7, s[30:31] offset:1024 sc1
v_rcp_f32 v77, v77
v_mfma_f32_16x16x32_bf16 v[20:23], a[8:11], a[252:255], v[20:23]
v_fmac_f32 v38, v38, v76
v_fmac_f32 v39, v39, v77
v_mfma_f32_16x16x32_bf16 v[20:23], a[4:7], a[236:239], v[20:23]
v_cvt_pk_bf16_f32 v80, v36, v37
v_cvt_pk_bf16_f32 v81, v38, v39
v_mfma_f32_16x16x32_bf16 v[20:23], a[0:3], a[220:223], v[20:23]
global_load_dwordx4 a[116:119], v7, s[30:31] offset:2048 sc1
ds_write_b64 v82, v[80:81] offset:25600
v_mfma_f32_16x16x32_bf16 v[24:27], a[0:3], a[224:227], v[24:27]
s_add_u32 s30, s30, 0x1800
v_fma_f32 v40, v40, v74, v68
v_fma_f32 v41, v41, v74, v69
v_mfma_f32_16x16x32_bf16 v[24:27], a[4:7], a[240:243], v[24:27]
s_addc_u32 s31, s31, 0
v_exp_f32 v76, v40
v_mfma_f32_16x16x32_bf16 v[24:27], a[8:11], v[104:107], v[24:27]
v_exp_f32 v77, v41
v_mfma_f32_16x16x32_bf16 v[28:31], a[8:11], v[108:111], v[28:31]
v_fma_f32 v76, v76, s56, s56
v_fma_f32 v77, v77, s56, s56
v_mfma_f32_16x16x32_bf16 v[28:31], a[4:7], a[244:247], v[28:31]
v_fma_f32 v76, -v76, v76, -0.5
v_fma_f32 v77, -v77, v77, -0.5
v_mfma_f32_16x16x32_bf16 v[28:31], a[0:3], a[228:231], v[28:31]
global_load_dwordx4 a[0:3], v7, s[30:31] offset:-3072 sc1
v_rcp_f32 v76, v76
v_mfma_f32_16x16x32_bf16 v[16:19], a[12:15], v[112:115], v[16:19]
v_rcp_f32 v77, v77
v_mfma_f32_16x16x32_bf16 v[16:19], a[16:19], v[128:131], v[16:19]
s_waitcnt vmcnt(26)
v_fmac_f32 v40, v40, v76
v_fmac_f32 v41, v41, v77
v_mfma_f32_16x16x32_bf16 v[16:19], a[20:23], v[144:147], v[16:19]
global_load_dwordx4 a[4:7], v7, s[30:31] offset:-2048 sc1
v_fma_f32 v42, v42, v74, v70
v_fma_f32 v43, v43, v74, v71
v_mfma_f32_16x16x32_bf16 v[20:23], a[20:23], v[148:151], v[20:23]
v_exp_f32 v76, v42
v_mfma_f32_16x16x32_bf16 v[20:23], a[16:19], v[132:135], v[20:23]
v_exp_f32 v77, v43
v_mfma_f32_16x16x32_bf16 v[20:23], a[12:15], v[116:119], v[20:23]
global_load_dwordx4 a[8:11], v7, s[30:31] offset:-1024 sc1
v_fma_f32 v76, v76, s56, s56
v_fma_f32 v77, v77, s56, s56
v_mfma_f32_16x16x32_bf16 v[24:27], a[12:15], v[120:123], v[24:27]
v_fma_f32 v76, -v76, v76, -0.5
v_fma_f32 v77, -v77, v77, -0.5
v_mfma_f32_16x16x32_bf16 v[24:27], a[16:19], v[136:139], v[24:27]
v_rcp_f32 v76, v76
v_mfma_f32_16x16x32_bf16 v[24:27], a[20:23], v[152:155], v[24:27]
v_rcp_f32 v77, v77
v_mfma_f32_16x16x32_bf16 v[28:31], a[20:23], v[156:159], v[28:31]
v_fmac_f32 v42, v42, v76
v_fmac_f32 v43, v43, v77
v_mfma_f32_16x16x32_bf16 v[28:31], a[16:19], v[140:143], v[28:31]
v_cvt_pk_bf16_f32 v78, v40, v41
v_cvt_pk_bf16_f32 v79, v42, v43
v_mfma_f32_16x16x32_bf16 v[28:31], a[12:15], v[124:127], v[28:31]
s_waitcnt vmcnt(25)
global_load_dwordx4 a[12:15], v7, s[30:31] offset:0 sc1
ds_write_b64 v82, v[78:79] offset:26624
v_mfma_f32_16x16x32_bf16 v[16:19], a[24:27], v[160:163], v[16:19]
v_fma_f32 v44, v44, v75, v68
v_fma_f32 v45, v45, v75, v69
v_mfma_f32_16x16x32_bf16 v[16:19], a[28:31], v[176:179], v[16:19]
v_exp_f32 v76, v44
v_mfma_f32_16x16x32_bf16 v[16:19], a[32:35], v[192:195], v[16:19]
global_load_dwordx4 a[16:19], v7, s[30:31] offset:1024 sc1
v_exp_f32 v77, v45
v_mfma_f32_16x16x32_bf16 v[20:23], a[32:35], v[196:199], v[20:23]
v_fma_f32 v76, v76, s56, s56
v_fma_f32 v77, v77, s56, s56
v_mfma_f32_16x16x32_bf16 v[20:23], a[28:31], v[180:183], v[20:23]
v_fma_f32 v76, -v76, v76, -0.5
v_fma_f32 v77, -v77, v77, -0.5
v_mfma_f32_16x16x32_bf16 v[20:23], a[24:27], v[164:167], v[20:23]
global_load_dwordx4 a[20:23], v7, s[30:31] offset:2048 sc1
v_rcp_f32 v76, v76
v_mfma_f32_16x16x32_bf16 v[24:27], a[24:27], v[168:171], v[24:27]
s_add_u32 s30, s30, 0x1800
v_rcp_f32 v77, v77
v_mfma_f32_16x16x32_bf16 v[24:27], a[28:31], v[184:187], v[24:27]
s_addc_u32 s31, s31, 0
v_fmac_f32 v44, v44, v76
v_fmac_f32 v45, v45, v77
v_mfma_f32_16x16x32_bf16 v[24:27], a[32:35], v[200:203], v[24:27]
v_fma_f32 v46, v46, v75, v70
v_fma_f32 v47, v47, v75, v71
v_mfma_f32_16x16x32_bf16 v[28:31], a[32:35], v[204:207], v[28:31]
v_exp_f32 v76, v46
v_mfma_f32_16x16x32_bf16 v[28:31], a[28:31], v[188:191], v[28:31]
v_exp_f32 v77, v47
v_mfma_f32_16x16x32_bf16 v[28:31], a[24:27], v[172:175], v[28:31]
s_waitcnt vmcnt(25)
global_load_dwordx4 a[24:27], v7, s[30:31] offset:-3072 sc1
v_fma_f32 v76, v76, s56, s56
v_fma_f32 v77, v77, s56, s56
v_mfma_f32_16x16x32_bf16 v[16:19], a[36:39], v[208:211], v[16:19]
s_waitcnt lgkmcnt(3)
s_barrier
ds_read_b128 a[120:123], v9 offset:0
v_fma_f32 v76, -v76, v76, -0.5
v_fma_f32 v77, -v77, v77, -0.5
v_mfma_f32_16x16x32_bf16 v[16:19], a[40:43], v[224:227], v[16:19]
ds_read_b128 a[136:139], v9 offset:4096
v_rcp_f32 v76, v76
v_mfma_f32_16x16x32_bf16 v[16:19], a[44:47], v[240:243], v[16:19]
global_load_dwordx4 a[28:31], v7, s[30:31] offset:-2048 sc1
v_rcp_f32 v77, v77
v_mfma_f32_16x16x32_bf16 v[20:23], a[44:47], v[244:247], v[20:23]
v_fmac_f32 v46, v46, v76
v_fmac_f32 v47, v47, v77
v_mfma_f32_16x16x32_bf16 v[20:23], a[40:43], v[228:231], v[20:23]
ds_read_b128 a[124:127], v9 offset:1024
v_cvt_pk_bf16_f32 v80, v44, v45
v_cvt_pk_bf16_f32 v81, v46, v47
v_mfma_f32_16x16x32_bf16 v[20:23], a[36:39], v[212:215], v[20:23]
global_load_dwordx4 a[32:35], v7, s[30:31] offset:-1024 sc1
ds_read_b128 a[140:143], v9 offset:5120
ds_write_b64 v82, v[80:81] offset:27648
v_mfma_f32_16x16x32_bf16 v[24:27], a[36:39], v[216:219], v[24:27]
s_waitcnt vmcnt(16)
v_fma_f32 v16, v16, v72, v64
v_fma_f32 v17, v17, v72, v65
v_mfma_f32_16x16x32_bf16 v[24:27], a[40:43], v[232:235], v[24:27]
v_exp_f32 v76, v16
v_mfma_f32_16x16x32_bf16 v[24:27], a[44:47], v[248:251], v[24:27]
ds_read_b128 a[128:131], v9 offset:2048
v_exp_f32 v77, v17
v_mfma_f32_16x16x32_bf16 v[28:31], a[44:47], v[252:255], v[28:31]
ds_read_b128 a[144:147], v9 offset:6144
v_fma_f32 v76, v76, s56, s56
v_fma_f32 v77, v77, s56, s56
v_mfma_f32_16x16x32_bf16 v[28:31], a[40:43], v[236:239], v[28:31]
v_fma_f32 v76, -v76, v76, -0.5
v_fma_f32 v77, -v77, v77, -0.5
v_mfma_f32_16x16x32_bf16 v[28:31], a[36:39], v[220:223], v[28:31]
s_waitcnt lgkmcnt(6)
global_load_dwordx4 a[36:39], v7, s[30:31] offset:0 sc1
v_rcp_f32 v76, v76
v_mfma_f32_16x16x32_bf16 v[32:35], a[48:51], a[120:123], 0
s_waitcnt lgkmcnt(5)
ds_read_b128 a[132:135], v9 offset:3072
ds_read_b128 a[148:151], v9 offset:7168
v_mfma_f32_16x16x32_bf16 v[32:35], a[56:59], a[136:139], v[32:35]
s_lshl_b32 s57, s26, 13
v_rcp_f32 v77, v77
v_mfma_f32_16x16x32_bf16 v[48:51], a[60:63], a[136:139], 0
s_add_u32 s60, s58, s57
global_load_dwordx4 a[40:43], v7, s[30:31] offset:1024 sc1
ds_read_b128 a[152:155], v9 offset:8192
v_mfma_f32_16x16x32_bf16 v[48:51], a[52:55], a[120:123], v[48:51]
s_waitcnt lgkmcnt(7)
v_fmac_f32 v16, v16, v76
v_fmac_f32 v17, v17, v77
v_mfma_f32_16x16x32_bf16 v[36:39], a[48:51], a[124:127], 0
s_waitcnt lgkmcnt(6)
s_addc_u32 s61, s59, 0
v_fma_f32 v18, v18, v72, v66
v_fma_f32 v19, v19, v72, v67
v_mfma_f32_16x16x32_bf16 v[36:39], a[56:59], a[140:143], v[36:39]
s_add_u32 s57, s26, 1
global_load_dwordx4 a[44:47], v7, s[30:31] offset:2048 sc1
ds_read_b128 a[168:171], v9 offset:12288
v_mfma_f32_16x16x32_bf16 v[52:55], a[60:63], a[140:143], 0
s_add_u32 s30, s30, 0x1800
v_exp_f32 v76, v18
v_mfma_f32_16x16x32_bf16 v[52:55], a[52:55], a[124:127], v[52:55]
s_waitcnt lgkmcnt(5)
v_exp_f32 v77, v19
v_mfma_f32_16x16x32_bf16 v[40:43], a[48:51], a[128:131], 0
s_waitcnt lgkmcnt(4)
s_addc_u32 s31, s31, 0
ds_read_b128 a[156:159], v9 offset:9216
ds_read_b128 a[172:175], v9 offset:13312
v_mfma_f32_16x16x32_bf16 v[40:43], a[56:59], a[144:147], v[40:43]
s_and_b32 s57, s57, 7
v_fma_f32 v76, v76, s56, s56
v_fma_f32 v77, v77, s56, s56
v_mfma_f32_16x16x32_bf16 v[56:59], a[60:63], a[144:147], 0
s_lshl_b32 s55, s57, 9
v_fma_f32 v76, -v76, v76, -0.5
v_fma_f32 v77, -v77, v77, -0.5
v_mfma_f32_16x16x32_bf16 v[56:59], a[52:55], a[128:131], v[56:59]
s_waitcnt lgkmcnt(5)
v_rcp_f32 v76, v76
v_mfma_f32_16x16x32_bf16 v[44:47], a[48:51], a[132:135], 0
s_waitcnt lgkmcnt(4)
s_lshl_b32 s57, s57, 13
global_load_dwordx4 a[48:51], v7, s[30:31] offset:-3072 sc1
ds_read_b128 a[160:163], v9 offset:10240
v_mfma_f32_16x16x32_bf16 v[44:47], a[56:59], a[148:151], v[44:47]
s_add_u32 s57, s57, 65536
ds_read_b128 a[176:179], v9 offset:14336
ds_read_b128 a[164:167], v9 offset:11264
v_mfma_f32_16x16x32_bf16 v[60:63], a[60:63], a[148:151], 0
s_add_u32 s62, s58, s57
v_rcp_f32 v77, v77
v_mfma_f32_16x16x32_bf16 v[60:63], a[52:55], a[132:135], v[60:63]
s_waitcnt lgkmcnt(6)
global_load_dwordx4 a[52:55], v7, s[30:31] offset:-2048 sc1
ds_read_b128 a[180:183], v9 offset:15360
v_mfma_f32_16x16x32_bf16 v[32:35], a[64:67], a[152:155], v[32:35]
s_waitcnt lgkmcnt(6)
s_addc_u32 s63, s59, 0
v_fmac_f32 v18, v18, v76
v_fmac_f32 v19, v19, v77
v_mfma_f32_16x16x32_bf16 v[32:35], a[72:75], a[168:171], v[32:35]
s_add_u32 s66, s72, s55
v_cvt_pk_bf16_f32 v78, v16, v17
v_cvt_pk_bf16_f32 v79, v18, v19
v_add_u32 v82, s14, v12
v_mfma_f32_16x16x32_bf16 v[48:51], a[76:79], a[168:171], v[48:51]
s_addc_u32 s67, s73, 0
global_load_dwordx4 a[56:59], v7, s[30:31] offset:-1024 sc1
ds_read_b128 a[184:187], v9 offset:16384
v_mfma_f32_16x16x32_bf16 v[48:51], a[68:71], a[152:155], v[48:51]
s_waitcnt lgkmcnt(6)
ds_write_b64 v82, v[78:79] offset:32768
v_mfma_f32_16x16x32_bf16 v[36:39], a[64:67], a[156:159], v[36:39]
s_waitcnt lgkmcnt(6)
s_and_b32 s74, s26, 3
v_fma_f32 v20, v20, v73, v64
v_fma_f32 v21, v21, v73, v65
v_mfma_f32_16x16x32_bf16 v[36:39], a[72:75], a[172:175], v[36:39]
s_lshl_b32 s74, s74, 2
global_load_dwordx4 a[60:63], v7, s[30:31] offset:0 sc1
ds_read_b128 a[200:203], v9 offset:20480
v_mfma_f32_16x16x32_bf16 v[52:55], a[76:79], a[172:175], v[52:55]
s_lshl_b32 s75, s26, 8
v_exp_f32 v76, v20
v_mfma_f32_16x16x32_bf16 v[52:55], a[68:71], a[156:159], v[52:55]
s_waitcnt lgkmcnt(6)
v_exp_f32 v77, v21
v_mfma_f32_16x16x32_bf16 v[40:43], a[64:67], a[160:163], v[40:43]
s_waitcnt lgkmcnt(5)
s_lshl_b32 s76, s26, 1
ds_read_b128 a[188:191], v9 offset:17408
ds_read_b128 a[204:207], v9 offset:21504
v_mfma_f32_16x16x32_bf16 v[40:43], a[72:75], a[176:179], v[40:43]
s_lshr_b32 s55, s24, 1
v_fma_f32 v76, v76, s56, s56
v_fma_f32 v77, v77, s56, s56
v_mfma_f32_16x16x32_bf16 v[56:59], a[76:79], a[176:179], v[56:59]
s_add_u32 s76, s76, s55
v_fma_f32 v76, -v76, v76, -0.5
v_fma_f32 v77, -v77, v77, -0.5
v_mfma_f32_16x16x32_bf16 v[56:59], a[68:71], a[160:163], v[56:59]
s_waitcnt lgkmcnt(6)
v_rcp_f32 v76, v76
v_mfma_f32_16x16x32_bf16 v[44:47], a[64:67], a[164:167], v[44:47]
s_waitcnt lgkmcnt(5)
s_lshl_b32 s76, s76, 10
global_load_dwordx4 a[64:67], v7, s[30:31] offset:1024 sc1
ds_read_b128 a[192:195], v9 offset:18432
v_mfma_f32_16x16x32_bf16 v[44:47], a[72:75], a[180:183], v[44:47]
s_and_b32 s55, s24, 1
ds_read_b128 a[208:211], v9 offset:22528
ds_read_b128 a[196:199], v9 offset:19456
v_mfma_f32_16x16x32_bf16 v[60:63], a[76:79], a[180:183], v[60:63]
s_lshl_b32 s55, s55, 3
v_rcp_f32 v77, v77
v_mfma_f32_16x16x32_bf16 v[60:63], a[68:71], a[164:167], v[60:63]
s_waitcnt lgkmcnt(7)
global_load_dwordx4 a[68:71], v7, s[30:31] offset:2048 sc1
ds_read_b128 a[212:215], v9 offset:23552
v_mfma_f32_16x16x32_bf16 v[32:35], a[80:83], a[184:187], v[32:35]
s_waitcnt lgkmcnt(6)
s_cmp_eq_u32 s9, 11
v_fmac_f32 v20, v20, v76
v_fmac_f32 v21, v21, v77
v_mfma_f32_16x16x32_bf16 v[32:35], a[88:91], a[200:203], v[32:35]
s_waitcnt vmcnt(24)
v_fma_f32 v22, v22, v73, v66
v_fma_f32 v23, v23, v73, v67
v_mfma_f32_16x16x32_bf16 v[48:51], a[92:95], a[200:203], v[48:51]
s_cselect_b32 s6, 12, 11
v_exp_f32 v76, v22
v_mfma_f32_16x16x32_bf16 v[48:51], a[84:87], a[184:187], v[48:51]
s_waitcnt lgkmcnt(5)
v_exp_f32 v77, v23
v_mfma_f32_16x16x32_bf16 v[36:39], a[80:83], a[188:191], v[36:39]
s_waitcnt lgkmcnt(4)
s_cmp_eq_u32 s9, 10
ds_read_b128 a[216:219], v9 offset:24576
ds_read_b128 a[232:235], v9 offset:28672
v_mfma_f32_16x16x32_bf16 v[36:39], a[88:91], a[204:207], v[36:39]
s_cselect_b32 s6, 10, s6
v_fma_f32 v76, v76, s56, s56
v_fma_f32 v77, v77, s56, s56
v_mfma_f32_16x16x32_bf16 v[52:55], a[92:95], a[204:207], v[52:55]
s_mul_i32 s6, s6, 18432
v_fma_f32 v76, -v76, v76, -0.5
v_fma_f32 v77, -v77, v77, -0.5
v_mfma_f32_16x16x32_bf16 v[52:55], a[84:87], a[188:191], v[52:55]
s_waitcnt lgkmcnt(5)
v_rcp_f32 v76, v76
v_mfma_f32_16x16x32_bf16 v[40:43], a[80:83], a[192:195], v[40:43]
s_waitcnt lgkmcnt(4)
s_add_u32 s30, s10, s6
ds_read_b128 a[220:223], v9 offset:25600
ds_read_b128 a[236:239], v9 offset:29696
v_mfma_f32_16x16x32_bf16 v[40:43], a[88:91], a[208:211], v[40:43]
s_addc_u32 s31, s11, 0
global_load_dwordx4 a[72:75], v7, s[30:31] offset:-3072 sc1
ds_read_b128 a[224:227], v9 offset:26624
v_mfma_f32_16x16x32_bf16 v[56:59], a[92:95], a[208:211], v[56:59]
s_add_u32 s76, s76, s55
v_rcp_f32 v77, v77
v_mfma_f32_16x16x32_bf16 v[56:59], a[84:87], a[192:195], v[56:59]
s_waitcnt lgkmcnt(6)
v_fmac_f32 v22, v22, v76
v_fmac_f32 v23, v23, v77
v_mfma_f32_16x16x32_bf16 v[44:47], a[80:83], a[196:199], v[44:47]
s_waitcnt lgkmcnt(5)
s_lshr_b32 s77, s26, 2
global_load_dwordx4 a[76:79], v7, s[30:31] offset:-2048 sc1
ds_read_b128 a[240:243], v9 offset:30720
v_mfma_f32_16x16x32_bf16 v[44:47], a[88:91], a[212:215], v[44:47]
s_mul_i32 s77, s77, 36864
v_cvt_pk_bf16_f32 v80, v20, v21
v_cvt_pk_bf16_f32 v81, v22, v23
v_mfma_f32_16x16x32_bf16 v[60:63], a[92:95], a[212:215], v[60:63]
s_lshl_b32 s55, s24, 9
ds_write_b64 v82, v[80:81] offset:33792
v_mfma_f32_16x16x32_bf16 v[60:63], a[84:87], a[196:199], v[60:63]
s_waitcnt vmcnt(22) lgkmcnt(6)
global_load_dwordx4 a[80:83], v7, s[30:31] offset:-1024 sc1
ds_read_b128 a[228:231], v9 offset:27648
v_mfma_f32_16x16x32_bf16 v[32:35], a[96:99], a[216:219], v[32:35]
s_waitcnt lgkmcnt(6)
s_add_u32 s77, s77, s55
v_fma_f32 v24, v24, v74, v64
v_fma_f32 v25, v25, v74, v65
v_mfma_f32_16x16x32_bf16 v[32:35], a[104:107], a[232:235], v[32:35]
s_add_u32 s77, s77, 16384
ds_read_b128 a[244:247], v9 offset:31744
ds_read_b128 a[248:251], v10 offset:0
v_mfma_f32_16x16x32_bf16 v[48:51], a[108:111], a[232:235], v[48:51]
s_lshl_b32 s55, s26, 13
global_load_dwordx4 a[84:87], v7, s[30:31] offset:0 sc1
ds_read_b128 v[112:115], v10 offset:4096
v_mfma_f32_16x16x32_bf16 v[48:51], a[100:103], a[216:219], v[48:51]
s_waitcnt lgkmcnt(8)
v_exp_f32 v76, v24
v_mfma_f32_16x16x32_bf16 v[36:39], a[96:99], a[220:223], v[36:39]
s_waitcnt lgkmcnt(7)
s_add_u32 s52, s58, s55
v_exp_f32 v77, v25
v_mfma_f32_16x16x32_bf16 v[36:39], a[104:107], a[236:239], v[36:39]
s_addc_u32 s53, s59, 0
global_load_dwordx4 a[88:91], v7, s[30:31] offset:1024 sc1
ds_read_b128 a[252:255], v10 offset:1024
v_mfma_f32_16x16x32_bf16 v[52:55], a[108:111], a[236:239], v[52:55]
s_lshl_b32 s55, s26, 9
v_fma_f32 v76, v76, s56, s56
v_fma_f32 v77, v77, s56, s56
v_mfma_f32_16x16x32_bf16 v[52:55], a[100:103], a[220:223], v[52:55]
s_waitcnt lgkmcnt(7)
v_fma_f32 v76, -v76, v76, -0.5
v_fma_f32 v77, -v77, v77, -0.5
v_mfma_f32_16x16x32_bf16 v[40:43], a[96:99], a[224:227], v[40:43]
s_waitcnt lgkmcnt(6)
s_add_u32 s78, s72, s55
global_load_dwordx4 a[92:95], v7, s[30:31] offset:2048 sc1
ds_read_b128 v[116:119], v10 offset:5120
v_mfma_f32_16x16x32_bf16 v[40:43], a[104:107], a[240:243], v[40:43]
s_addc_u32 s79, s73, 0
v_rcp_f32 v76, v76
v_mfma_f32_16x16x32_bf16 v[56:59], a[108:111], a[240:243], v[56:59]
s_add_u32 s30, s30, 0x1800
v_rcp_f32 v77, v77
v_mfma_f32_16x16x32_bf16 v[56:59], a[100:103], a[224:227], v[56:59]
s_waitcnt lgkmcnt(5)
v_fmac_f32 v24, v24, v76
v_fmac_f32 v25, v25, v77
v_mfma_f32_16x16x32_bf16 v[44:47], a[96:99], a[228:231], v[44:47]
s_waitcnt lgkmcnt(4)
s_addc_u32 s31, s31, 0
global_load_dwordx4 a[96:99], v7, s[30:31] offset:-3072 sc1
ds_read_b128 v[104:107], v10 offset:2048
v_mfma_f32_16x16x32_bf16 v[44:47], a[104:107], a[244:247], v[44:47]
ds_read_b128 v[120:123], v10 offset:6144
ds_read_b128 v[108:111], v10 offset:3072
v_mfma_f32_16x16x32_bf16 v[60:63], a[108:111], a[244:247], v[60:63]
v_fma_f32 v26, v26, v74, v66
v_fma_f32 v27, v27, v74, v67
v_mfma_f32_16x16x32_bf16 v[60:63], a[100:103], a[228:231], v[60:63]
s_waitcnt vmcnt(23) lgkmcnt(6)
global_load_dwordx4 a[100:103], v7, s[30:31] offset:-2048 sc1
ds_read_b128 v[124:127], v10 offset:7168
v_mfma_f32_16x16x32_bf16 v[32:35], a[112:115], a[248:251], v[32:35]
s_waitcnt lgkmcnt(6)
v_exp_f32 v76, v26
v_mfma_f32_16x16x32_bf16 v[32:35], a[0:3], v[112:115], v[32:35]
v_exp_f32 v77, v27
v_mfma_f32_16x16x32_bf16 v[48:51], a[4:7], v[112:115], v[48:51]
global_load_dwordx4 a[104:107], v7, s[30:31] offset:-1024 sc1
ds_read_b128 v[128:131], v10 offset:8192
v_mfma_f32_16x16x32_bf16 v[48:51], a[116:119], a[248:251], v[48:51]
s_waitcnt lgkmcnt(6)
v_fma_f32 v76, v76, s56, s56
v_fma_f32 v77, v77, s56, s56
v_mfma_f32_16x16x32_bf16 v[36:39], a[112:115], a[252:255], v[36:39]
s_waitcnt lgkmcnt(5)
v_fma_f32 v76, -v76, v76, -0.5
v_fma_f32 v77, -v77, v77, -0.5
v_mfma_f32_16x16x32_bf16 v[36:39], a[0:3], v[116:119], v[36:39]
global_load_dwordx4 a[108:111], v7, s[30:31] offset:0 sc1
ds_read_b128 v[144:147], v10 offset:12288
v_mfma_f32_16x16x32_bf16 v[52:55], a[4:7], v[116:119], v[52:55]
v_rcp_f32 v76, v76
v_mfma_f32_16x16x32_bf16 v[52:55], a[116:119], a[252:255], v[52:55]
s_waitcnt lgkmcnt(5)
v_rcp_f32 v77, v77
v_mfma_f32_16x16x32_bf16 v[40:43], a[112:115], v[104:107], v[40:43]
s_waitcnt lgkmcnt(4)
ds_read_b128 v[132:135], v10 offset:9216
ds_read_b128 v[148:151], v10 offset:13312
v_mfma_f32_16x16x32_bf16 v[40:43], a[0:3], v[120:123], v[40:43]
v_fmac_f32 v26, v26, v76
v_fmac_f32 v27, v27, v77
v_mfma_f32_16x16x32_bf16 v[56:59], a[4:7], v[120:123], v[56:59]
v_cvt_pk_bf16_f32 v78, v24, v25
v_cvt_pk_bf16_f32 v79, v26, v27
v_mfma_f32_16x16x32_bf16 v[56:59], a[116:119], v[104:107], v[56:59]
s_waitcnt lgkmcnt(5)
ds_write_b64 v82, v[78:79] offset:34816
v_mfma_f32_16x16x32_bf16 v[44:47], a[112:115], v[108:111], v[44:47]
s_waitcnt lgkmcnt(5)
global_load_dwordx4 a[112:115], v7, s[30:31] offset:1024 sc1
ds_read_b128 v[136:139], v10 offset:10240
v_mfma_f32_16x16x32_bf16 v[44:47], a[0:3], v[124:127], v[44:47]
ds_read_b128 v[152:155], v10 offset:14336
ds_read_b128 v[140:143], v10 offset:11264
v_mfma_f32_16x16x32_bf16 v[60:63], a[4:7], v[124:127], v[60:63]
v_fma_f32 v28, v28, v75, v64
v_fma_f32 v29, v29, v75, v65
v_mfma_f32_16x16x32_bf16 v[60:63], a[116:119], v[108:111], v[60:63]
s_waitcnt vmcnt(23) lgkmcnt(7)
global_load_dwordx4 a[116:119], v7, s[30:31] offset:2048 sc1
ds_read_b128 v[156:159], v10 offset:15360
v_mfma_f32_16x16x32_bf16 v[32:35], a[8:11], v[128:131], v[32:35]
s_waitcnt lgkmcnt(7)
v_exp_f32 v76, v28
v_mfma_f32_16x16x32_bf16 v[32:35], a[16:19], v[144:147], v[32:35]
s_add_u32 s30, s30, 0x1800
v_exp_f32 v77, v29
v_mfma_f32_16x16x32_bf16 v[48:51], a[20:23], v[144:147], v[48:51]
s_addc_u32 s31, s31, 0
global_load_dwordx4 a[0:3], v7, s[30:31] offset:-3072 sc1
s_barrier
ds_read_b128 v[160:163], v10 offset:16384
v_mfma_f32_16x16x32_bf16 v[48:51], a[12:15], v[128:131], v[48:51]
s_waitcnt lgkmcnt(7)
v_fma_f32 v76, v76, s56, s56
v_fma_f32 v77, v77, s56, s56
v_mfma_f32_16x16x32_bf16 v[36:39], a[8:11], v[132:135], v[36:39]
s_waitcnt lgkmcnt(6)
v_fma_f32 v76, -v76, v76, -0.5
v_fma_f32 v77, -v77, v77, -0.5
v_mfma_f32_16x16x32_bf16 v[36:39], a[16:19], v[148:151], v[36:39]
global_load_dwordx4 a[4:7], v7, s[30:31] offset:-2048 sc1
ds_read_b128 v[176:179], v10 offset:20480
v_mfma_f32_16x16x32_bf16 v[52:55], a[20:23], v[148:151], v[52:55]
v_rcp_f32 v76, v76
v_mfma_f32_16x16x32_bf16 v[52:55], a[12:15], v[132:135], v[52:55]
s_waitcnt lgkmcnt(5)
v_rcp_f32 v77, v77
v_mfma_f32_16x16x32_bf16 v[40:43], a[8:11], v[136:139], v[40:43]
s_waitcnt lgkmcnt(4)
ds_read_b128 v[164:167], v10 offset:17408
ds_read_b128 v[180:183], v10 offset:21504
v_mfma_f32_16x16x32_bf16 v[40:43], a[16:19], v[152:155], v[40:43]
v_fmac_f32 v28, v28, v76
v_fmac_f32 v29, v29, v77
v_mfma_f32_16x16x32_bf16 v[56:59], a[20:23], v[152:155], v[56:59]
v_fma_f32 v30, v30, v75, v66
v_fma_f32 v31, v31, v75, v67
v_mfma_f32_16x16x32_bf16 v[56:59], a[12:15], v[136:139], v[56:59]
s_waitcnt lgkmcnt(5)
v_exp_f32 v76, v30
v_mfma_f32_16x16x32_bf16 v[44:47], a[8:11], v[140:143], v[44:47]
s_waitcnt lgkmcnt(4)
global_load_dwordx4 a[8:11], v7, s[30:31] offset:-1024 sc1
ds_read_b128 v[168:171], v10 offset:18432
v_mfma_f32_16x16x32_bf16 v[44:47], a[16:19], v[156:159], v[44:47]
ds_read_b128 v[184:187], v10 offset:22528
ds_read_b128 v[172:175], v10 offset:19456
v_mfma_f32_16x16x32_bf16 v[60:63], a[20:23], v[156:159], v[60:63]
v_exp_f32 v77, v31
v_mfma_f32_16x16x32_bf16 v[60:63], a[12:15], v[140:143], v[60:63]
s_waitcnt vmcnt(23) lgkmcnt(6)
global_load_dwordx4 a[12:15], v7, s[30:31] offset:0 sc1
ds_read_b128 v[188:191], v10 offset:23552
v_mfma_f32_16x16x32_bf16 v[32:35], a[24:27], v[160:163], v[32:35]
s_waitcnt lgkmcnt(6)
v_fma_f32 v76, v76, s56, s56
v_fma_f32 v77, v77, s56, s56
v_mfma_f32_16x16x32_bf16 v[32:35], a[32:35], v[176:179], v[32:35]
v_fma_f32 v76, -v76, v76, -0.5
v_fma_f32 v77, -v77, v77, -0.5
v_mfma_f32_16x16x32_bf16 v[48:51], a[36:39], v[176:179], v[48:51]
global_load_dwordx4 a[16:19], v7, s[30:31] offset:1024 sc1
ds_read_b128 v[192:195], v10 offset:24576
v_mfma_f32_16x16x32_bf16 v[48:51], a[28:31], v[160:163], v[48:51]
s_waitcnt lgkmcnt(6)
v_rcp_f32 v76, v76
v_mfma_f32_16x16x32_bf16 v[36:39], a[24:27], v[164:167], v[36:39]
s_waitcnt lgkmcnt(5)
v_rcp_f32 v77, v77
v_mfma_f32_16x16x32_bf16 v[36:39], a[32:35], v[180:183], v[36:39]
global_load_dwordx4 a[20:23], v7, s[30:31] offset:2048 sc1
ds_read_b128 v[208:211], v10 offset:28672
v_mfma_f32_16x16x32_bf16 v[52:55], a[36:39], v[180:183], v[52:55]
s_cmp_eq_u32 s9, 12
v_fmac_f32 v30, v30, v76
v_fmac_f32 v31, v31, v77
v_mfma_f32_16x16x32_bf16 v[52:55], a[28:31], v[164:167], v[52:55]
s_waitcnt lgkmcnt(5)
v_cvt_pk_bf16_f32 v80, v28, v29
v_cvt_pk_bf16_f32 v81, v30, v31
v_mfma_f32_16x16x32_bf16 v[40:43], a[24:27], v[168:171], v[40:43]
s_waitcnt lgkmcnt(4)
s_cselect_b32 s6, 13, 12
ds_read_b128 v[196:199], v10 offset:25600
ds_read_b128 v[212:215], v10 offset:29696
v_mfma_f32_16x16x32_bf16 v[40:43], a[32:35], v[184:187], v[40:43]
s_cmp_eq_u32 s9, 11
ds_write_b64 v82, v[80:81] offset:35840
v_mfma_f32_16x16x32_bf16 v[56:59], a[36:39], v[184:187], v[56:59]
s_cselect_b32 s6, 11, s6
v_mfma_f32_16x16x32_bf16 v[56:59], a[28:31], v[168:171], v[56:59]
s_waitcnt lgkmcnt(6)
v_mfma_f32_16x16x32_bf16 v[44:47], a[24:27], v[172:175], v[44:47]
s_waitcnt lgkmcnt(5)
s_mul_i32 s6, s6, 18432
ds_read_b128 v[200:203], v10 offset:26624
ds_read_b128 v[216:219], v10 offset:30720
v_mfma_f32_16x16x32_bf16 v[44:47], a[32:35], v[188:191], v[44:47]
s_add_u32 s30, s10, s6
v_mfma_f32_16x16x32_bf16 v[60:63], a[36:39], v[188:191], v[60:63]
s_addc_u32 s31, s11, 0
global_load_dwordx4 a[24:27], v7, s[30:31] offset:-3072 sc1
ds_read_b128 v[204:207], v10 offset:27648
v_mfma_f32_16x16x32_bf16 v[60:63], a[28:31], v[172:175], v[60:63]
s_waitcnt vmcnt(23) lgkmcnt(7)
v_mfma_f32_16x16x32_bf16 v[32:35], a[40:43], v[192:195], v[32:35]
s_waitcnt lgkmcnt(6)
v_mfma_f32_16x16x32_bf16 v[32:35], a[48:51], v[208:211], v[32:35]
global_load_dwordx4 a[28:31], v7, s[30:31] offset:-2048 sc1
ds_read_b128 v[220:223], v10 offset:31744
v_mfma_f32_16x16x32_bf16 v[48:51], a[52:55], v[208:211], v[48:51]
v_mfma_f32_16x16x32_bf16 v[48:51], a[44:47], v[192:195], v[48:51]
s_waitcnt lgkmcnt(6)
v_mfma_f32_16x16x32_bf16 v[36:39], a[40:43], v[196:199], v[36:39]
s_waitcnt lgkmcnt(5)
global_load_dwordx4 a[32:35], v7, s[30:31] offset:-1024 sc1
s_waitcnt lgkmcnt(4)
s_barrier
ds_read_b128 v[224:227], v10 offset:32768
v_mfma_f32_16x16x32_bf16 v[36:39], a[48:51], v[212:215], v[36:39]
ds_read_b128 v[240:243], v10 offset:36864
ds_read_b128 v[228:231], v10 offset:33792
v_mfma_f32_16x16x32_bf16 v[52:55], a[52:55], v[212:215], v[52:55]
v_mfma_f32_16x16x32_bf16 v[52:55], a[44:47], v[196:199], v[52:55]
s_waitcnt lgkmcnt(6)
global_load_dwordx4 a[36:39], v7, s[30:31] offset:0 sc1
ds_read_b128 v[244:247], v10 offset:37888
v_mfma_f32_16x16x32_bf16 v[40:43], a[40:43], v[200:203], v[40:43]
s_waitcnt lgkmcnt(6)
v_mfma_f32_16x16x32_bf16 v[40:43], a[48:51], v[216:219], v[40:43]
v_mfma_f32_16x16x32_bf16 v[56:59], a[52:55], v[216:219], v[56:59]
v_mfma_f32_16x16x32_bf16 v[56:59], a[44:47], v[200:203], v[56:59]
s_waitcnt lgkmcnt(5)
v_mfma_f32_16x16x32_bf16 v[44:47], a[40:43], v[204:207], v[44:47]
s_waitcnt lgkmcnt(4)
global_load_dwordx4 a[40:43], v7, s[30:31] offset:1024 sc1
ds_read_b128 v[232:235], v10 offset:34816
v_mfma_f32_16x16x32_bf16 v[44:47], a[48:51], v[220:223], v[44:47]
ds_read_b128 v[248:251], v10 offset:38912
ds_read_b128 v[236:239], v10 offset:35840
v_mfma_f32_16x16x32_bf16 v[60:63], a[52:55], v[220:223], v[60:63]
v_mfma_f32_16x16x32_bf16 v[60:63], a[44:47], v[204:207], v[60:63]
s_waitcnt vmcnt(23) lgkmcnt(6)
global_load_dwordx4 a[44:47], v7, s[30:31] offset:2048 sc1
ds_read_b128 v[252:255], v10 offset:39936
v_mfma_f32_16x16x32_bf16 v[32:35], a[56:59], v[224:227], v[32:35]
s_waitcnt lgkmcnt(6)
v_mfma_f32_16x16x32_bf16 v[32:35], a[64:67], v[240:243], v[32:35]
s_add_u32 s30, s30, 0x1800
v_mfma_f32_16x16x32_bf16 v[48:51], a[68:71], v[240:243], v[48:51]
s_addc_u32 s31, s31, 0
global_load_dwordx4 a[48:51], v7, s[30:31] offset:-3072 sc1
v_mfma_f32_16x16x32_bf16 v[48:51], a[60:63], v[224:227], v[48:51]
s_waitcnt lgkmcnt(5)
v_mfma_f32_16x16x32_bf16 v[36:39], a[56:59], v[228:231], v[36:39]
s_waitcnt lgkmcnt(4)
v_mfma_f32_16x16x32_bf16 v[36:39], a[64:67], v[244:247], v[36:39]
global_load_dwordx4 a[52:55], v7, s[30:31] offset:-2048 sc1
v_mfma_f32_16x16x32_bf16 v[52:55], a[68:71], v[244:247], v[52:55]
v_mfma_f32_16x16x32_bf16 v[52:55], a[60:63], v[228:231], v[52:55]
s_waitcnt lgkmcnt(3)
v_mfma_f32_16x16x32_bf16 v[40:43], a[56:59], v[232:235], v[40:43]
s_waitcnt lgkmcnt(2)
v_mfma_f32_16x16x32_bf16 v[40:43], a[64:67], v[248:251], v[40:43]
v_cvt_pk_bf16_f32 v84, v32, v33
v_cvt_pk_bf16_f32 v85, v34, v35
v_mfma_f32_16x16x32_bf16 v[56:59], a[68:71], v[248:251], v[56:59]
v_mfma_f32_16x16x32_bf16 v[56:59], a[60:63], v[232:235], v[56:59]
s_waitcnt lgkmcnt(1)
v_mfma_f32_16x16x32_bf16 v[44:47], a[56:59], v[236:239], v[44:47]
s_waitcnt lgkmcnt(0)
global_load_dwordx4 a[56:59], v7, s[30:31] offset:-1024 sc1
v_mfma_f32_16x16x32_bf16 v[44:47], a[64:67], v[252:255], v[44:47]
v_cvt_pk_bf16_f32 v86, v36, v37
v_cvt_pk_bf16_f32 v87, v38, v39
v_mfma_f32_16x16x32_bf16 v[60:63], a[68:71], v[252:255], v[60:63]
v_mfma_f32_16x16x32_bf16 v[60:63], a[60:63], v[236:239], v[60:63]
s_waitcnt vmcnt(24)
global_load_dwordx4 a[60:63], v7, s[30:31] offset:0 sc1
v_mfma_f32_16x16x32_bf16 v[16:19], a[72:75], a[120:123], 0
v_mfma_f32_16x16x32_bf16 v[16:19], a[76:79], a[136:139], v[16:19]
v_cvt_pk_bf16_f32 v88, v40, v41
v_cvt_pk_bf16_f32 v89, v42, v43
v_mfma_f32_16x16x32_bf16 v[16:19], a[80:83], a[152:155], v[16:19]
global_load_dwordx4 a[64:67], v7, s[30:31] offset:1024 sc1
v_mfma_f32_16x16x32_bf16 v[20:23], a[80:83], a[156:159], 0
v_mfma_f32_16x16x32_bf16 v[20:23], a[76:79], a[140:143], v[20:23]
v_mfma_f32_16x16x32_bf16 v[20:23], a[72:75], a[124:127], v[20:23]
global_load_dwordx4 a[68:71], v7, s[30:31] offset:2048 sc1
v_mfma_f32_16x16x32_bf16 v[24:27], a[72:75], a[128:131], 0
s_add_u32 s30, s30, 0x1800
v_cvt_pk_bf16_f32 v90, v44, v45
v_cvt_pk_bf16_f32 v91, v46, v47
v_mfma_f32_16x16x32_bf16 v[24:27], a[76:79], a[144:147], v[24:27]
s_addc_u32 s31, s31, 0
v_cvt_pk_bf16_f32 v92, v48, v49
v_cvt_pk_bf16_f32 v93, v50, v51
v_mfma_f32_16x16x32_bf16 v[24:27], a[80:83], a[160:163], v[24:27]
v_cvt_pk_bf16_f32 v94, v52, v53
v_cvt_pk_bf16_f32 v95, v54, v55
v_mfma_f32_16x16x32_bf16 v[28:31], a[80:83], a[164:167], 0
v_cvt_pk_bf16_f32 v96, v56, v57
v_cvt_pk_bf16_f32 v97, v58, v59
v_mfma_f32_16x16x32_bf16 v[28:31], a[76:79], a[148:151], v[28:31]
v_cvt_pk_bf16_f32 v98, v60, v61
v_cvt_pk_bf16_f32 v99, v62, v63
v_mfma_f32_16x16x32_bf16 v[28:31], a[72:75], a[132:135], v[28:31]
s_waitcnt vmcnt(24)
global_load_dwordx4 a[72:75], v7, s[30:31] offset:-3072 sc1
v_mfma_f32_16x16x32_bf16 v[16:19], a[84:87], a[168:171], v[16:19]
global_store_dwordx4 v102, v[84:87], s[60:61] offset:0 sc1
global_store_dwordx4 v102, v[88:91], s[60:61] offset:1024 sc1
v_mfma_f32_16x16x32_bf16 v[16:19], a[88:91], a[184:187], v[16:19]
v_lshrrev_b32 v2, 2, v6
v_and_b32 v3, 1, v6
v_mfma_f32_16x16x32_bf16 v[16:19], a[92:95], a[200:203], v[16:19]
global_load_dwordx4 a[76:79], v7, s[30:31] offset:-2048 sc1
v_mfma_f32_16x16x32_bf16 v[20:23], a[92:95], a[204:207], v[20:23]
v_cmp_eq_u32 vcc, v2, v5
v_lshlrev_b32 v3, 4, v3
v_mfma_f32_16x16x32_bf16 v[20:23], a[88:91], a[188:191], v[20:23]
v_mov_b32 v4, 0x3f80
v_lshlrev_b32 v3, v3, v4
v_mfma_f32_16x16x32_bf16 v[20:23], a[84:87], a[172:175], v[20:23]
v_cndmask_b32 v3, 0, v3, vcc
v_and_b32 v4, 2, v6
v_mfma_f32_16x16x32_bf16 v[24:27], a[84:87], a[176:179], v[24:27]
v_cmp_eq_u32 vcc, 0, v4
v_mov_b32 v66, 0
v_mfma_f32_16x16x32_bf16 v[24:27], a[88:91], a[192:195], v[24:27]
global_load_dwordx4 a[80:83], v7, s[30:31] offset:-1024 sc1
v_mfma_f32_16x16x32_bf16 v[24:27], a[92:95], a[208:211], v[24:27]
v_mov_b32 v67, 0
v_and_b32 v4, 3, v1
v_mfma_f32_16x16x32_bf16 v[28:31], a[92:95], a[212:215], v[28:31]
v_cndmask_b32 v64, 0, v3, vcc
v_sub_u32 v65, v3, v64
v_mfma_f32_16x16x32_bf16 v[28:31], a[88:91], a[196:199], v[28:31]
v_mov_b32 v68, v64
v_mov_b32 v69, v65
v_mfma_f32_16x16x32_bf16 v[28:31], a[84:87], a[180:183], v[28:31]
s_waitcnt vmcnt(26)
global_load_dwordx4 a[84:87], v7, s[30:31] offset:0 sc1
v_mfma_f32_16x16x32_bf16 v[16:19], a[96:99], a[216:219], v[16:19]
v_and_b32 v8, 0xff, v102
v_and_b32 v14, 1, v2
v_mfma_f32_16x16x32_bf16 v[16:19], a[100:103], a[232:235], v[16:19]
v_lshl_add_u32 v8, v2, 13, v8
v_add_u32 v4, s74, v4
v_mfma_f32_16x16x32_bf16 v[16:19], a[104:107], a[248:251], v[16:19]
v_add_u32 v8, s75, v8
v_lshrrev_b32 v3, 1, v5
v_mfma_f32_16x16x32_bf16 v[20:23], a[104:107], a[252:255], v[20:23]
v_add_u32 v13, 0x8000, v8
v_lshl_add_u32 v10, v3, 4, v4
v_mfma_f32_16x16x32_bf16 v[20:23], a[100:103], a[236:239], v[20:23]
global_load_dwordx4 a[88:91], v7, s[30:31] offset:1024 sc1
v_mfma_f32_16x16x32_bf16 v[20:23], a[96:99], a[220:223], v[20:23]
v_and_b32 v2, 1, v5
v_lshlrev_b32 v10, 4, v10
v_mfma_f32_16x16x32_bf16 v[24:27], a[96:99], a[224:227], v[24:27]
v_add_u32 v9, s76, v7
v_lshl_add_u32 v10, v2, 3, v10
v_mfma_f32_16x16x32_bf16 v[24:27], a[100:103], a[240:243], v[24:27]
v_mul_u32_u24 v11, 18432, v2
v_mul_u32_u24 v14, 18432, v14
v_mfma_f32_16x16x32_bf16 v[24:27], a[104:107], v[104:107], v[24:27]
global_load_dwordx4 a[92:95], v7, s[30:31] offset:2048 sc1
v_mfma_f32_16x16x32_bf16 v[28:31], a[104:107], v[108:111], v[28:31]
s_cmp_eq_u32 s9, 13
v_add3_u32 v10, v10, v14, s77
v_mov_b32 v15, v4
v_mfma_f32_16x16x32_bf16 v[28:31], a[100:103], a[244:247], v[28:31]
s_cselect_b32 s6, 14, 13
v_mfma_f32_16x16x32_bf16 v[28:31], a[96:99], a[228:231], v[28:31]
s_waitcnt vmcnt(26)
v_mfma_f32_16x16x32_bf16 v[16:19], a[108:111], v[112:115], v[16:19]
s_cmp_eq_u32 s9, 12
v_mfma_f32_16x16x32_bf16 v[16:19], a[112:115], v[128:131], v[16:19]
s_cselect_b32 s6, 12, s6
v_mfma_f32_16x16x32_bf16 v[16:19], a[116:119], v[144:147], v[16:19]
s_mul_i32 s6, s6, 18432
v_mfma_f32_16x16x32_bf16 v[20:23], a[116:119], v[148:151], v[20:23]
s_add_u32 s30, s10, s6
v_mfma_f32_16x16x32_bf16 v[20:23], a[112:115], v[132:135], v[20:23]
s_addc_u32 s31, s11, 0
global_load_dwordx4 a[96:99], v7, s[30:31] offset:-3072 sc1
v_mfma_f32_16x16x32_bf16 v[20:23], a[108:111], v[116:119], v[20:23]
s_cmp_eq_u32 s9, 11
v_mfma_f32_16x16x32_bf16 v[24:27], a[108:111], v[120:123], v[24:27]
s_cselect_b32 s57, 12, 11
v_mfma_f32_16x16x32_bf16 v[24:27], a[112:115], v[136:139], v[24:27]
s_cmp_eq_u32 s9, 10
global_load_dwordx4 a[100:103], v7, s[30:31] offset:-2048 sc1
v_mfma_f32_16x16x32_bf16 v[24:27], a[116:119], v[152:155], v[24:27]
s_cselect_b32 s57, 10, s57
global_store_dwordx4 v7, v[92:95], s[62:63] offset:0 sc1
global_store_dwordx4 v7, v[96:99], s[62:63] offset:1024 sc1
v_mfma_f32_16x16x32_bf16 v[28:31], a[116:119], v[156:159], v[28:31]
s_add_u32 s57, s57, s26
v_mfma_f32_16x16x32_bf16 v[28:31], a[112:115], v[140:143], v[28:31]
s_sub_u32 s57, s57, 9
global_load_dwordx4 a[104:107], v7, s[30:31] offset:-1024 sc1
v_mfma_f32_16x16x32_bf16 v[28:31], a[108:111], v[124:127], v[28:31]
s_waitcnt vmcnt(28)
v_mfma_f32_16x16x32_bf16 v[16:19], a[0:3], v[160:163], v[16:19]
s_and_b32 s57, s57, 7
v_mfma_f32_16x16x32_bf16 v[16:19], a[4:7], v[176:179], v[16:19]
s_lshl_b32 s55, s57, 9
v_mfma_f32_16x16x32_bf16 v[16:19], a[8:11], v[192:195], v[16:19]
s_lshl_b32 s57, s57, 13
global_load_dwordx4 a[108:111], v7, s[30:31] offset:0 sc1
v_mfma_f32_16x16x32_bf16 v[20:23], a[8:11], v[196:199], v[20:23]
s_add_u32 s57, s57, 131072
v_mfma_f32_16x16x32_bf16 v[20:23], a[4:7], v[180:183], v[20:23]
s_add_u32 s60, s58, s57
v_mfma_f32_16x16x32_bf16 v[20:23], a[0:3], v[164:167], v[20:23]
s_addc_u32 s61, s59, 0
v_mfma_f32_16x16x32_bf16 v[24:27], a[0:3], v[168:171], v[24:27]
s_add_u32 s64, s72, s55
v_mfma_f32_16x16x32_bf16 v[24:27], a[4:7], v[184:187], v[24:27]
s_addc_u32 s65, s73, 0
global_load_dwordx4 a[112:115], v7, s[30:31] offset:1024 sc1
v_mfma_f32_16x16x32_bf16 v[24:27], a[8:11], v[200:203], v[24:27]
v_mfma_f32_16x16x32_bf16 v[28:31], a[8:11], v[204:207], v[28:31]
v_mfma_f32_16x16x32_bf16 v[28:31], a[4:7], v[188:191], v[28:31]
v_mfma_f32_16x16x32_bf16 v[28:31], a[0:3], v[172:175], v[28:31]
s_waitcnt vmcnt(27)
global_load_dwordx4 a[116:119], v7, s[30:31] offset:2048 sc1
v_mfma_f32_16x16x32_bf16 v[16:19], a[12:15], v[208:211], v[16:19]
s_add_u32 s30, s30, 0x1800
v_mfma_f32_16x16x32_bf16 v[16:19], a[16:19], v[224:227], v[16:19]
s_addc_u32 s31, s31, 0
v_mfma_f32_16x16x32_bf16 v[16:19], a[20:23], v[240:243], v[16:19]
v_mfma_f32_16x16x32_bf16 v[20:23], a[20:23], v[244:247], v[20:23]
v_mfma_f32_16x16x32_bf16 v[20:23], a[16:19], v[228:231], v[20:23]
global_load_dwordx4 a[0:3], v7, s[30:31] offset:-3072 sc1
v_mfma_f32_16x16x32_bf16 v[20:23], a[12:15], v[212:215], v[20:23]
v_mfma_f32_16x16x32_bf16 v[24:27], a[12:15], v[216:219], v[24:27]
v_mfma_f32_16x16x32_bf16 v[24:27], a[16:19], v[232:235], v[24:27]
v_mfma_f32_16x16x32_bf16 v[24:27], a[20:23], v[248:251], v[24:27]
global_load_dwordx4 a[4:7], v7, s[30:31] offset:-2048 sc1
v_mfma_f32_16x16x32_bf16 v[28:31], a[20:23], v[252:255], v[28:31]
v_mfma_f32_16x16x32_bf16 v[28:31], a[16:19], v[236:239], v[28:31]
v_cvt_pk_bf16_f32 v84, v16, v17
v_cvt_pk_bf16_f32 v85, v18, v19
v_mfma_f32_16x16x32_bf16 v[28:31], a[12:15], v[220:223], v[28:31]
s_waitcnt vmcnt(27)
v_mfma_f32_16x16x32_bf16 v[32:35], a[24:27], a[120:123], 0
v_mfma_f32_16x16x32_bf16 v[32:35], a[28:31], a[136:139], v[32:35]
global_load_dwordx4 a[8:11], v7, s[30:31] offset:-1024 sc1
v_mfma_f32_16x16x32_bf16 v[32:35], a[32:35], a[152:155], v[32:35]
v_cvt_pk_bf16_f32 v86, v20, v21
v_cvt_pk_bf16_f32 v87, v22, v23
v_mfma_f32_16x16x32_bf16 v[36:39], a[32:35], a[156:159], 0
v_mfma_f32_16x16x32_bf16 v[36:39], a[28:31], a[140:143], v[36:39]
v_cvt_pk_bf16_f32 v88, v24, v25
v_cvt_pk_bf16_f32 v89, v26, v27
v_mfma_f32_16x16x32_bf16 v[36:39], a[24:27], a[124:127], v[36:39]
v_mfma_f32_16x16x32_bf16 v[40:43], a[24:27], a[128:131], 0
global_load_dwordx4 a[12:15], v7, s[30:31] offset:0 sc1
v_mfma_f32_16x16x32_bf16 v[40:43], a[28:31], a[144:147], v[40:43]
v_cvt_pk_bf16_f32 v90, v28, v29
v_cvt_pk_bf16_f32 v91, v30, v31
v_mfma_f32_16x16x32_bf16 v[40:43], a[32:35], a[160:163], v[40:43]
s_bitcmp1_b32 s25, 0
s_cbranch_scc0 L_ei_o_31
L_ei_e_32:
v_mfma_f32_16x16x32_bf16 v[44:47], a[32:35], a[164:167], 0
v_mfma_f32_16x16x32_bf16 v[44:47], a[28:31], a[148:151], v[44:47]
global_load_dwordx4 a[16:19], v7, s[30:31] offset:1024 sc1
v_mfma_f32_16x16x32_bf16 v[44:47], a[24:27], a[132:135], v[44:47]
s_waitcnt vmcnt(27)
v_mfma_f32_16x16x32_bf16 v[32:35], a[36:39], a[168:171], v[32:35]
v_mfma_f32_16x16x32_bf16 v[32:35], a[40:43], a[184:187], v[32:35]
v_mfma_f32_16x16x32_bf16 v[32:35], a[44:47], a[200:203], v[32:35]
v_mfma_f32_16x16x32_bf16 v[36:39], a[44:47], a[204:207], v[36:39]
s_waitcnt vmcnt(9)
global_load_dwordx4 a[20:23], v7, s[30:31] offset:2048 sc1
v_mfma_f32_16x16x32_bf16 v[36:39], a[40:43], a[188:191], v[36:39]
s_add_u32 s30, s30, 0x1800
s_atomic_add s54, s[66:67], 4
s_atomic_add s54, s[72:73], 64
v_mfma_f32_16x16x32_bf16 v[36:39], a[36:39], a[172:175], v[36:39]
s_addc_u32 s31, s31, 0
v_mfma_f32_16x16x32_bf16 v[40:43], a[36:39], a[176:179], v[40:43]
v_mfma_f32_16x16x32_bf16 v[40:43], a[40:43], a[192:195], v[40:43]
global_load_dwordx4 a[24:27], v7, s[30:31] offset:-3072 sc1
v_mfma_f32_16x16x32_bf16 v[40:43], a[44:47], a[208:211], v[40:43]
v_mfma_f32_16x16x32_bf16 v[44:47], a[44:47], a[212:215], v[44:47]
v_mfma_f32_16x16x32_bf16 v[44:47], a[40:43], a[196:199], v[44:47]
v_mfma_f32_16x16x32_bf16 v[44:47], a[36:39], a[180:183], v[44:47]
v_mfma_f32_16x16x32_bf16 v[32:35], a[48:51], a[216:219], v[32:35]
global_load_dwordx4 a[28:31], v7, s[30:31] offset:-2048 sc1
v_mfma_f32_16x16x32_bf16 v[32:35], a[52:55], a[232:235], v[32:35]
v_mfma_f32_16x16x32_bf16 v[32:35], a[56:59], a[248:251], v[32:35]
v_mfma_f32_16x16x32_bf16 v[36:39], a[56:59], a[252:255], v[36:39]
v_mfma_f32_16x16x32_bf16 v[36:39], a[52:55], a[236:239], v[36:39]
global_load_dwordx4 a[32:35], v7, s[30:31] offset:-1024 sc1
v_mfma_f32_16x16x32_bf16 v[36:39], a[48:51], a[220:223], v[36:39]
v_mfma_f32_16x16x32_bf16 v[40:43], a[48:51], a[224:227], v[40:43]
v_mfma_f32_16x16x32_bf16 v[40:43], a[52:55], a[240:243], v[40:43]
v_mfma_f32_16x16x32_bf16 v[40:43], a[56:59], v[104:107], v[40:43]
v_mfma_f32_16x16x32_bf16 v[44:47], a[56:59], v[108:111], v[44:47]
global_load_dwordx4 a[36:39], v7, s[30:31] offset:0 sc1
v_mfma_f32_16x16x32_bf16 v[44:47], a[52:55], a[244:247], v[44:47]
v_mfma_f32_16x16x32_bf16 v[44:47], a[48:51], a[228:231], v[44:47]
v_mfma_f32_16x16x32_bf16 v[32:35], a[60:63], v[112:115], v[32:35]
v_mfma_f32_16x16x32_bf16 v[32:35], a[64:67], v[128:131], v[32:35]
global_load_dwordx4 a[40:43], v7, s[30:31] offset:1024 sc1
v_mfma_f32_16x16x32_bf16 v[32:35], a[68:71], v[144:147], v[32:35]
v_mfma_f32_16x16x32_bf16 v[36:39], a[68:71], v[148:151], v[36:39]
v_mfma_f32_16x16x32_bf16 v[36:39], a[64:67], v[132:135], v[36:39]
s_cmp_eq_u32 s9, 12
v_mfma_f32_16x16x32_bf16 v[36:39], a[60:63], v[116:119], v[36:39]
s_cselect_b32 s57, 13, 12
v_mfma_f32_16x16x32_bf16 v[40:43], a[60:63], v[120:123], v[40:43]
s_cmp_eq_u32 s9, 11
global_load_dwordx4 a[44:47], v7, s[30:31] offset:2048 sc1
v_mfma_f32_16x16x32_bf16 v[40:43], a[64:67], v[136:139], v[40:43]
s_cselect_b32 s57, 11, s57
s_cmp_eq_u32 s9, 14
s_cselect_b32 s6, 15, 14
s_cmp_eq_u32 s9, 13
s_cselect_b32 s6, 13, s6
s_mul_i32 s6, s6, 18432
s_add_u32 s30, s10, s6
s_addc_u32 s31, s11, 0
s_add_u32 s57, s57, s26
s_sub_u32 s57, s57, 9
s_and_b32 s57, s57, 7
s_lshl_b32 s55, s57, 9
s_lshl_b32 s57, s57, 13
s_add_u32 s57, s57, 196608
s_add_u32 s62, s58, s57
s_addc_u32 s63, s59, 0
s_add_u32 s66, s72, s55
s_addc_u32 s67, s73, 0
s_bitcmp1_b32 s25, 0
s_cbranch_scc1 L_ei_o_33
L_ei_e_34:
v_mfma_f32_16x16x32_bf16 v[40:43], a[68:71], v[152:155], v[40:43]
v_mfma_f32_16x16x32_bf16 v[44:47], a[68:71], v[156:159], v[44:47]
v_mfma_f32_16x16x32_bf16 v[44:47], a[64:67], v[140:143], v[44:47]
global_load_dwordx4 a[48:51], v7, s[30:31] offset:-3072 sc1
v_mfma_f32_16x16x32_bf16 v[44:47], a[60:63], v[124:127], v[44:47]
v_mfma_f32_16x16x32_bf16 v[32:35], a[72:75], v[160:163], v[32:35]
v_mfma_f32_16x16x32_bf16 v[32:35], a[76:79], v[176:179], v[32:35]
v_mfma_f32_16x16x32_bf16 v[32:35], a[80:83], v[192:195], v[32:35]
v_mfma_f32_16x16x32_bf16 v[36:39], a[80:83], v[196:199], v[36:39]
global_load_dwordx4 a[52:55], v7, s[30:31] offset:-2048 sc1
v_mfma_f32_16x16x32_bf16 v[36:39], a[76:79], v[180:183], v[36:39]
s_mov_b64 s[28:29], 0
s_atomic_add s28, s[78:79], 4 glc
v_mfma_f32_16x16x32_bf16 v[36:39], a[72:75], v[164:167], v[36:39]
v_mfma_f32_16x16x32_bf16 v[40:43], a[72:75], v[168:171], v[40:43]
v_mfma_f32_16x16x32_bf16 v[40:43], a[76:79], v[184:187], v[40:43]
global_load_dwordx4 a[56:59], v7, s[30:31] offset:-1024 sc1
v_mfma_f32_16x16x32_bf16 v[40:43], a[80:83], v[200:203], v[40:43]
v_mfma_f32_16x16x32_bf16 v[44:47], a[80:83], v[204:207], v[44:47]
v_mfma_f32_16x16x32_bf16 v[44:47], a[76:79], v[188:191], v[44:47]
v_mfma_f32_16x16x32_bf16 v[44:47], a[72:75], v[172:175], v[44:47]
v_mfma_f32_16x16x32_bf16 v[32:35], a[84:87], v[208:211], v[32:35]
global_load_dwordx4 a[60:63], v7, s[30:31] offset:0 sc1
v_mfma_f32_16x16x32_bf16 v[32:35], a[88:91], v[224:227], v[32:35]
v_mfma_f32_16x16x32_bf16 v[32:35], a[92:95], v[240:243], v[32:35]
v_mfma_f32_16x16x32_bf16 v[36:39], a[92:95], v[244:247], v[36:39]
v_mfma_f32_16x16x32_bf16 v[36:39], a[88:91], v[228:231], v[36:39]
global_load_dwordx4 a[64:67], v7, s[30:31] offset:1024 sc1
v_mfma_f32_16x16x32_bf16 v[36:39], a[84:87], v[212:215], v[36:39]
v_mfma_f32_16x16x32_bf16 v[40:43], a[84:87], v[216:219], v[40:43]
v_mfma_f32_16x16x32_bf16 v[40:43], a[88:91], v[232:235], v[40:43]
v_mfma_f32_16x16x32_bf16 v[40:43], a[92:95], v[248:251], v[40:43]
v_mfma_f32_16x16x32_bf16 v[44:47], a[92:95], v[252:255], v[44:47]
global_load_dwordx4 a[68:71], v7, s[30:31] offset:2048 sc1
v_mfma_f32_16x16x32_bf16 v[44:47], a[88:91], v[236:239], v[44:47]
s_add_u32 s30, s30, 0x1800
v_cvt_pk_bf16_f32 v84, v32, v33
v_cvt_pk_bf16_f32 v85, v34, v35
v_mfma_f32_16x16x32_bf16 v[44:47], a[84:87], v[220:223], v[44:47]
s_addc_u32 s31, s31, 0
v_mfma_f32_16x16x32_bf16 v[16:19], a[96:99], a[120:123], 0
v_mfma_f32_16x16x32_bf16 v[16:19], a[100:103], a[136:139], v[16:19]
s_waitcnt vmcnt(21)
global_load_dwordx4 a[72:75], v7, s[30:31] offset:-3072 sc1
v_mfma_f32_16x16x32_bf16 v[16:19], a[104:107], a[152:155], v[16:19]
v_cvt_pk_bf16_f32 v86, v36, v37
v_cvt_pk_bf16_f32 v87, v38, v39
v_mfma_f32_16x16x32_bf16 v[20:23], a[104:107], a[156:159], 0
v_mfma_f32_16x16x32_bf16 v[20:23], a[100:103], a[140:143], v[20:23]
v_cvt_pk_bf16_f32 v88, v40, v41
v_cvt_pk_bf16_f32 v89, v42, v43
v_mfma_f32_16x16x32_bf16 v[20:23], a[96:99], a[124:127], v[20:23]
v_mfma_f32_16x16x32_bf16 v[24:27], a[96:99], a[128:131], 0
global_load_dwordx4 a[76:79], v7, s[30:31] offset:-2048 sc1
v_mfma_f32_16x16x32_bf16 v[24:27], a[100:103], a[144:147], v[24:27]
v_cvt_pk_bf16_f32 v90, v44, v45
v_cvt_pk_bf16_f32 v91, v46, v47
v_mfma_f32_16x16x32_bf16 v[24:27], a[104:107], a[160:163], v[24:27]
s_cmp_eq_u32 s28, 1
s_cbranch_scc0 L_rc_s_35
L_rc_b_36:
v_mfma_f32_16x16x32_bf16 v[28:31], a[104:107], a[164:167], 0
s_bitcmp1_b32 s25, 0
s_cbranch_scc1 L_ei_o_37
global_store_dwordx4 v7, v[84:87], s[62:63] offset:0 sc1
global_store_dwordx4 v7, v[88:91], s[62:63] offset:1024 sc1
L_ei_e_38:
v_mfma_f32_16x16x32_bf16 v[28:31], a[100:103], a[148:151], v[28:31]
v_mfma_f32_16x16x32_bf16 v[28:31], a[96:99], a[132:135], v[28:31]
s_waitcnt vmcnt(22)
global_load_dwordx4 a[80:83], v7, s[30:31] offset:-1024 sc1
v_mfma_f32_16x16x32_bf16 v[16:19], a[108:111], a[168:171], v[16:19]
v_mfma_f32_16x16x32_bf16 v[16:19], a[112:115], a[184:187], v[16:19]
v_mfma_f32_16x16x32_bf16 v[16:19], a[116:119], a[200:203], v[16:19]
v_mfma_f32_16x16x32_bf16 v[20:23], a[116:119], a[204:207], v[20:23]
s_waitcnt vmcnt(11)
global_load_dwordx4 a[84:87], v7, s[30:31] offset:0 sc1
v_mfma_f32_16x16x32_bf16 v[20:23], a[112:115], a[188:191], v[20:23]
s_atomic_add s54, s[64:65], 8
v_mfma_f32_16x16x32_bf16 v[20:23], a[108:111], a[172:175], v[20:23]
v_mfma_f32_16x16x32_bf16 v[24:27], a[108:111], a[176:179], v[24:27]
v_mfma_f32_16x16x32_bf16 v[24:27], a[112:115], a[192:195], v[24:27]
v_mfma_f32_16x16x32_bf16 v[24:27], a[116:119], a[208:211], v[24:27]
global_load_dwordx4 a[88:91], v7, s[30:31] offset:1024 sc1
v_mfma_f32_16x16x32_bf16 v[28:31], a[116:119], a[212:215], v[28:31]
v_mfma_f32_16x16x32_bf16 v[28:31], a[112:115], a[196:199], v[28:31]
v_mfma_f32_16x16x32_bf16 v[28:31], a[108:111], a[180:183], v[28:31]
v_mfma_f32_16x16x32_bf16 v[16:19], a[0:3], a[216:219], v[16:19]
global_load_dwordx4 a[92:95], v7, s[30:31] offset:2048 sc1
v_mfma_f32_16x16x32_bf16 v[16:19], a[4:7], a[232:235], v[16:19]
s_add_u32 s30, s30, 0x1800
v_mfma_f32_16x16x32_bf16 v[16:19], a[8:11], a[248:251], v[16:19]
s_addc_u32 s31, s31, 0
v_mfma_f32_16x16x32_bf16 v[20:23], a[8:11], a[252:255], v[20:23]
v_mfma_f32_16x16x32_bf16 v[20:23], a[4:7], a[236:239], v[20:23]
v_mfma_f32_16x16x32_bf16 v[20:23], a[0:3], a[220:223], v[20:23]
global_load_dwordx4 a[96:99], v7, s[30:31] offset:-3072 sc1
v_mfma_f32_16x16x32_bf16 v[24:27], a[0:3], a[224:227], v[24:27]
v_mfma_f32_16x16x32_bf16 v[24:27], a[4:7], a[240:243], v[24:27]
v_mfma_f32_16x16x32_bf16 v[24:27], a[8:11], v[104:107], v[24:27]
v_mfma_f32_16x16x32_bf16 v[28:31], a[8:11], v[108:111], v[28:31]
global_load_dwordx4 a[100:103], v7, s[30:31] offset:-2048 sc1
v_mfma_f32_16x16x32_bf16 v[28:31], a[4:7], a[244:247], v[28:31]
v_mfma_f32_16x16x32_bf16 v[28:31], a[0:3], a[228:231], v[28:31]
v_mfma_f32_16x16x32_bf16 v[16:19], a[12:15], v[112:115], v[16:19]
v_mfma_f32_16x16x32_bf16 v[16:19], a[16:19], v[128:131], v[16:19]
v_mfma_f32_16x16x32_bf16 v[16:19], a[20:23], v[144:147], v[16:19]
global_load_dwordx4 a[104:107], v7, s[30:31] offset:-1024 sc1
v_mfma_f32_16x16x32_bf16 v[20:23], a[20:23], v[148:151], v[20:23]
v_mfma_f32_16x16x32_bf16 v[20:23], a[16:19], v[132:135], v[20:23]
s_cmp_eq_u32 s9, 13
v_mfma_f32_16x16x32_bf16 v[20:23], a[12:15], v[116:119], v[20:23]
s_cselect_b32 s57, 14, 13
v_mfma_f32_16x16x32_bf16 v[24:27], a[12:15], v[120:123], v[24:27]
s_cmp_eq_u32 s9, 12
global_load_dwordx4 a[108:111], v7, s[30:31] offset:0 sc1
v_mfma_f32_16x16x32_bf16 v[24:27], a[16:19], v[136:139], v[24:27]
s_cselect_b32 s57, 12, s57
s_add_u32 s57, s57, s26
s_sub_u32 s57, s57, 9
s_and_b32 s57, s57, 7
s_lshl_b32 s55, s57, 9
s_lshl_b32 s57, s57, 13
s_add_u32 s57, s57, 262144
s_add_u32 s60, s58, s57
s_addc_u32 s61, s59, 0
s_add_u32 s64, s72, s55
s_addc_u32 s65, s73, 0
s_bitcmp1_b32 s25, 0
s_cbranch_scc1 L_ei_o_39
s_add_u32 s52, s52, 65536
s_addc_u32 s53, s53, 0
global_load_dwordx4 v[92:95], v7, s[52:53] offset:0 sc1
global_load_dwordx4 v[96:99], v7, s[52:53] offset:1024 sc1
L_ei_e_40:
v_mfma_f32_16x16x32_bf16 v[24:27], a[20:23], v[152:155], v[24:27]
v_mfma_f32_16x16x32_bf16 v[28:31], a[20:23], v[156:159], v[28:31]
v_mfma_f32_16x16x32_bf16 v[28:31], a[16:19], v[140:143], v[28:31]
v_mfma_f32_16x16x32_bf16 v[28:31], a[12:15], v[124:127], v[28:31]
global_load_dwordx4 a[112:115], v7, s[30:31] offset:1024 sc1
v_mfma_f32_16x16x32_bf16 v[16:19], a[24:27], v[160:163], v[16:19]
v_mfma_f32_16x16x32_bf16 v[16:19], a[28:31], v[176:179], v[16:19]
v_mfma_f32_16x16x32_bf16 v[16:19], a[32:35], v[192:195], v[16:19]
v_mfma_f32_16x16x32_bf16 v[20:23], a[32:35], v[196:199], v[20:23]
global_load_dwordx4 a[116:119], v7, s[30:31] offset:2048 sc1
v_mfma_f32_16x16x32_bf16 v[20:23], a[28:31], v[180:183], v[20:23]
s_cmp_eq_u32 s9, 15
s_mov_b64 s[28:29], 0
s_atomic_add s28, s[78:79], 8 glc
s_atomic_add s29, s[72:73], 64 glc
v_mfma_f32_16x16x32_bf16 v[20:23], a[24:27], v[164:167], v[20:23]
s_cselect_b32 s6, 16, 15
v_mfma_f32_16x16x32_bf16 v[24:27], a[24:27], v[168:171], v[24:27]
s_cmp_eq_u32 s9, 14
v_mfma_f32_16x16x32_bf16 v[24:27], a[28:31], v[184:187], v[24:27]
s_cselect_b32 s6, 14, s6
v_mfma_f32_16x16x32_bf16 v[24:27], a[32:35], v[200:203], v[24:27]
s_mul_i32 s6, s6, 18432
v_mfma_f32_16x16x32_bf16 v[28:31], a[32:35], v[204:207], v[28:31]
s_add_u32 s30, s10, s6
v_mfma_f32_16x16x32_bf16 v[28:31], a[28:31], v[188:191], v[28:31]
s_addc_u32 s31, s11, 0
global_load_dwordx4 a[0:3], v7, s[30:31] offset:-3072 sc1
v_mfma_f32_16x16x32_bf16 v[28:31], a[24:27], v[172:175], v[28:31]
v_mfma_f32_16x16x32_bf16 v[16:19], a[36:39], v[208:211], v[16:19]
v_mfma_f32_16x16x32_bf16 v[16:19], a[40:43], v[224:227], v[16:19]
global_load_dwordx4 a[4:7], v7, s[30:31] offset:-2048 sc1
v_mfma_f32_16x16x32_bf16 v[16:19], a[44:47], v[240:243], v[16:19]
v_mfma_f32_16x16x32_bf16 v[20:23], a[44:47], v[244:247], v[20:23]
v_mfma_f32_16x16x32_bf16 v[20:23], a[40:43], v[228:231], v[20:23]
v_mfma_f32_16x16x32_bf16 v[20:23], a[36:39], v[212:215], v[20:23]
global_load_dwordx4 a[8:11], v7, s[30:31] offset:-1024 sc1
v_mfma_f32_16x16x32_bf16 v[24:27], a[36:39], v[216:219], v[24:27]
v_mfma_f32_16x16x32_bf16 v[24:27], a[40:43], v[232:235], v[24:27]
v_mfma_f32_16x16x32_bf16 v[24:27], a[44:47], v[248:251], v[24:27]
v_mfma_f32_16x16x32_bf16 v[28:31], a[44:47], v[252:255], v[28:31]
global_load_dwordx4 a[12:15], v7, s[30:31] offset:0 sc1
v_mfma_f32_16x16x32_bf16 v[28:31], a[40:43], v[236:239], v[28:31]
v_cvt_pk_bf16_f32 v84, v16, v17
v_cvt_pk_bf16_f32 v85, v18, v19
v_mfma_f32_16x16x32_bf16 v[28:31], a[36:39], v[220:223], v[28:31]
s_waitcnt vmcnt(23)
v_mfma_f32_16x16x32_bf16 v[32:35], a[48:51], a[120:123], 0
v_mfma_f32_16x16x32_bf16 v[32:35], a[52:55], a[136:139], v[32:35]
v_cvt_pk_bf16_f32 v86, v20, v21
v_cvt_pk_bf16_f32 v87, v22, v23
v_mfma_f32_16x16x32_bf16 v[32:35], a[56:59], a[152:155], v[32:35]
global_load_dwordx4 a[16:19], v7, s[30:31] offset:1024 sc1
v_mfma_f32_16x16x32_bf16 v[36:39], a[56:59], a[156:159], 0
v_mfma_f32_16x16x32_bf16 v[36:39], a[52:55], a[140:143], v[36:39]
v_cvt_pk_bf16_f32 v88, v24, v25
v_cvt_pk_bf16_f32 v89, v26, v27
v_mfma_f32_16x16x32_bf16 v[36:39], a[48:51], a[124:127], v[36:39]
v_mfma_f32_16x16x32_bf16 v[40:43], a[48:51], a[128:131], 0
global_load_dwordx4 a[20:23], v7, s[30:31] offset:2048 sc1
v_mfma_f32_16x16x32_bf16 v[40:43], a[52:55], a[144:147], v[40:43]
s_add_u32 s30, s30, 0x1800
v_cvt_pk_bf16_f32 v90, v28, v29
v_cvt_pk_bf16_f32 v91, v30, v31
v_mfma_f32_16x16x32_bf16 v[40:43], a[56:59], a[160:163], v[40:43]
s_addc_u32 s31, s31, 0
s_add_u32 s41, s28, s29
s_cmp_eq_u32 s41, 9
s_cbranch_scc0 L_rc_s_41
L_rc_b_42:
v_mfma_f32_16x16x32_bf16 v[44:47], a[56:59], a[164:167], 0
s_bitcmp1_b32 s25, 0
s_cbranch_scc1 L_ei_o_43
global_store_dwordx4 v7, v[84:87], s[60:61] offset:0 sc1
global_store_dwordx4 v7, v[88:91], s[60:61] offset:1024 sc1
L_ei_e_44:
v_mfma_f32_16x16x32_bf16 v[44:47], a[52:55], a[148:151], v[44:47]
v_mfma_f32_16x16x32_bf16 v[44:47], a[48:51], a[132:135], v[44:47]
s_waitcnt vmcnt(24)
global_load_dwordx4 a[24:27], v7, s[30:31] offset:-3072 sc1
v_mfma_f32_16x16x32_bf16 v[32:35], a[60:63], a[168:171], v[32:35]
v_mfma_f32_16x16x32_bf16 v[32:35], a[64:67], a[184:187], v[32:35]
v_mfma_f32_16x16x32_bf16 v[32:35], a[68:71], a[200:203], v[32:35]
v_mfma_f32_16x16x32_bf16 v[36:39], a[68:71], a[204:207], v[36:39]
s_waitcnt vmcnt(11)
s_atomic_add s54, s[66:67], 12
v_mfma_f32_16x16x32_bf16 v[36:39], a[64:67], a[188:191], v[36:39]
global_load_dwordx4 a[28:31], v7, s[30:31] offset:-2048 sc1
v_mfma_f32_16x16x32_bf16 v[36:39], a[60:63], a[172:175], v[36:39]
v_mfma_f32_16x16x32_bf16 v[48:51], v[64:67], v[92:95], 0
v_mfma_f32_16x16x32_bf16 v[52:55], v[66:69], v[92:95], 0
v_mfma_f32_16x16x32_bf16 v[56:59], v[64:67], v[96:99], 0
v_mfma_f32_16x16x32_bf16 v[60:63], v[66:69], v[96:99], 0
v_mfma_f32_16x16x32_bf16 v[40:43], a[60:63], a[176:179], v[40:43]
v_mfma_f32_16x16x32_bf16 v[40:43], a[64:67], a[192:195], v[40:43]
v_mfma_f32_16x16x32_bf16 v[40:43], a[68:71], a[208:211], v[40:43]
global_load_dwordx4 a[32:35], v7, s[30:31] offset:-1024 sc1
v_mfma_f32_16x16x32_bf16 v[44:47], a[68:71], a[212:215], v[44:47]
v_mfma_f32_16x16x32_bf16 v[44:47], a[64:67], a[196:199], v[44:47]
v_mfma_f32_16x16x32_bf16 v[44:47], a[60:63], a[180:183], v[44:47]
v_mfma_f32_16x16x32_bf16 v[32:35], a[72:75], a[216:219], v[32:35]
v_mfma_f32_16x16x32_bf16 v[32:35], a[76:79], a[232:235], v[32:35]
global_load_dwordx4 a[36:39], v7, s[30:31] offset:0 sc1
v_mfma_f32_16x16x32_bf16 v[32:35], a[80:83], a[248:251], v[32:35]
global_load_dwordx4 v[92:95], v8, s[58:59] sc1
global_load_dwordx4 v[96:99], v13, s[58:59] sc1
v_mfma_f32_16x16x32_bf16 v[36:39], a[80:83], a[252:255], v[36:39]
v_mfma_f32_16x16x32_bf16 v[36:39], a[76:79], a[236:239], v[36:39]
v_mfma_f32_16x16x32_bf16 v[36:39], a[72:75], a[220:223], v[36:39]
global_load_dwordx4 a[40:43], v7, s[30:31] offset:1024 sc1
v_mfma_f32_16x16x32_bf16 v[40:43], a[72:75], a[224:227], v[40:43]
v_mfma_f32_16x16x32_bf16 v[40:43], a[76:79], a[240:243], v[40:43]
v_mfma_f32_16x16x32_bf16 v[40:43], a[80:83], v[104:107], v[40:43]
v_mfma_f32_16x16x32_bf16 v[44:47], a[80:83], v[108:111], v[44:47]
v_mfma_f32_16x16x32_bf16 v[44:47], a[76:79], a[244:247], v[44:47]
global_load_dwordx4 a[44:47], v7, s[30:31] offset:2048 sc1
v_mfma_f32_16x16x32_bf16 v[44:47], a[72:75], a[228:231], v[44:47]
s_add_u32 s30, s30, 0x1800
v_mfma_f32_16x16x32_bf16 v[32:35], a[84:87], v[112:115], v[32:35]
s_addc_u32 s31, s31, 0
v_mfma_f32_16x16x32_bf16 v[32:35], a[88:91], v[128:131], v[32:35]
v_mfma_f32_16x16x32_bf16 v[32:35], a[92:95], v[144:147], v[32:35]
global_load_dwordx4 a[48:51], v7, s[30:31] offset:-3072 sc1
v_mfma_f32_16x16x32_bf16 v[36:39], a[92:95], v[148:151], v[36:39]
v_mfma_f32_16x16x32_bf16 v[36:39], a[88:91], v[132:135], v[36:39]
s_cmp_eq_u32 s9, 14
v_mfma_f32_16x16x32_bf16 v[36:39], a[84:87], v[116:119], v[36:39]
s_cselect_b32 s57, 15, 14
v_mfma_f32_16x16x32_bf16 v[40:43], a[84:87], v[120:123], v[40:43]
s_cmp_eq_u32 s9, 13
v_mfma_f32_16x16x32_bf16 v[40:43], a[88:91], v[136:139], v[40:43]
s_cselect_b32 s57, 13, s57
global_load_dwordx4 a[52:55], v7, s[30:31] offset:-2048 sc1
v_mfma_f32_16x16x32_bf16 v[40:43], a[92:95], v[152:155], v[40:43]
s_add_u32 s57, s57, s26
s_sub_u32 s57, s57, 9
s_and_b32 s57, s57, 7
s_lshl_b32 s55, s57, 9
s_lshl_b32 s57, s57, 13
s_add_u32 s57, s57, 327680
s_add_u32 s62, s58, s57
s_addc_u32 s63, s59, 0
s_add_u32 s66, s72, s55
s_addc_u32 s67, s73, 0
s_bitcmp1_b32 s25, 0
s_cbranch_scc1 L_ei_o_45
s_add_u32 s52, s52, 65536
s_addc_u32 s53, s53, 0
global_load_dwordx4 v[70:73], v7, s[52:53] offset:0 sc1
global_load_dwordx4 v[74:77], v7, s[52:53] offset:1024 sc1
L_ei_e_46:
v_mfma_f32_16x16x32_bf16 v[44:47], a[92:95], v[156:159], v[44:47]
v_mfma_f32_16x16x32_bf16 v[44:47], a[88:91], v[140:143], v[44:47]
v_mfma_f32_16x16x32_bf16 v[44:47], a[84:87], v[124:127], v[44:47]
global_load_dwordx4 a[56:59], v7, s[30:31] offset:-1024 sc1
v_mfma_f32_16x16x32_bf16 v[32:35], a[96:99], v[160:163], v[32:35]
v_mfma_f32_16x16x32_bf16 v[32:35], a[100:103], v[176:179], v[32:35]
v_mfma_f32_16x16x32_bf16 v[32:35], a[104:107], v[192:195], v[32:35]
v_mfma_f32_16x16x32_bf16 v[36:39], a[104:107], v[196:199], v[36:39]
s_mov_b64 s[28:29], 0
s_atomic_add s28, s[78:79], 12 glc
v_mfma_f32_16x16x32_bf16 v[36:39], a[100:103], v[180:183], v[36:39]
global_load_dwordx4 a[60:63], v7, s[30:31] offset:0 sc1
v_mfma_f32_16x16x32_bf16 v[36:39], a[96:99], v[164:167], v[36:39]
v_mfma_f32_16x16x32_bf16 v[40:43], a[96:99], v[168:171], v[40:43]
v_mfma_f32_16x16x32_bf16 v[40:43], a[100:103], v[184:187], v[40:43]
v_mfma_f32_16x16x32_bf16 v[40:43], a[104:107], v[200:203], v[40:43]
global_load_dwordx4 a[64:67], v7, s[30:31] offset:1024 sc1
v_mfma_f32_16x16x32_bf16 v[44:47], a[104:107], v[204:207], v[44:47]
v_mfma_f32_16x16x32_bf16 v[44:47], a[100:103], v[188:191], v[44:47]
v_mfma_f32_16x16x32_bf16 v[44:47], a[96:99], v[172:175], v[44:47]
v_mfma_f32_16x16x32_bf16 v[32:35], a[108:111], v[208:211], v[32:35]
s_waitcnt vmcnt(23)
v_mfma_f32_16x16x32_bf16 v[32:35], a[112:115], v[224:227], v[32:35]
global_load_dwordx4 a[68:71], v7, s[30:31] offset:2048 sc1
v_mfma_f32_16x16x32_bf16 v[32:35], a[116:119], v[240:243], v[32:35]
s_cmp_eq_u32 s9, 16
v_mfma_f32_16x16x32_bf16 v[36:39], a[116:119], v[244:247], v[36:39]
s_cselect_b32 s6, 17, 16
v_mfma_f32_16x16x32_bf16 v[36:39], a[112:115], v[228:231], v[36:39]
s_cmp_eq_u32 s9, 15
v_mfma_f32_16x16x32_bf16 v[36:39], a[108:111], v[212:215], v[36:39]
s_cselect_b32 s6, 15, s6
v_mfma_f32_16x16x32_bf16 v[40:43], a[108:111], v[216:219], v[40:43]
s_mul_i32 s6, s6, 18432
v_mfma_f32_16x16x32_bf16 v[40:43], a[112:115], v[232:235], v[40:43]
s_add_u32 s30, s10, s6
v_mfma_f32_16x16x32_bf16 v[40:43], a[116:119], v[248:251], v[40:43]
s_addc_u32 s31, s11, 0
global_load_dwordx4 a[72:75], v7, s[30:31] offset:-3072 sc1
v_mfma_f32_16x16x32_bf16 v[44:47], a[116:119], v[252:255], v[44:47]
s_waitcnt vmcnt(11)
v_mfma_f32_16x16x32_bf16 v[78:81], v[64:67], v[92:95], 0
v_mfma_f32_16x16x32_bf16 v[78:81], v[64:67], v[96:99], v[78:81]
v_mfma_f32_16x16x32_bf16 v[100:103], v[66:69], v[92:95], 0
v_mfma_f32_16x16x32_bf16 v[100:103], v[66:69], v[96:99], v[100:103]
v_mfma_f32_16x16x32_bf16 v[44:47], a[112:115], v[236:239], v[44:47]
v_cvt_pk_bf16_f32 v84, v32, v33
v_cvt_pk_bf16_f32 v85, v34, v35
v_mfma_f32_16x16x32_bf16 v[44:47], a[108:111], v[220:223], v[44:47]
global_load_dwordx4 a[76:79], v7, s[30:31] offset:-2048 sc1
v_mfma_f32_16x16x32_bf16 v[16:19], a[0:3], a[120:123], 0
v_mfma_f32_16x16x32_bf16 v[16:19], a[4:7], a[136:139], v[16:19]
v_cvt_pk_bf16_f32 v86, v36, v37
v_cvt_pk_bf16_f32 v87, v38, v39
v_mfma_f32_16x16x32_bf16 v[16:19], a[8:11], a[152:155], v[16:19]
global_load_dwordx4 a[80:83], v7, s[30:31] offset:-1024 sc1
v_mfma_f32_16x16x32_bf16 v[20:23], a[8:11], a[156:159], 0
v_mfma_f32_16x16x32_bf16 v[20:23], a[4:7], a[140:143], v[20:23]
v_cvt_pk_bf16_f32 v88, v40, v41
v_cvt_pk_bf16_f32 v89, v42, v43
v_mfma_f32_16x16x32_bf16 v[20:23], a[0:3], a[124:127], v[20:23]
v_mfma_f32_16x16x32_bf16 v[24:27], a[0:3], a[128:131], 0
v_mfma_f32_16x16x32_bf16 v[24:27], a[4:7], a[144:147], v[24:27]
global_load_dwordx4 a[84:87], v7, s[30:31] offset:0 sc1
v_mfma_f32_16x16x32_bf16 v[24:27], a[8:11], a[160:163], v[24:27]
v_cvt_pk_bf16_f32 v90, v44, v45
v_cvt_pk_bf16_f32 v91, v46, v47
v_mfma_f32_16x16x32_bf16 v[28:31], a[8:11], a[164:167], 0
s_cmp_eq_u32 s28, 1
s_cbranch_scc0 L_rc_s_47
L_rc_b_48:
v_mfma_f32_16x16x32_bf16 v[28:31], a[4:7], a[148:151], v[28:31]
s_bitcmp1_b32 s25, 0
s_cbranch_scc1 L_ei_o_49
global_store_dwordx4 v7, v[84:87], s[62:63] offset:0 sc1
global_store_dwordx4 v7, v[88:91], s[62:63] offset:1024 sc1
L_ei_e_50:
v_mfma_f32_16x16x32_bf16 v[28:31], a[0:3], a[132:135], v[28:31]
v_mfma_f32_16x16x32_bf16 v[16:19], a[12:15], a[168:171], v[16:19]
global_load_dwordx4 a[88:91], v7, s[30:31] offset:1024 sc1
v_mfma_f32_16x16x32_bf16 v[16:19], a[16:19], a[184:187], v[16:19]
v_mfma_f32_16x16x32_bf16 v[16:19], a[20:23], a[200:203], v[16:19]
v_mfma_f32_16x16x32_bf16 v[20:23], a[20:23], a[204:207], v[20:23]
s_waitcnt vmcnt(11)
s_atomic_add s54, s[64:65], 16
v_mfma_f32_16x16x32_bf16 v[20:23], a[16:19], a[188:191], v[20:23]
global_load_dwordx4 a[92:95], v7, s[30:31] offset:2048 sc1
v_mfma_f32_16x16x32_bf16 v[20:23], a[12:15], a[172:175], v[20:23]
s_add_u32 s30, s30, 0x1800
v_mfma_f32_16x16x32_bf16 v[48:51], v[64:67], v[70:73], v[48:51]
v_mfma_f32_16x16x32_bf16 v[52:55], v[66:69], v[70:73], v[52:55]
v_mfma_f32_16x16x32_bf16 v[56:59], v[64:67], v[74:77], v[56:59]
v_mfma_f32_16x16x32_bf16 v[60:63], v[66:69], v[74:77], v[60:63]
v_mfma_f32_16x16x32_bf16 v[24:27], a[12:15], a[176:179], v[24:27]
s_addc_u32 s31, s31, 0
v_mfma_f32_16x16x32_bf16 v[24:27], a[16:19], a[192:195], v[24:27]
v_mfma_f32_16x16x32_bf16 v[24:27], a[20:23], a[208:211], v[24:27]
v_mfma_f32_16x16x32_bf16 v[28:31], a[20:23], a[212:215], v[28:31]
global_load_dwordx4 a[96:99], v7, s[30:31] offset:-3072 sc1
v_mfma_f32_16x16x32_bf16 v[28:31], a[16:19], a[196:199], v[28:31]
v_mfma_f32_16x16x32_bf16 v[28:31], a[12:15], a[180:183], v[28:31]
v_mfma_f32_16x16x32_bf16 v[16:19], a[24:27], a[216:219], v[16:19]
v_mfma_f32_16x16x32_bf16 v[16:19], a[28:31], a[232:235], v[16:19]
global_load_dwordx4 a[100:103], v7, s[30:31] offset:-2048 sc1
v_mfma_f32_16x16x32_bf16 v[16:19], a[32:35], a[248:251], v[16:19]
v_mfma_f32_16x16x32_bf16 v[20:23], a[32:35], a[252:255], v[20:23]
v_mfma_f32_16x16x32_bf16 v[20:23], a[28:31], a[236:239], v[20:23]
v_mfma_f32_16x16x32_bf16 v[20:23], a[24:27], a[220:223], v[20:23]
v_mfma_f32_16x16x32_bf16 v[24:27], a[24:27], a[224:227], v[24:27]
global_load_dwordx4 a[104:107], v7, s[30:31] offset:-1024 sc1
v_mfma_f32_16x16x32_bf16 v[24:27], a[28:31], a[240:243], v[24:27]
v_mfma_f32_16x16x32_bf16 v[24:27], a[32:35], v[104:107], v[24:27]
v_mfma_f32_16x16x32_bf16 v[28:31], a[32:35], v[108:111], v[28:31]
v_mfma_f32_16x16x32_bf16 v[28:31], a[28:31], a[244:247], v[28:31]
global_load_dwordx4 a[108:111], v7, s[30:31] offset:0 sc1
v_mfma_f32_16x16x32_bf16 v[28:31], a[24:27], a[228:231], v[28:31]
v_mfma_f32_16x16x32_bf16 v[16:19], a[36:39], v[112:115], v[16:19]
v_mfma_f32_16x16x32_bf16 v[16:19], a[40:43], v[128:131], v[16:19]
v_mfma_f32_16x16x32_bf16 v[16:19], a[44:47], v[144:147], v[16:19]
v_mfma_f32_16x16x32_bf16 v[20:23], a[44:47], v[148:151], v[20:23]
global_load_dwordx4 a[112:115], v7, s[30:31] offset:1024 sc1
v_mfma_f32_16x16x32_bf16 v[20:23], a[40:43], v[132:135], v[20:23]
s_cmp_eq_u32 s9, 15
v_mfma_f32_16x16x32_bf16 v[20:23], a[36:39], v[116:119], v[20:23]
s_cselect_b32 s57, 16, 15
v_mfma_f32_16x16x32_bf16 v[24:27], a[36:39], v[120:123], v[24:27]
s_cmp_eq_u32 s9, 14
v_mfma_f32_16x16x32_bf16 v[24:27], a[40:43], v[136:139], v[24:27]
s_cselect_b32 s57, 14, s57
global_load_dwordx4 a[116:119], v7, s[30:31] offset:2048 sc1
v_mfma_f32_16x16x32_bf16 v[24:27], a[44:47], v[152:155], v[24:27]
s_add_u32 s30, s30, 0x1800
s_addc_u32 s31, s31, 0
s_add_u32 s57, s57, s26
s_sub_u32 s57, s57, 9
s_and_b32 s57, s57, 7
s_lshl_b32 s55, s57, 9
s_lshl_b32 s57, s57, 13
s_add_u32 s57, s57, 393216
s_add_u32 s60, s58, s57
s_addc_u32 s61, s59, 0
s_add_u32 s64, s72, s55
s_addc_u32 s65, s73, 0
s_bitcmp1_b32 s25, 0
s_cbranch_scc1 L_ei_o_51
s_add_u32 s52, s52, 65536
s_addc_u32 s53, s53, 0
global_load_dwordx4 v[92:95], v7, s[52:53] offset:0 sc1
global_load_dwordx4 v[96:99], v7, s[52:53] offset:1024 sc1
L_ei_e_52:
v_mfma_f32_16x16x32_bf16 v[28:31], a[44:47], v[156:159], v[28:31]
v_mfma_f32_16x16x32_bf16 v[28:31], a[40:43], v[140:143], v[28:31]
v_mfma_f32_16x16x32_bf16 v[28:31], a[36:39], v[124:127], v[28:31]
v_mfma_f32_16x16x32_bf16 v[16:19], a[48:51], v[160:163], v[16:19]
global_load_dwordx4 a[0:3], v7, s[30:31] offset:-3072 sc1
v_mfma_f32_16x16x32_bf16 v[16:19], a[52:55], v[176:179], v[16:19]
s_waitcnt vmcnt(20)
v_mfma_f32_16x16x32_bf16 v[16:19], a[56:59], v[192:195], v[16:19]
v_mfma_f32_16x16x32_bf16 v[20:23], a[56:59], v[196:199], v[20:23]
s_mov_b64 s[28:29], 0
s_atomic_add s28, s[78:79], 16 glc
v_mfma_f32_16x16x32_bf16 v[20:23], a[52:55], v[180:183], v[20:23]
global_load_dwordx4 a[4:7], v7, s[30:31] offset:-2048 sc1
v_mfma_f32_16x16x32_bf16 v[20:23], a[48:51], v[164:167], v[20:23]
v_mfma_f32_16x16x32_bf16 v[24:27], a[48:51], v[168:171], v[24:27]
v_mfma_f32_16x16x32_bf16 v[24:27], a[52:55], v[184:187], v[24:27]
v_mfma_f32_16x16x32_bf16 v[24:27], a[56:59], v[200:203], v[24:27]
v_mfma_f32_16x16x32_bf16 v[28:31], a[56:59], v[204:207], v[28:31]
global_load_dwordx4 a[8:11], v7, s[30:31] offset:-1024 sc1
v_mfma_f32_16x16x32_bf16 v[28:31], a[52:55], v[188:191], v[28:31]
v_mfma_f32_16x16x32_bf16 v[28:31], a[48:51], v[172:175], v[28:31]
s_waitcnt vmcnt(19)
v_mfma_f32_16x16x32_bf16 v[16:19], a[60:63], v[208:211], v[16:19]
v_mfma_f32_16x16x32_bf16 v[16:19], a[64:67], v[224:227], v[16:19]
global_load_dwordx4 a[12:15], v7, s[30:31] offset:0 sc1
v_mfma_f32_16x16x32_bf16 v[16:19], a[68:71], v[240:243], v[16:19]
v_mfma_f32_16x16x32_bf16 v[20:23], a[68:71], v[244:247], v[20:23]
v_mfma_f32_16x16x32_bf16 v[20:23], a[64:67], v[228:231], v[20:23]
v_mfma_f32_16x16x32_bf16 v[20:23], a[60:63], v[212:215], v[20:23]
v_mfma_f32_16x16x32_bf16 v[24:27], a[60:63], v[216:219], v[24:27]
global_load_dwordx4 a[16:19], v7, s[30:31] offset:1024 sc1
v_mfma_f32_16x16x32_bf16 v[24:27], a[64:67], v[232:235], v[24:27]
v_mfma_f32_16x16x32_bf16 v[24:27], a[68:71], v[248:251], v[24:27]
v_mfma_f32_16x16x32_bf16 v[28:31], a[68:71], v[252:255], v[28:31]
v_mfma_f32_16x16x32_bf16 v[28:31], a[64:67], v[236:239], v[28:31]
global_load_dwordx4 a[20:23], v7, s[30:31] offset:2048 sc1
v_mfma_f32_16x16x32_bf16 v[28:31], a[60:63], v[220:223], v[28:31]
s_waitcnt vmcnt(19)
v_cvt_pk_bf16_f32 v84, v16, v17
v_cvt_pk_bf16_f32 v85, v18, v19
v_mfma_f32_16x16x32_bf16 v[32:35], a[72:75], a[120:123], 0
s_cmp_eq_u32 s9, 17
v_mfma_f32_16x16x32_bf16 v[32:35], a[76:79], a[136:139], v[32:35]
s_cselect_b32 s6, 18, 17
v_cvt_pk_bf16_f32 v86, v20, v21
v_cvt_pk_bf16_f32 v87, v22, v23
v_mfma_f32_16x16x32_bf16 v[32:35], a[80:83], a[152:155], v[32:35]
s_cmp_eq_u32 s9, 16
v_mfma_f32_16x16x32_bf16 v[36:39], a[80:83], a[156:159], 0
s_cselect_b32 s6, 16, s6
v_mfma_f32_16x16x32_bf16 v[36:39], a[76:79], a[140:143], v[36:39]
s_mul_i32 s6, s6, 18432
v_cvt_pk_bf16_f32 v88, v24, v25
v_cvt_pk_bf16_f32 v89, v26, v27
v_mfma_f32_16x16x32_bf16 v[36:39], a[72:75], a[124:127], v[36:39]
s_add_u32 s30, s10, s6
v_mfma_f32_16x16x32_bf16 v[40:43], a[72:75], a[128:131], 0
s_addc_u32 s31, s11, 0
global_load_dwordx4 a[24:27], v7, s[30:31] offset:-3072 sc1
v_mfma_f32_16x16x32_bf16 v[40:43], a[76:79], a[144:147], v[40:43]
v_cvt_pk_bf16_f32 v90, v28, v29
v_cvt_pk_bf16_f32 v91, v30, v31
v_mfma_f32_16x16x32_bf16 v[40:43], a[80:83], a[160:163], v[40:43]
s_cmp_eq_u32 s28, 1
s_cbranch_scc0 L_rc_s_53
L_rc_b_54:
v_mfma_f32_16x16x32_bf16 v[44:47], a[80:83], a[164:167], 0
global_load_dwordx4 a[28:31], v7, s[30:31] offset:-2048 sc1
v_mfma_f32_16x16x32_bf16 v[44:47], a[76:79], a[148:151], v[44:47]
global_store_dwordx4 v7, v[84:87], s[60:61] offset:0 sc1
global_store_dwordx4 v7, v[88:91], s[60:61] offset:1024 sc1
v_mfma_f32_16x16x32_bf16 v[44:47], a[72:75], a[132:135], v[44:47]
s_waitcnt vmcnt(18)
v_mfma_f32_16x16x32_bf16 v[32:35], a[84:87], a[168:171], v[32:35]
global_load_dwordx4 a[32:35], v7, s[30:31] offset:-1024 sc1
v_mfma_f32_16x16x32_bf16 v[32:35], a[88:91], a[184:187], v[32:35]
v_mfma_f32_16x16x32_bf16 v[32:35], a[92:95], a[200:203], v[32:35]
v_mfma_f32_16x16x32_bf16 v[36:39], a[92:95], a[204:207], v[36:39]
s_waitcnt vmcnt(11)
s_atomic_add s54, s[66:67], 20
v_mfma_f32_16x16x32_bf16 v[36:39], a[88:91], a[188:191], v[36:39]
v_mfma_f32_16x16x32_bf16 v[48:51], v[64:67], v[92:95], v[48:51]
v_mfma_f32_16x16x32_bf16 v[52:55], v[66:69], v[92:95], v[52:55]
v_mfma_f32_16x16x32_bf16 v[56:59], v[64:67], v[96:99], v[56:59]
v_mfma_f32_16x16x32_bf16 v[60:63], v[66:69], v[96:99], v[60:63]
v_mfma_f32_16x16x32_bf16 v[36:39], a[84:87], a[172:175], v[36:39]
global_load_dwordx4 a[36:39], v7, s[30:31] offset:0 sc1
v_mfma_f32_16x16x32_bf16 v[40:43], a[84:87], a[176:179], v[40:43]
v_mfma_f32_16x16x32_bf16 v[40:43], a[88:91], a[192:195], v[40:43]
v_mfma_f32_16x16x32_bf16 v[40:43], a[92:95], a[208:211], v[40:43]
v_mfma_f32_16x16x32_bf16 v[44:47], a[92:95], a[212:215], v[44:47]
global_load_dwordx4 a[40:43], v7, s[30:31] offset:1024 sc1
v_mfma_f32_16x16x32_bf16 v[44:47], a[88:91], a[196:199], v[44:47]
v_mfma_f32_16x16x32_bf16 v[44:47], a[84:87], a[180:183], v[44:47]
v_mfma_f32_16x16x32_bf16 v[32:35], a[96:99], a[216:219], v[32:35]
v_mfma_f32_16x16x32_bf16 v[32:35], a[100:103], a[232:235], v[32:35]
v_mfma_f32_16x16x32_bf16 v[32:35], a[104:107], a[248:251], v[32:35]
global_load_dwordx4 a[44:47], v7, s[30:31] offset:2048 sc1
v_mfma_f32_16x16x32_bf16 v[36:39], a[104:107], a[252:255], v[36:39]
s_add_u32 s30, s30, 0x1800
v_mfma_f32_16x16x32_bf16 v[36:39], a[100:103], a[236:239], v[36:39]
s_addc_u32 s31, s31, 0
v_mfma_f32_16x16x32_bf16 v[36:39], a[96:99], a[220:223], v[36:39]
v_mfma_f32_16x16x32_bf16 v[40:43], a[96:99], a[224:227], v[40:43]
global_load_dwordx4 a[48:51], v7, s[30:31] offset:-3072 sc1
v_mfma_f32_16x16x32_bf16 v[40:43], a[100:103], a[240:243], v[40:43]
v_mfma_f32_16x16x32_bf16 v[40:43], a[104:107], v[104:107], v[40:43]
v_mfma_f32_16x16x32_bf16 v[44:47], a[104:107], v[108:111], v[44:47]
v_mfma_f32_16x16x32_bf16 v[44:47], a[100:103], a[244:247], v[44:47]
v_mfma_f32_16x16x32_bf16 v[44:47], a[96:99], a[228:231], v[44:47]
global_load_dwordx4 a[52:55], v7, s[30:31] offset:-2048 sc1
v_mfma_f32_16x16x32_bf16 v[32:35], a[108:111], v[112:115], v[32:35]
v_mfma_f32_16x16x32_bf16 v[32:35], a[112:115], v[128:131], v[32:35]
v_mfma_f32_16x16x32_bf16 v[32:35], a[116:119], v[144:147], v[32:35]
v_mfma_f32_16x16x32_bf16 v[36:39], a[116:119], v[148:151], v[36:39]
global_load_dwordx4 a[56:59], v7, s[30:31] offset:-1024 sc1
v_mfma_f32_16x16x32_bf16 v[36:39], a[112:115], v[132:135], v[36:39]
s_cmp_eq_u32 s9, 16
v_mfma_f32_16x16x32_bf16 v[36:39], a[108:111], v[116:119], v[36:39]
s_cselect_b32 s57, 17, 16
v_mfma_f32_16x16x32_bf16 v[40:43], a[108:111], v[120:123], v[40:43]
s_cmp_eq_u32 s9, 15
v_mfma_f32_16x16x32_bf16 v[40:43], a[112:115], v[136:139], v[40:43]
s_cselect_b32 s57, 15, s57
s_add_u32 s57, s57, s26
s_sub_u32 s57, s57, 9
s_and_b32 s57, s57, 7
s_lshl_b32 s55, s57, 9
s_lshl_b32 s57, s57, 13
s_add_u32 s57, s57, 458752
s_add_u32 s62, s58, s57
s_addc_u32 s63, s59, 0
s_add_u32 s66, s72, s55
s_addc_u32 s67, s73, 0
s_add_u32 s52, s52, 65536
s_addc_u32 s53, s53, 0
global_load_dwordx4 v[70:73], v7, s[52:53] offset:0 sc1
global_load_dwordx4 v[74:77], v7, s[52:53] offset:1024 sc1
v_mfma_f32_16x16x32_bf16 v[40:43], a[116:119], v[152:155], v[40:43]
global_load_dwordx4 a[60:63], v7, s[30:31] offset:0 sc1
v_mfma_f32_16x16x32_bf16 v[44:47], a[116:119], v[156:159], v[44:47]
v_mfma_f32_16x16x32_bf16 v[44:47], a[112:115], v[140:143], v[44:47]
s_cmp_eq_u32 s3, 0
v_mfma_f32_16x16x32_bf16 v[44:47], a[108:111], v[124:127], v[44:47]
s_waitcnt vmcnt(17)
v_mfma_f32_16x16x32_bf16 v[32:35], a[0:3], v[160:163], v[32:35]
s_cselect_b32 s74, 0x100, 16
global_load_dwordx4 a[64:67], v7, s[30:31] offset:1024 sc1
v_mfma_f32_16x16x32_bf16 v[32:35], a[4:7], v[176:179], v[32:35]
s_cselect_b32 s75, 16, 0x900
v_mfma_f32_16x16x32_bf16 v[32:35], a[8:11], v[192:195], v[32:35]
s_cselect_b32 s76, 13770752, 0
v_mfma_f32_16x16x32_bf16 v[36:39], a[8:11], v[196:199], v[36:39]
s_waitcnt vmcnt(11)
s_atomic_add s54, s[64:65], 24
v_mfma_f32_16x16x32_bf16 v[36:39], a[4:7], v[180:183], v[36:39]
s_cselect_b32 s43, 1, 9
s_mov_b64 s[28:29], 0
s_atomic_add s28, s[78:79], 20 glc
v_mfma_f32_16x16x32_bf16 v[36:39], a[0:3], v[164:167], v[36:39]
s_lshl_b32 s43, s43, 7
global_load_dwordx4 a[68:71], v7, s[30:31] offset:2048 sc1
v_mfma_f32_16x16x32_bf16 v[40:43], a[0:3], v[168:171], v[40:43]
s_add_u32 s30, s30, 0x1800
v_mfma_f32_16x16x32_bf16 v[40:43], a[4:7], v[184:187], v[40:43]
s_addc_u32 s31, s31, 0
ds_read_b64 v[16:17], v9
ds_read_b64 v[18:19], v9 offset:18432
v_mfma_f32_16x16x32_bf16 v[40:43], a[8:11], v[200:203], v[40:43]
s_mul_i32 s55, s25, 73728
ds_read_b64 v[20:21], v9 offset:36864
ds_read_b64 v[22:23], v9 offset:55296
v_mfma_f32_16x16x32_bf16 v[44:47], a[8:11], v[204:207], v[44:47]
s_add_u32 s76, s76, s55
global_load_dwordx4 a[72:75], v7, s[30:31] offset:-3072 sc1
v_mfma_f32_16x16x32_bf16 v[44:47], a[4:7], v[188:191], v[44:47]
s_lshl_b32 s55, s24, 1
ds_read_b64 v[24:25], v10
v_mfma_f32_16x16x32_bf16 v[44:47], a[0:3], v[172:175], v[44:47]
s_mul_i32 s55, s55, s74
v_mfma_f32_16x16x32_bf16 v[32:35], a[12:15], v[208:211], v[32:35]
s_add_u32 s76, s76, s55
v_mfma_f32_16x16x32_bf16 v[32:35], a[16:19], v[224:227], v[32:35]
s_lshr_b32 s77, s26, 2
v_mfma_f32_16x16x32_bf16 v[32:35], a[20:23], v[240:243], v[32:35]
s_mul_i32 s77, s77, s43
global_load_dwordx4 a[76:79], v7, s[30:31] offset:-2048 sc1
v_mfma_f32_16x16x32_bf16 v[36:39], a[20:23], v[244:247], v[36:39]
s_add_u32 s77, s77, s76
v_mfma_f32_16x16x32_bf16 v[36:39], a[16:19], v[228:231], v[36:39]
s_lshl_b32 s55, s74, 6
v_mfma_f32_16x16x32_bf16 v[36:39], a[12:15], v[212:215], v[36:39]
s_add_u32 s77, s77, s55
v_mfma_f32_16x16x32_bf16 v[40:43], a[12:15], v[216:219], v[40:43]
s_mul_i32 s55, s74, s26
global_load_dwordx4 a[80:83], v7, s[30:31] offset:-1024 sc1
v_mfma_f32_16x16x32_bf16 v[40:43], a[16:19], v[232:235], v[40:43]
s_lshl_b32 s55, s55, 3
v_mfma_f32_16x16x32_bf16 v[40:43], a[20:23], v[248:251], v[40:43]
s_add_u32 s76, s76, s55
v_mfma_f32_16x16x32_bf16 v[44:47], a[20:23], v[252:255], v[44:47]
s_mov_b32 s56, 0x3f317218
v_mfma_f32_16x16x32_bf16 v[44:47], a[16:19], v[236:239], v[44:47]
v_cvt_pk_bf16_f32 v84, v32, v33
v_cvt_pk_bf16_f32 v85, v34, v35
v_mfma_f32_16x16x32_bf16 v[44:47], a[12:15], v[220:223], v[44:47]
global_load_dwordx4 a[84:87], v7, s[30:31] offset:0 sc1
v_mfma_f32_16x16x32_bf16 v[48:51], a[24:27], a[120:123], v[48:51]
v_mfma_f32_16x16x32_bf16 v[48:51], a[28:31], a[136:139], v[48:51]
s_waitcnt vmcnt(15)
v_cvt_pk_bf16_f32 v86, v36, v37
v_cvt_pk_bf16_f32 v87, v38, v39
v_mfma_f32_16x16x32_bf16 v[48:51], a[32:35], a[152:155], v[48:51]
v_mfma_f32_16x16x32_bf16 v[52:55], a[32:35], a[156:159], v[52:55]
global_load_dwordx4 a[88:91], v7, s[30:31] offset:1024 sc1
v_mfma_f32_16x16x32_bf16 v[52:55], a[28:31], a[140:143], v[52:55]
v_cvt_pk_bf16_f32 v88, v40, v41
v_cvt_pk_bf16_f32 v89, v42, v43
v_mfma_f32_16x16x32_bf16 v[52:55], a[24:27], a[124:127], v[52:55]
v_mfma_f32_16x16x32_bf16 v[56:59], a[24:27], a[128:131], v[56:59]
v_mfma_f32_16x16x32_bf16 v[56:59], a[28:31], a[144:147], v[56:59]
v_cvt_pk_bf16_f32 v90, v44, v45
v_cvt_pk_bf16_f32 v91, v46, v47
v_mfma_f32_16x16x32_bf16 v[56:59], a[32:35], a[160:163], v[56:59]
global_load_dwordx4 a[92:95], v7, s[30:31] offset:2048 sc1
v_mfma_f32_16x16x32_bf16 v[60:63], a[32:35], a[164:167], v[60:63]
s_lshl_b32 s55, s26, 2
s_add_u32 s55, s55, s24
s_mul_i32 s55, s55, 73728
s_add_u32 s55, s55, 4096
s_add_u32 s30, s22, s55
s_addc_u32 s31, s23, 0
s_waitcnt lgkmcnt(0)
s_cmp_eq_u32 s28, 1
s_cbranch_scc0 L_rc_s_55
L_rc_b_56:
v_mfma_f32_16x16x32_bf16 v[60:63], a[28:31], a[148:151], v[60:63]
global_store_dwordx4 v7, v[84:87], s[62:63] offset:0 sc1
global_store_dwordx4 v7, v[88:91], s[62:63] offset:1024 sc1
v_mfma_f32_16x16x32_bf16 v[60:63], a[24:27], a[132:135], v[60:63]
s_waitcnt vmcnt(16)
s_add_u32 s52, s52, 65536
s_addc_u32 s53, s53, 0
global_load_dwordx4 v[92:95], v7, s[52:53] offset:0 sc1
global_load_dwordx4 v[96:99], v7, s[52:53] offset:1024 sc1
v_mfma_f32_16x16x32_bf16 v[48:51], a[36:39], a[168:171], v[48:51]
s_mov_b64 s[28:29], 0
s_atomic_add s28, s[78:79], 24 glc
v_mfma_f32_16x16x32_bf16 v[48:51], a[40:43], a[184:187], v[48:51]
v_mfma_f32_16x16x32_bf16 v[48:51], a[44:47], a[200:203], v[48:51]
v_mfma_f32_16x16x32_bf16 v[52:55], a[44:47], a[204:207], v[52:55]
s_waitcnt vmcnt(13)
v_mfma_f32_16x16x32_bf16 v[48:51], v[64:67], v[70:73], v[48:51]
v_mfma_f32_16x16x32_bf16 v[52:55], v[66:69], v[70:73], v[52:55]
v_mfma_f32_16x16x32_bf16 v[56:59], v[64:67], v[74:77], v[56:59]
v_mfma_f32_16x16x32_bf16 v[60:63], v[66:69], v[74:77], v[60:63]
v_mfma_f32_16x16x32_bf16 v[52:55], a[40:43], a[188:191], v[52:55]
v_lshrrev_b32 v3, 1, v5
v_and_b32 v4, 7, v6
v_mfma_f32_16x16x32_bf16 v[52:55], a[36:39], a[172:175], v[52:55]
v_mul_u32_u24 v3, s74, v3
v_mul_u32_u24 v4, s75, v4
v_mfma_f32_16x16x32_bf16 v[56:59], a[36:39], a[176:179], v[56:59]
v_lshl_add_u32 v11, v11, 1, v3
v_lshrrev_b32 v2, 3, v6
v_mfma_f32_16x16x32_bf16 v[56:59], a[40:43], a[192:195], v[56:59]
v_lshl_add_u32 v14, v14, 1, v3
v_mul_u32_u24 v2, 18432, v2
v_mfma_f32_16x16x32_bf16 v[56:59], a[44:47], a[208:211], v[56:59]
v_and_b32 v8, 7, v15
v_add3_u32 v11, v11, v2, v4
v_mfma_f32_16x16x32_bf16 v[60:63], a[44:47], a[212:215], v[60:63]
v_lshrrev_b32 v2, 3, v15
v_mul_u32_u24 v8, s75, v8
v_mfma_f32_16x16x32_bf16 v[60:63], a[40:43], a[196:199], v[60:63]
v_mul_u32_u24 v2, 18432, v2
v_add_u32 v11, s76, v11
v_mfma_f32_16x16x32_bf16 v[60:63], a[36:39], a[180:183], v[60:63]
v_add3_u32 v8, v8, v2, v14
v_and_b32 v2, 1, v5
v_mfma_f32_16x16x32_bf16 v[48:51], a[48:51], a[216:219], v[48:51]
v_add_u32 v12, s43, v11
v_lshl_add_u32 v8, v2, 3, v8
v_mfma_f32_16x16x32_bf16 v[48:51], a[52:55], a[232:235], v[48:51]
v_add_u32 v8, s77, v8
v_mov_b32 v4, 0xffff0000
v_mfma_f32_16x16x32_bf16 v[48:51], a[56:59], a[248:251], v[48:51]
v_add_f32_dpp v84, v78, v78 row_ror:8 row_mask:0xf bank_mask:0xf
v_add_f32_dpp v85, v79, v79 row_ror:8 row_mask:0xf bank_mask:0xf
v_mfma_f32_16x16x32_bf16 v[52:55], a[56:59], a[252:255], v[52:55]
v_add_f32_dpp v86, v80, v80 row_ror:8 row_mask:0xf bank_mask:0xf
v_add_f32_dpp v87, v81, v81 row_ror:8 row_mask:0xf bank_mask:0xf
v_mfma_f32_16x16x32_bf16 v[52:55], a[52:55], a[236:239], v[52:55]
v_add_f32_dpp v88, v100, v100 row_ror:8 row_mask:0xf bank_mask:0xf
v_add_f32_dpp v89, v101, v101 row_ror:8 row_mask:0xf bank_mask:0xf
v_mfma_f32_16x16x32_bf16 v[52:55], a[48:51], a[220:223], v[52:55]
v_add_f32_dpp v90, v102, v102 row_ror:8 row_mask:0xf bank_mask:0xf
v_add_f32_dpp v91, v103, v103 row_ror:8 row_mask:0xf bank_mask:0xf
v_mfma_f32_16x16x32_bf16 v[56:59], a[48:51], a[224:227], v[56:59]
v_add_f32_dpp v78, v84, v84 row_ror:4 row_mask:0xf bank_mask:0x5
v_add_f32_dpp v79, v85, v85 row_ror:4 row_mask:0xf bank_mask:0x5
v_mfma_f32_16x16x32_bf16 v[56:59], a[52:55], a[240:243], v[56:59]
v_add_f32_dpp v80, v86, v86 row_ror:4 row_mask:0xf bank_mask:0x5
v_add_f32_dpp v81, v87, v87 row_ror:4 row_mask:0xf bank_mask:0x5
v_mfma_f32_16x16x32_bf16 v[56:59], a[56:59], v[104:107], v[56:59]
v_add_f32_dpp v78, v88, v88 row_ror:4 row_mask:0xf bank_mask:0xa
v_add_f32_dpp v79, v89, v89 row_ror:4 row_mask:0xf bank_mask:0xa
v_mfma_f32_16x16x32_bf16 v[60:63], a[56:59], v[108:111], v[60:63]
v_add_f32_dpp v80, v90, v90 row_ror:4 row_mask:0xf bank_mask:0xa
v_add_f32_dpp v81, v91, v91 row_ror:4 row_mask:0xf bank_mask:0xa
v_mfma_f32_16x16x32_bf16 v[60:63], a[52:55], a[244:247], v[60:63]
v_lshlrev_b32 v26, 16, v16
v_and_b32 v27, v4, v16
v_mfma_f32_16x16x32_bf16 v[60:63], a[48:51], a[228:231], v[60:63]
s_waitcnt vmcnt(10)
v_lshlrev_b32 v28, 16, v17
v_and_b32 v29, v4, v17
v_mfma_f32_16x16x32_bf16 v[48:51], a[60:63], v[112:115], v[48:51]
v_lshlrev_b32 v30, 16, v18
v_and_b32 v31, v4, v18
v_mfma_f32_16x16x32_bf16 v[48:51], a[64:67], v[128:131], v[48:51]
v_lshlrev_b32 v32, 16, v19
v_and_b32 v33, v4, v19
v_mfma_f32_16x16x32_bf16 v[48:51], a[68:71], v[144:147], v[48:51]
v_lshlrev_b32 v34, 16, v20
v_and_b32 v35, v4, v20
v_mfma_f32_16x16x32_bf16 v[52:55], a[68:71], v[148:151], v[52:55]
v_lshlrev_b32 v36, 16, v21
v_and_b32 v37, v4, v21
v_mfma_f32_16x16x32_bf16 v[52:55], a[64:67], v[132:135], v[52:55]
v_lshlrev_b32 v38, 16, v22
v_and_b32 v39, v4, v22
v_mfma_f32_16x16x32_bf16 v[52:55], a[60:63], v[116:119], v[52:55]
v_lshlrev_b32 v40, 16, v23
v_and_b32 v41, v4, v23
v_mfma_f32_16x16x32_bf16 v[56:59], a[60:63], v[120:123], v[56:59]
v_lshlrev_b32 v42, 16, v24
v_and_b32 v43, v4, v24
v_mfma_f32_16x16x32_bf16 v[56:59], a[64:67], v[136:139], v[56:59]
v_lshlrev_b32 v44, 16, v25
v_and_b32 v45, v4, v25
v_mfma_f32_16x16x32_bf16 v[56:59], a[68:71], v[152:155], v[56:59]
v_fmac_f32 v42, s56, v78
v_fmac_f32 v43, s56, v79
v_mfma_f32_16x16x32_bf16 v[60:63], a[68:71], v[156:159], v[60:63]
v_fmac_f32 v44, s56, v80
v_fmac_f32 v45, s56, v81
v_mfma_f32_16x16x32_bf16 v[60:63], a[64:67], v[140:143], v[60:63]
v_cvt_pk_bf16_f32 v24, v42, v43
v_cvt_pk_bf16_f32 v25, v44, v45
v_mfma_f32_16x16x32_bf16 v[60:63], a[60:63], v[124:127], v[60:63]
s_waitcnt vmcnt(7)
s_cmp_eq_u32 s28, 1
s_cbranch_scc0 L_rc_s_57
L_rc_b_58:
v_mfma_f32_16x16x32_bf16 v[48:51], a[72:75], v[160:163], v[48:51]
s_add_u32 s52, s52, 65536
s_addc_u32 s53, s53, 0
global_load_dwordx4 v[70:73], v7, s[52:53] offset:0 sc1
global_load_dwordx4 v[74:77], v7, s[52:53] offset:1024 sc1
v_mfma_f32_16x16x32_bf16 v[48:51], a[76:79], v[176:179], v[48:51]
s_waitcnt vmcnt(4)
s_atomic_add s54, s[66:67], 28
v_mfma_f32_16x16x32_bf16 v[48:51], a[80:83], v[192:195], v[48:51]
v_mfma_f32_16x16x32_bf16 v[52:55], a[80:83], v[196:199], v[52:55]
s_waitcnt vmcnt(2)
v_mfma_f32_16x16x32_bf16 v[48:51], v[64:67], v[92:95], v[48:51]
v_mfma_f32_16x16x32_bf16 v[52:55], v[66:69], v[92:95], v[52:55]
v_mfma_f32_16x16x32_bf16 v[56:59], v[64:67], v[96:99], v[56:59]
v_mfma_f32_16x16x32_bf16 v[60:63], v[66:69], v[96:99], v[60:63]
v_mfma_f32_16x16x32_bf16 v[52:55], a[76:79], v[180:183], v[52:55]
v_mfma_f32_16x16x32_bf16 v[52:55], a[72:75], v[164:167], v[52:55]
v_mfma_f32_16x16x32_bf16 v[56:59], a[72:75], v[168:171], v[56:59]
v_mfma_f32_16x16x32_bf16 v[56:59], a[76:79], v[184:187], v[56:59]
v_mfma_f32_16x16x32_bf16 v[56:59], a[80:83], v[200:203], v[56:59]
v_mfma_f32_16x16x32_bf16 v[60:63], a[80:83], v[204:207], v[60:63]
v_mfma_f32_16x16x32_bf16 v[60:63], a[76:79], v[188:191], v[60:63]
v_mfma_f32_16x16x32_bf16 v[60:63], a[72:75], v[172:175], v[60:63]
v_mfma_f32_16x16x32_bf16 v[48:51], a[84:87], v[208:211], v[48:51]
v_mfma_f32_16x16x32_bf16 v[48:51], a[88:91], v[224:227], v[48:51]
v_mfma_f32_16x16x32_bf16 v[48:51], a[92:95], v[240:243], v[48:51]
v_mfma_f32_16x16x32_bf16 v[52:55], a[92:95], v[244:247], v[52:55]
v_mfma_f32_16x16x32_bf16 v[52:55], a[88:91], v[228:231], v[52:55]
v_mfma_f32_16x16x32_bf16 v[52:55], a[84:87], v[212:215], v[52:55]
v_mfma_f32_16x16x32_bf16 v[56:59], a[84:87], v[216:219], v[56:59]
v_mfma_f32_16x16x32_bf16 v[56:59], a[88:91], v[232:235], v[56:59]
v_mfma_f32_16x16x32_bf16 v[56:59], a[92:95], v[248:251], v[56:59]
v_mfma_f32_16x16x32_bf16 v[60:63], a[92:95], v[252:255], v[60:63]
v_mfma_f32_16x16x32_bf16 v[60:63], a[88:91], v[236:239], v[60:63]
v_mfma_f32_16x16x32_bf16 v[60:63], a[84:87], v[220:223], v[60:63]
s_mov_b64 s[28:29], 0
s_atomic_add s28, s[78:79], 28 glc
s_waitcnt vmcnt(0)
v_mfma_f32_16x16x32_bf16 v[48:51], v[64:67], v[70:73], v[48:51]
v_mfma_f32_16x16x32_bf16 v[52:55], v[66:69], v[70:73], v[52:55]
v_mfma_f32_16x16x32_bf16 v[56:59], v[64:67], v[74:77], v[56:59]
v_mfma_f32_16x16x32_bf16 v[60:63], v[66:69], v[74:77], v[60:63]
s_mov_b32 s41, 0
L_rB_p_59:
s_waitcnt lgkmcnt(0)
s_cmp_eq_u32 s28, 1
s_cbranch_scc1 L_rB_g_60
s_mov_b64 s[28:29], 0
s_atomic_add s28, s[78:79], 28 glc
s_add_u32 s41, s41, 1
s_cmp_gt_u32 s41, 2097152
s_cbranch_scc0 L_rB_p_59
s_waitcnt lgkmcnt(0)
L_rB_g_60:
s_add_u32 s52, s52, 65536
s_addc_u32 s53, s53, 0
global_load_dwordx4 v[92:95], v7, s[52:53] offset:0 sc1
global_load_dwordx4 v[96:99], v7, s[52:53] offset:1024 sc1
s_waitcnt vmcnt(0)
v_mfma_f32_16x16x32_bf16 v[48:51], v[64:67], v[92:95], v[48:51]
v_mfma_f32_16x16x32_bf16 v[52:55], v[66:69], v[92:95], v[52:55]
v_mfma_f32_16x16x32_bf16 v[56:59], v[64:67], v[96:99], v[56:59]
v_mfma_f32_16x16x32_bf16 v[60:63], v[66:69], v[96:99], v[60:63]
s_nop 4
v_fmac_f32 v26, s56, v48
v_fmac_f32 v27, s56, v49
v_cvt_pk_bf16_f32 v16, v26, v27
v_fmac_f32 v28, s56, v50
v_fmac_f32 v29, s56, v51
v_cvt_pk_bf16_f32 v17, v28, v29
v_fmac_f32 v30, s56, v52
v_fmac_f32 v31, s56, v53
v_cvt_pk_bf16_f32 v18, v30, v31
v_fmac_f32 v32, s56, v54
v_fmac_f32 v33, s56, v55
v_cvt_pk_bf16_f32 v19, v32, v33
v_fmac_f32 v34, s56, v56
v_fmac_f32 v35, s56, v57
v_cvt_pk_bf16_f32 v20, v34, v35
v_fmac_f32 v36, s56, v58
v_fmac_f32 v37, s56, v59
v_cvt_pk_bf16_f32 v21, v36, v37
v_fmac_f32 v38, s56, v60
v_fmac_f32 v39, s56, v61
v_cvt_pk_bf16_f32 v22, v38, v39
v_fmac_f32 v40, s56, v62
v_fmac_f32 v41, s56, v63
v_cvt_pk_bf16_f32 v23, v40, v41
v_permlane16_swap_b32 v16, v18
v_permlane16_swap_b32 v17, v19
v_permlane16_swap_b32 v20, v22
v_permlane16_swap_b32 v21, v23
s_cmp_lg_u32 s3, 0
s_cbranch_scc1 L_final
global_store_dwordx4 v11, v[16:19], s[22:23] sc1
global_store_dwordx4 v12, v[20:23], s[22:23] sc1
s_mov_b32 exec_lo, 0x00ff00ff
s_mov_b32 exec_hi, 0x00ff00ff
global_store_dwordx2 v8, v[24:25], s[22:23] sc1
s_mov_b64 exec, -1
global_load_dwordx4 a[0:3], v7, s[30:31] offset:-4096 sc1
global_load_dwordx4 a[4:7], v7, s[30:31] offset:-3072 sc1
global_load_dwordx4 a[8:11], v7, s[30:31] offset:-2048 sc1
s_cmp_ge_u32 s24, 2
s_cbranch_scc1 L_qp_61
global_load_dwordx4 a[12:15], v7, s[30:31] offset:-1024 sc1
L_qp_61:
global_load_dwordx4 a[16:19], v7, s[30:31] offset:0 sc1
global_load_dwordx4 a[20:23], v7, s[30:31] offset:1024 sc1
global_load_dwordx4 a[24:27], v7, s[30:31] offset:2048 sc1
s_cmp_ge_u32 s24, 2
s_cbranch_scc1 L_qp_62
global_load_dwordx4 a[28:31], v7, s[30:31] offset:3072 sc1
L_qp_62:
s_add_u32 s30, s30, 0x2000
s_addc_u32 s31, s31, 0
s_lshl_b32 s40, s25, 8
s_add_u32 s40, s40, 16384
s_add_u32 s70, s68, s40
s_addc_u32 s71, s69, 0
s_cmp_eq_u32 s25, 0
s_cselect_b32 s41, 0, 256
s_sub_u32 s66, s70, s41
s_subb_u32 s67, s71, 0
s_mov_b32 s28, 1
s_mov_b32 s3, 1
s_add_u32 s48, s22, 41164800
s_addc_u32 s49, s23, 0
s_add_u32 s68, s22, 16326656
s_addc_u32 s69, s23, 0
s_mov_b32 s38, 2048
s_mov_b32 s39, 4096
s_mov_b32 s64, 512
s_mul_i32 s42, s27, 18432
s_lshl_b32 s43, s25, 2
s_max_u32 s43, s43, 1
s_sub_u32 s43, s43, 1
s_mul_i32 s43, s43, 18432
s_lshr_b32 s44, s24, 1
s_mul_i32 s44, s44, 2048
s_add_u32 s43, s43, s44
s_add_u32 s42, s42, 13770752
s_add_u32 s43, s43, 13770752
s_add_u32 s32, s22, s42
s_addc_u32 s33, s23, 0
s_add_u32 s34, s22, s43
s_addc_u32 s35, s23, 0
s_add_u32 s36, s24, 1
s_mul_i32 s36, s36, 18432
s_lshl_b32 s37, s24, 10
v_lshrrev_b32 v13, 1, v5
v_and_b32 v10, 7, v1
v_lshrrev_b32 v12, 3, v6
s_lshr_b32 s44, s24, 1
s_lshl_b32 s44, s44, 3
v_mov_b32 v8, v7
v_add_u32 v155, 0x400, v7
v_mov_b32 v9, v7
v_add_u32 v157, 0x400, v7
v_lshl_add_u32 v13, v13, 4, v10
v_lshl_add_u32 v15, s26, 4, v10
v_add_u32 v13, s44, v13
v_add_u32 v15, s44, v15
s_bitcmp1_b32 s24, 0
s_cselect_b64 vcc, -1, 0
s_cselect_b32 s45, 3, 1
s_mul_i32 s45, s45, 18432
v_add_u32 v158, 55296, v157
v_cndmask_b32 v156, v8, v155, vcc
v_and_b32 v164, 1, v5
v_mul_u32_u24 v11, 18432, v12
v_lshl_add_u32 v11, v164, 3, v11
s_lshl_b32 s44, s26, 11
s_add_u32 s44, s44, s45
s_add_u32 s45, s45, 16384
v_lshl_add_u32 v13, v13, 4, v11
v_add_u32 v13, s44, v13
v_lshl_add_u32 v15, v15, 4, v11
v_add_u32 v15, s45, v15
v_xor_b32 v14, s64, v13
s_lshl_b32 s64, s64, 1
v_xor_b32 v159, s64, v13
v_xor_b32 v160, s64, v14
v_mad_u32_u24 v12, v12, 40, v10
v_add_u32 v10, 55296, v9
s_lshl_b32 s47, s24, 5
s_add_u32 s47, s47, 92160
v_mul_u32_u24 v11, 144, v12
v_lshl_add_u32 v11, v5, 3, v11
v_add_u32 v11, s47, v11
v_lshrrev_b32 v163, 1, v5
v_mul_u32_u24 v163, 40, v163
v_lshl_add_u32 v163, v164, 2, v163
v_and_b32 v164, 3, v6
v_add_u32 v165, v163, v164
v_mul_u32_u24 v165, 144, v165
v_lshrrev_b32 v164, 2, v6
v_lshl_add_u32 v165, v164, 3, v165
v_add_u32 v165, s47, v165
v_mul_u32_u24 v161, 640, v5
v_lshl_add_u32 v161, v12, 2, v161
v_add_u32 v161, 127680, v161
v_and_b32 v164, 1, v6
v_add_u32 v164, v164, v163
v_lshrrev_b32 v166, 1, v6
v_mul_u32_u24 v166, 640, v166
v_lshl_add_u32 v166, v164, 3, v166
v_add_u32 v166, 130240, v166
v_lshlrev_b32 v163, 2, v163
v_add_u32 v163, 126720, v163
v_lshlrev_b32 v162, 2, v12
v_add_u32 v162, 127040, v162
v_add_u32 v164, 133120, v7
s_mov_b32 vcc_lo, 0xf0000f
s_mov_b32 vcc_hi, 0xf0000f00
v_cndmask_b32 v162, v164, v162, vcc
s_mov_b32 vcc_lo, 0x1000100
s_mov_b32 vcc_hi, 0x1000100
v_cndmask_b32 v163, v164, v163, vcc
s_mov_b32 vcc_lo, 0xff00ff
s_mov_b32 vcc_hi, 0xff00ff
v_cndmask_b32 v166, v164, v166, vcc
s_mov_b32 s50, 0x22222222
s_mov_b32 s51, 0x22222222
s_mov_b32 s52, 0x44444444
s_mov_b32 s53, 0x44444444
s_mov_b32 s54, 0x88888888
s_mov_b32 s55, 0x88888888
s_lshl_b32 s44, s26, 8
s_sub_u32 s44, 2048, s44
v_and_b32 v154, 1, v1
v_mul_u32_u24 v153, s44, v154
v_sub_u32 v153, 16527616, v153
v_mad_u32_u24 v154, v154, 9, 9
s_mov_b32 exec_lo, 0
v_mov_b32 v153, 16527872
v_mov_b32 v154, 12
s_mov_b32 exec_lo, -1
s_waitcnt vmcnt(6)
s_waitcnt lgkmcnt(0)
s_barrier
s_cmp_lg_u32 s24, 0
s_cbranch_scc1 L_sy_o_63
s_atomic_add s28, s[70:71], 0 glc
s_setprio 3
s_mov_b32 s29, 0
s_atomic_add s29, s[66:67], 0 glc
L_sy_o_63:
global_load_dwordx4 a[32:35], v7, s[30:31] offset:-4096 sc1
global_load_dwordx4 a[36:39], v7, s[30:31] offset:-3072 sc1
global_load_dwordx4 a[40:43], v7, s[30:31] offset:-2048 sc1
s_cmp_ge_u32 s24, 2
s_cbranch_scc1 L_qp_66
global_load_dwordx4 a[44:47], v7, s[30:31] offset:-1024 sc1
L_qp_66:
global_load_dwordx4 a[48:51], v7, s[30:31] offset:0 sc1
global_load_dwordx4 a[52:55], v7, s[30:31] offset:1024 sc1
global_load_dwordx4 a[56:59], v7, s[30:31] offset:2048 sc1
s_cmp_ge_u32 s24, 2
s_cbranch_scc1 L_qp_67
global_load_dwordx4 a[60:63], v7, s[30:31] offset:3072 sc1
L_qp_67:
s_add_u32 s30, s30, 0x2000
s_addc_u32 s31, s31, 0
global_load_dwordx4 a[64:67], v7, s[30:31] offset:-4096 sc1
global_load_dwordx4 a[68:71], v7, s[30:31] offset:-3072 sc1
global_load_dwordx4 a[72:75], v7, s[30:31] offset:-2048 sc1
s_cmp_ge_u32 s24, 2
s_cbranch_scc1 L_qp_68
global_load_dwordx4 a[76:79], v7, s[30:31] offset:-1024 sc1
L_qp_68:
global_load_dwordx4 a[80:83], v7, s[30:31] offset:0 sc1
global_load_dwordx4 a[84:87], v7, s[30:31] offset:1024 sc1
global_load_dwordx4 a[88:91], v7, s[30:31] offset:2048 sc1
s_cmp_ge_u32 s24, 2
s_cbranch_scc1 L_qp_69
global_load_dwordx4 a[92:95], v7, s[30:31] offset:3072 sc1
L_qp_69:
s_add_u32 s30, s30, 0x2000
s_addc_u32 s31, s31, 0
s_cmp_lg_u32 s24, 0
s_cbranch_scc1 L_sy_d_64
s_mov_b32 s41, 0
s_setprio 0
s_waitcnt lgkmcnt(0)
s_add_u32 s28, s28, 1
L_sy_p_65:
s_and_b32 s28, s28, s29
s_cmp_eq_u32 s28, 8
s_cbranch_scc1 L_sy_d_64
s_mov_b32 s28, 0
s_atomic_add s28, s[70:71], 0 glc
s_mov_b32 s29, 0
s_atomic_add s29, s[66:67], 0 glc
s_add_u32 s41, s41, 1
s_cmp_gt_u32 s41, 2097152
s_waitcnt lgkmcnt(0)
s_cbranch_scc0 L_sy_p_65
L_sy_d_64:
s_barrier
s_branch L_layer
L_final:
global_store_dwordx4 v11, v[16:19], s[18:19]
global_store_dwordx4 v12, v[20:23], s[18:19]
s_mov_b32 exec_lo, 0x00ff00ff
s_mov_b32 exec_hi, 0x00ff00ff
global_store_dwordx2 v8, v[24:25], s[18:19]
s_mov_b64 exec, -1
L_mega_end:
s_endpgm
L_rdy_s_19:
s_mov_b32 s41, 0
L_rdy_s_19_l:
global_load_dword v152, v153, s[22:23] sc1
s_add_u32 s41, s41, 1
s_cmp_gt_u32 s41, 2097152
s_waitcnt vmcnt(0)
s_cbranch_scc1 L_rdy_b_20
v_cmp_ne_u32 vcc, v152, v154
s_cbranch_vccnz L_rdy_s_19_l
s_branch L_rdy_b_20
L_rdy_s_21:
s_mov_b32 s41, 0
L_rdy_s_21_l:
global_load_dword v152, v153, s[22:23] sc1
s_add_u32 s41, s41, 1
s_cmp_gt_u32 s41, 2097152
s_waitcnt vmcnt(0)
s_cbranch_scc1 L_rdy_b_22
v_cmp_ne_u32 vcc, v152, v154
s_cbranch_vccnz L_rdy_s_21_l
s_branch L_rdy_b_22
L_rdy_s_23:
s_mov_b32 s41, 0
L_rdy_s_23_l:
global_load_dword v152, v153, s[22:23] sc1
s_add_u32 s41, s41, 1
s_cmp_gt_u32 s41, 2097152
s_waitcnt vmcnt(0)
s_cbranch_scc1 L_rdy_b_24
v_cmp_ne_u32 vcc, v152, v154
s_cbranch_vccnz L_rdy_s_23_l
s_branch L_rdy_b_24
L_ei_o_31:
global_store_dwordx4 v7, v[84:87], s[60:61] offset:0 sc1
global_store_dwordx4 v7, v[88:91], s[60:61] offset:1024 sc1
s_branch L_ei_e_32
L_ei_o_33:
global_store_dwordx4 v7, v[84:87], s[60:61] offset:0 sc1
global_store_dwordx4 v7, v[88:91], s[60:61] offset:1024 sc1
s_branch L_ei_e_34
L_rc_s_35:
s_mov_b32 s40, 0
L_rc_s_35_l:
s_waitcnt lgkmcnt(0)
s_cmp_eq_u32 s28, 1
s_cbranch_scc1 L_rc_b_36
s_add_u32 s40, s40, 1
s_cmp_gt_u32 s40, 2097152
s_cbranch_scc1 L_rc_b_36
s_mov_b64 s[28:29], 0
s_atomic_add s28, s[78:79], 4 glc
s_branch L_rc_s_35_l
L_ei_o_37:
s_add_u32 s52, s52, 65536
s_addc_u32 s53, s53, 0
global_load_dwordx4 v[92:95], v7, s[52:53] offset:0 sc1
global_load_dwordx4 v[96:99], v7, s[52:53] offset:1024 sc1
s_branch L_ei_e_38
L_ei_o_39:
global_store_dwordx4 v7, v[84:87], s[62:63] offset:0 sc1
global_store_dwordx4 v7, v[88:91], s[62:63] offset:1024 sc1
s_branch L_ei_e_40
L_rc_s_41:
s_mov_b32 s40, 0
L_rc_s_41_l:
s_waitcnt lgkmcnt(0)
s_add_u32 s41, s28, s29
s_cmp_eq_u32 s41, 9
s_cbranch_scc1 L_rc_b_42
s_add_u32 s40, s40, 1
s_cmp_gt_u32 s40, 2097152
s_cbranch_scc1 L_rc_b_42
s_mov_b64 s[28:29], 0
s_atomic_add s28, s[78:79], 8 glc
s_atomic_add s29, s[72:73], 64 glc
s_branch L_rc_s_41_l
L_ei_o_43:
s_add_u32 s52, s52, 65536
s_addc_u32 s53, s53, 0
global_load_dwordx4 v[70:73], v7, s[52:53] offset:0 sc1
global_load_dwordx4 v[74:77], v7, s[52:53] offset:1024 sc1
s_branch L_ei_e_44
L_ei_o_45:
global_store_dwordx4 v7, v[84:87], s[60:61] offset:0 sc1
global_store_dwordx4 v7, v[88:91], s[60:61] offset:1024 sc1
s_branch L_ei_e_46
L_rc_s_47:
s_mov_b32 s40, 0
L_rc_s_47_l:
s_waitcnt lgkmcnt(0)
s_cmp_eq_u32 s28, 1
s_cbranch_scc1 L_rc_b_48
s_add_u32 s40, s40, 1
s_cmp_gt_u32 s40, 2097152
s_cbranch_scc1 L_rc_b_48
s_mov_b64 s[28:29], 0
s_atomic_add s28, s[78:79], 12 glc
s_branch L_rc_s_47_l
L_ei_o_49:
s_add_u32 s52, s52, 65536
s_addc_u32 s53, s53, 0
global_load_dwordx4 v[92:95], v7, s[52:53] offset:0 sc1
global_load_dwordx4 v[96:99], v7, s[52:53] offset:1024 sc1
s_branch L_ei_e_50
L_ei_o_51:
global_store_dwordx4 v7, v[84:87], s[62:63] offset:0 sc1
global_store_dwordx4 v7, v[88:91], s[62:63] offset:1024 sc1
s_branch L_ei_e_52
L_rc_s_53:
s_mov_b32 s40, 0
L_rc_s_53_l:
s_waitcnt lgkmcnt(0)
s_cmp_eq_u32 s28, 1
s_cbranch_scc1 L_rc_b_54
s_add_u32 s40, s40, 1
s_cmp_gt_u32 s40, 2097152
s_cbranch_scc1 L_rc_b_54
s_mov_b64 s[28:29], 0
s_atomic_add s28, s[78:79], 16 glc
s_branch L_rc_s_53_l
L_rc_s_55:
s_mov_b32 s40, 0
L_rc_s_55_l:
s_waitcnt lgkmcnt(0)
s_cmp_eq_u32 s28, 1
s_cbranch_scc1 L_rc_b_56
s_add_u32 s40, s40, 1
s_cmp_gt_u32 s40, 2097152
s_cbranch_scc1 L_rc_b_56
s_mov_b64 s[28:29], 0
s_atomic_add s28, s[78:79], 20 glc
s_branch L_rc_s_55_l
L_rc_s_57:
s_mov_b32 s40, 0
L_rc_s_57_l:
s_waitcnt lgkmcnt(0)
s_cmp_eq_u32 s28, 1
s_cbranch_scc1 L_rc_b_58
s_add_u32 s40, s40, 1
s_cmp_gt_u32 s40, 2097152
s_cbranch_scc1 L_rc_b_58
s_mov_b64 s[28:29], 0
s_atomic_add s28, s[78:79], 24 glc
s_branch L_rc_s_57_l
L_mega_last:
.section .rodata,"a"

.p2align 6
.amdhsa_kernel mega_kernel
  .amdhsa_next_free_vgpr 512
  .amdhsa_next_free_sgpr 102
  .amdhsa_accum_offset 256
  .amdhsa_group_segment_fixed_size 0
  .amdhsa_kernarg_size 80
  .amdhsa_user_sgpr_count 2
  .amdhsa_user_sgpr_kernarg_segment_ptr 1
  .amdhsa_system_sgpr_workgroup_id_x 1
.end_amdhsa_kernel
```
